```python
import torch

def _softmax(x, axis=-1):
    return torch.softmax(x, dim=axis)
def _gelu(x):
    return torch.nn.functional.gelu(x, approximate="tanh")
def _silu(x):
    return torch.nn.functional.silu(x)
def _sigmoid(x):
    return torch.sigmoid(x)
def _layernorm(x, axis=-1, eps=1e-5):
    m = x.mean(dim=axis, keepdim=True)
    v = x.var(dim=axis, keepdim=True, unbiased=False)
    return (x - m) / torch.sqrt(v + eps)
def _scatter_add(tgt, idx, src, axis=0):
    return tgt.clone().index_add_(axis, idx, src)
def _segment_sum(src, seg, n):
    out = torch.zeros((n,) + src.shape[1:], dtype=src.dtype)
    return out.index_add_(0, seg, src)
def _pad(x, pw):
    flat = tuple(v for pair in reversed(pw) for v in pair)
    return torch.nn.functional.pad(x, flat)

kernel_name = 'sequential_preLN__sliding_local_dilated__dense_activation_gelu__prompt'

def setup_inputs():

    _w = (lambda a: (lambda t: t.to(torch.bfloat16) if t.is_floating_point() else t)(torch.as_tensor(a)))
    def _A_setup():
        B, S, D = 1, 2048, 1024
        return {
            "x": _w((lambda *s: torch.randn(*s, dtype=torch.bfloat16) * 0.05)(B, S, D)),
            "wqkv": _w((lambda *s: torch.randn(*s, dtype=torch.bfloat16) * 0.05)(D, 3 * D)),
            "wo": _w((lambda *s: torch.randn(*s, dtype=torch.bfloat16) * 0.05)(D, D)),
        }
    _A_in = _A_setup()

    def _B_setup():
        B, S, D, F = 1, 2048, 1024, 3584
        return {
            "x": _w((lambda *s: torch.randn(*s, dtype=torch.bfloat16) * 0.05)(B, S, D)),
            "w1": _w((lambda *s: torch.randn(*s, dtype=torch.bfloat16) * 3.2)(D, F) * (D ** -0.5)),
            "b1": _w((lambda *s: torch.randn(*s, dtype=torch.bfloat16) * 3.2)(F) * 0.01),
            "w2": _w((lambda *s: torch.randn(*s, dtype=torch.bfloat16) * 0.4)(F, D) * (F ** -0.5)),
            "b2": _w((lambda *s: torch.randn(*s, dtype=torch.bfloat16) * 0.4)(D) * 0.01),
        }
    _B_in = _B_setup()

    return {
        "A_x": _A_in["x"],
        "A_wqkv": _A_in["wqkv"],
        "A_wo": _A_in["wo"],
        "B_x": _B_in["x"],
        "B_w1": _B_in["w1"],
        "B_b1": _B_in["b1"],
        "B_w2": _B_in["w2"],
        "B_b2": _B_in["b2"],
    }

def reference(A_x, A_wqkv, A_wo, B_x, B_w1, B_b1, B_w2, B_b2):
    def _A_ref(x, wqkv, wo):
        B, S, D = x.shape
        H = 32; Dh = D // H
        W, dil = 8, 2
        qkv = (lambda x, *d: x.permute(*d))((x @ wqkv).reshape(B, S, 3, H, Dh), 2, 0, 3, 1, 4)
        q, k, v = qkv[0], qkv[1], qkv[2]
        scale = Dh ** -0.5
        pos = torch.arange(S)
        off = torch.arange(W) * dil
        idx = pos[:, None] - off[None, :]
        mask = idx >= 0
        idx_c = torch.where(mask, idx, 0).reshape(-1)
        kg = k[:, :, idx_c, :].reshape(B, H, S, W, Dh)
        vg = v[:, :, idx_c, :].reshape(B, H, S, W, Dh)
        logits = torch.einsum("bhsd,bhswd->bhsw", q, kg) * scale
        logits = torch.where(mask[None, None, :, :], logits, -1e9)
        attn = _softmax(logits, axis=-1)
        o = torch.einsum("bhsw,bhswd->bhsd", attn, vg)
        return (lambda x, *d: x.permute(*d))(o, 0, 2, 1, 3).reshape(B, S, D) @ wo

    def _B_ref(x, w1, b1, w2, b2):
        h = torch.einsum("bsd,df->bsf", x, w1) + b1
        h = _gelu(h)
        return torch.einsum("bsf,fd->bsd", h, w2) + b2

    x = A_x
    h = x + _A_ref(_layernorm(x, axis=-1), A_wqkv, A_wo)
    h2 = h + _B_ref(_layernorm(h, axis=-1), B_w1, B_b1, B_w2, B_b2)
    return h2
```

```asm
; @launch grid=(256,1,1) block=(512,1,1) lds=162048
.amdgcn_target "amdgcn-amd-amdhsa--gfx950"
.text
.globl sequential_preLN__sliding_local_dilated__dense_activation_gelu__prompt_kernel
.p2align 8
.type sequential_preLN__sliding_local_dilated__dense_activation_gelu__prompt_kernel,@function
sequential_preLN__sliding_local_dilated__dense_activation_gelu__prompt_kernel:
    s_cmp_ge_u32 s2, 256
    s_cbranch_scc1 KEND
    s_load_dwordx16 s[48:63], s[0:1], 0
    s_load_dwordx4 s[64:67], s[0:1], 64
    s_load_dwordx2 s[68:69], s[0:1], 80
    v_lshrrev_b32 v1, 6, v0
    s_and_b32 s3, s2, 7
    s_lshr_b32 s7, s2, 3
    v_readfirstlane_b32 s6, v1
    s_and_b32 s70, s3, 1
    s_lshl_b32 s70, s70, 3
    s_and_b32 s4, s7, 7
    s_add_u32 s70, s70, s4
    s_lshr_b32 s71, s3, 1
    s_lshr_b32 s4, s7, 3
    s_lshl_b32 s71, s71, 2
    s_add_u32 s71, s71, s4
    s_and_b32 s72, s7, 15
    s_lshl_b32 s73, s3, 1
    s_lshr_b32 s4, s7, 4
    s_add_u32 s73, s73, s4
    s_lshr_b32 s4, s3, 2
    s_lshl_b32 s4, s4, 2
    s_lshr_b32 s5, s7, 3
    s_add_u32 s4, s4, s5
    s_bfe_u32 s5, s3, 0x10001
    v_and_b32 v1, 63, v0
    v_and_b32 v2, 15, v0
    v_lshrrev_b32 v3, 4, v1
    s_cmp_ge_u32 s6, 4
    s_cbranch_scc1 LOADER
    s_lshl_b32 s3, s70, 7
    s_lshl_b32 s7, s71, 3
    s_add_u32 s3, s3, s7
    s_lshl_b32 s7, s6, 1
    s_add_u32 s34, s3, s7
    s_lshl_b32 s3, s34, 11
    v_lshlrev_b32 v4, 4, v1
    s_waitcnt lgkmcnt(0)
    s_mov_b32 s8, s48
    s_mov_b32 s9, s49
    s_mov_b32 s10, 4194304
    s_mov_b32 s11, 0x20000
    buffer_load_dwordx4 v[24:27], v4, s[8:11], s3 offen offset:0
    buffer_load_dwordx4 v[28:31], v4, s[8:11], s3 offen offset:1024
    buffer_load_dwordx4 v[32:35], v4, s[8:11], s3 offen offset:2048
    buffer_load_dwordx4 v[36:39], v4, s[8:11], s3 offen offset:3072
    s_lshl_b32 s3, s6, 2
    s_add_u32 s3, s3, 147456
    v_mov_b32 v5, s3
    v_mov_b32 v6, 0
    ds_write_b32 v5, v6
    v_mov_b32 v5, 147472
    ds_write_b32 v5, v6
    ds_write_b32 v5, v6 offset:4
    ds_write_b32 v5, v6 offset:8
    ds_write_b32 v5, v6 offset:36
    ds_write_b32 v5, v6 offset:40
    ds_write_b32 v5, v6 offset:44
    s_getpc_b64 s[34:35]
CT1:
    s_add_u32 s34, s34, CT_s-CT1
    s_addc_u32 s35, s35, (CT_s-CT1)>>32
    s_lshl_b32 s3, s6, 7
    v_lshlrev_b32 v51, 9, v1
    v_add_u32 v51, s3, v51
    v_cmp_gt_u32 vcc, CT_e1-CT_s, v51
    s_nop 0
    s_mov_b64 exec, vcc
    global_load_dword v240, v51, s[34:35]
CT1_e:
    s_mov_b64 exec, -1
    s_getpc_b64 s[34:35]
CT2:
    s_add_u32 s34, s34, LOADER-CT2
    s_addc_u32 s35, s35, (LOADER-CT2)>>32
    s_lshl_b32 s3, s6, 7
    v_lshlrev_b32 v51, 9, v1
    v_add_u32 v51, s3, v51
    v_cmp_gt_u32 vcc, LD1_e-LOADER, v51
    s_nop 0
    s_mov_b64 exec, vcc
    global_load_dword v241, v51, s[34:35]
CT2_e:
    s_mov_b64 exec, -1
CT_s:
    s_add_u32 s20, s68, 4194304
    s_addc_u32 s21, s69, 0
    s_mov_b32 s22, 4194304
    s_mov_b32 s23, 0x20000
    s_and_b32 s34, s6, 1
    s_lshr_b32 s35, s6, 1
    s_lshl_b32 s36, s34, 13
    v_lshrrev_b32 v4, 1, v2
    v_xor_b32 v4, v4, v3
    v_lshlrev_b32 v4, 4, v4
    v_lshl_add_u32 v7, v2, 7, v4
    v_add_u32 v5, s36, v7
    v_add_u32 v5, 2048, v5
    v_lshrrev_b32 v4, 1, v2
    v_xor_b32 v4, v4, v3
    v_xor_b32 v4, 4, v4
    v_lshlrev_b32 v4, 4, v4
    v_lshl_add_u32 v8, v2, 7, v4
    v_add_u32 v6, s36, v8
    v_add_u32 v6, 2048, v6
    s_mov_b32 s36, 24576
    s_lshl_b32 s37, s35, 1
    s_add_u32 s38, s37, 1
    v_bfe_u32 v13, v2, 3, 1
    v_and_b32 v12, 1, v3
    v_lshl_or_b32 v13, v12, 1, v13
    v_lshrrev_b32 v12, 2, v2
    v_lshl_add_u32 v12, v3, 3, v12
    v_lshlrev_b32 v14, 7, v12
    v_and_b32 v12, 3, v2
    v_lshl_add_u32 v14, v12, 3, v14
    v_add_u32 v14, s36, v14
    v_xor_b32 v12, s37, v13
    v_lshl_add_u32 v15, v12, 5, v14
    v_xor_b32 v12, s38, v13
    v_lshl_add_u32 v16, v12, 5, v14
    v_mov_b32 v68, 0
    v_mov_b32 v69, 0
    v_mov_b32 v70, 0
    v_mov_b32 v71, 0
    v_mov_b32 v72, 0
    v_mov_b32 v73, 0
    v_mov_b32 v74, 0
    v_mov_b32 v75, 0
    v_mov_b32 v76, 0
    v_mov_b32 v77, 0
    v_mov_b32 v78, 0
    v_mov_b32 v79, 0
    v_mov_b32 v80, 0
    v_mov_b32 v81, 0
    v_mov_b32 v82, 0
    v_mov_b32 v83, 0
    v_mov_b32 v84, 0
    v_mov_b32 v85, 0
    v_mov_b32 v86, 0
    v_mov_b32 v87, 0
    v_mov_b32 v88, 0
    v_mov_b32 v89, 0
    v_mov_b32 v90, 0
    v_mov_b32 v91, 0
    v_mov_b32 v92, 0
    v_mov_b32 v93, 0
    v_mov_b32 v94, 0
    v_mov_b32 v95, 0
    v_mov_b32 v96, 0
    v_mov_b32 v97, 0
    v_mov_b32 v98, 0
    v_mov_b32 v99, 0
    v_mov_b32 v100, 0
    v_mov_b32 v101, 0
    v_mov_b32 v102, 0
    v_mov_b32 v103, 0
    v_mov_b32 v104, 0
    v_mov_b32 v105, 0
    v_mov_b32 v106, 0
    v_mov_b32 v107, 0
    v_mov_b32 v108, 0
    v_mov_b32 v109, 0
    v_mov_b32 v110, 0
    v_mov_b32 v111, 0
    v_mov_b32 v112, 0
    v_mov_b32 v113, 0
    v_mov_b32 v114, 0
    v_mov_b32 v115, 0
    v_mov_b32 v116, 0
    v_mov_b32 v117, 0
    v_mov_b32 v118, 0
    v_mov_b32 v119, 0
    v_mov_b32 v120, 0
    v_mov_b32 v121, 0
    v_mov_b32 v122, 0
    v_mov_b32 v123, 0
    v_mov_b32 v124, 0
    v_mov_b32 v125, 0
    v_mov_b32 v126, 0
    v_mov_b32 v127, 0
    v_mov_b32 v128, 0
    v_mov_b32 v129, 0
    v_mov_b32 v130, 0
    v_mov_b32 v131, 0
    v_mov_b32 v132, 0
    v_mov_b32 v133, 0
    v_mov_b32 v134, 0
    v_mov_b32 v135, 0
    v_mov_b32 v136, 0
    v_mov_b32 v137, 0
    v_mov_b32 v138, 0
    v_mov_b32 v139, 0
    v_mov_b32 v140, 0
    v_mov_b32 v141, 0
    v_mov_b32 v142, 0
    v_mov_b32 v143, 0
    v_mov_b32 v144, 0
    v_mov_b32 v145, 0
    v_mov_b32 v146, 0
    v_mov_b32 v147, 0
    v_mov_b32 v148, 0
    v_mov_b32 v149, 0
    v_mov_b32 v150, 0
    v_mov_b32 v151, 0
    v_mov_b32 v152, 0
    v_mov_b32 v153, 0
    v_mov_b32 v154, 0
    v_mov_b32 v155, 0
    v_mov_b32 v156, 0
    v_mov_b32 v157, 0
    v_mov_b32 v158, 0
    v_mov_b32 v159, 0
    v_mov_b32 v160, 0
    v_mov_b32 v161, 0
    v_mov_b32 v162, 0
    v_mov_b32 v163, 0
    v_mov_b32 v164, 0
    v_mov_b32 v165, 0
    v_mov_b32 v166, 0
    v_mov_b32 v167, 0
    v_mov_b32 v168, 0
    v_mov_b32 v169, 0
    v_mov_b32 v170, 0
    v_mov_b32 v171, 0
    s_waitcnt vmcnt(2)
    v_mov_b32 v48, 0x3f803f80
    v_dot2_f32_bf16 v40, v24, v48, 0
    v_dot2_f32_bf16 v41, v24, v24, 0
    v_dot2_f32_bf16 v42, v32, v48, 0
    v_dot2_f32_bf16 v43, v32, v32, 0
    v_dot2_f32_bf16 v40, v25, v48, v40
    v_dot2_f32_bf16 v41, v25, v25, v41
    v_dot2_f32_bf16 v42, v33, v48, v42
    v_dot2_f32_bf16 v43, v33, v33, v43
    v_dot2_f32_bf16 v40, v26, v48, v40
    v_dot2_f32_bf16 v41, v26, v26, v41
    v_dot2_f32_bf16 v42, v34, v48, v42
    v_dot2_f32_bf16 v43, v34, v34, v43
    v_dot2_f32_bf16 v40, v27, v48, v40
    v_dot2_f32_bf16 v41, v27, v27, v41
    v_dot2_f32_bf16 v42, v35, v48, v42
    v_dot2_f32_bf16 v43, v35, v35, v43
    v_dot2_f32_bf16 v40, v28, v48, v40
    v_dot2_f32_bf16 v41, v28, v28, v41
    v_dot2_f32_bf16 v42, v36, v48, v42
    v_dot2_f32_bf16 v43, v36, v36, v43
    v_dot2_f32_bf16 v40, v29, v48, v40
    v_dot2_f32_bf16 v41, v29, v29, v41
    v_dot2_f32_bf16 v42, v37, v48, v42
    v_dot2_f32_bf16 v43, v37, v37, v43
    v_dot2_f32_bf16 v40, v30, v48, v40
    v_dot2_f32_bf16 v41, v30, v30, v41
    v_dot2_f32_bf16 v42, v38, v48, v42
    v_dot2_f32_bf16 v43, v38, v38, v43
    v_dot2_f32_bf16 v40, v31, v48, v40
    v_dot2_f32_bf16 v41, v31, v31, v41
    v_dot2_f32_bf16 v42, v39, v48, v42
    v_dot2_f32_bf16 v43, v39, v39, v43
    s_nop 2
    v_add_f32_dpp v40, v40, v40 quad_perm:[1,0,3,2] row_mask:0xf bank_mask:0xf
    v_add_f32_dpp v41, v41, v41 quad_perm:[1,0,3,2] row_mask:0xf bank_mask:0xf
    v_add_f32_dpp v42, v42, v42 quad_perm:[1,0,3,2] row_mask:0xf bank_mask:0xf
    v_add_f32_dpp v43, v43, v43 quad_perm:[1,0,3,2] row_mask:0xf bank_mask:0xf
    v_add_f32_dpp v40, v40, v40 quad_perm:[2,3,0,1] row_mask:0xf bank_mask:0xf
    v_add_f32_dpp v41, v41, v41 quad_perm:[2,3,0,1] row_mask:0xf bank_mask:0xf
    v_add_f32_dpp v42, v42, v42 quad_perm:[2,3,0,1] row_mask:0xf bank_mask:0xf
    v_add_f32_dpp v43, v43, v43 quad_perm:[2,3,0,1] row_mask:0xf bank_mask:0xf
    v_add_f32_dpp v40, v40, v40 row_half_mirror row_mask:0xf bank_mask:0xf
    v_add_f32_dpp v41, v41, v41 row_half_mirror row_mask:0xf bank_mask:0xf
    v_add_f32_dpp v42, v42, v42 row_half_mirror row_mask:0xf bank_mask:0xf
    v_add_f32_dpp v43, v43, v43 row_half_mirror row_mask:0xf bank_mask:0xf
    v_add_f32_dpp v40, v40, v40 row_mirror row_mask:0xf bank_mask:0xf
    v_add_f32_dpp v41, v41, v41 row_mirror row_mask:0xf bank_mask:0xf
    v_add_f32_dpp v42, v42, v42 row_mirror row_mask:0xf bank_mask:0xf
    v_add_f32_dpp v43, v43, v43 row_mirror row_mask:0xf bank_mask:0xf
    v_mov_b32 v44, v40
    v_mov_b32 v45, v41
    v_mov_b32 v46, v42
    v_mov_b32 v47, v43
    v_permlane16_swap_b32 v40, v44
    v_permlane16_swap_b32 v41, v45
    v_permlane16_swap_b32 v42, v46
    v_permlane16_swap_b32 v43, v47
    v_add_f32 v40, v40, v44
    v_add_f32 v41, v41, v45
    v_add_f32 v42, v42, v46
    v_add_f32 v43, v43, v47
    v_mov_b32 v44, v40
    v_mov_b32 v45, v41
    v_mov_b32 v46, v42
    v_mov_b32 v47, v43
    v_permlane32_swap_b32 v40, v44
    v_permlane32_swap_b32 v41, v45
    v_permlane32_swap_b32 v42, v46
    v_permlane32_swap_b32 v43, v47
    v_add_f32 v40, v40, v44
    v_add_f32 v41, v41, v45
    v_add_f32 v42, v42, v46
    v_add_f32 v43, v43, v47
    v_mul_f32 v40, 0x3a800000, v40
    v_mul_f32 v41, 0x3a800000, v41
    v_fma_f32 v41, -v40, v40, v41
    v_max_f32 v41, 0, v41
    v_mul_f32 v42, 0x3a800000, v42
    v_mul_f32 v43, 0x3a800000, v43
    v_fma_f32 v43, -v42, v42, v43
    v_max_f32 v43, 0, v43
    v_cvt_pk_bf16_f32 v40, v40, v40
    v_lshlrev_b32 v40, 16, v40
    v_cvt_pk_bf16_f32 v41, v41, v41
    v_lshlrev_b32 v41, 16, v41
    v_add_f32 v41, 0x3727c5ac, v41
    v_cvt_pk_bf16_f32 v41, v41, v41
    v_lshlrev_b32 v41, 16, v41
    v_sqrt_f32 v41, v41
    s_nop 0
    v_cvt_pk_bf16_f32 v41, v41, v41
    v_lshlrev_b32 v41, 16, v41
    v_rcp_f32 v44, v41
    s_nop 0
    v_mul_f32 v45, v40, v44
    v_sub_f32 v45, 0, v45
    v_cvt_pk_bf16_f32 v42, v42, v42
    v_lshlrev_b32 v42, 16, v42
    v_cvt_pk_bf16_f32 v43, v43, v43
    v_lshlrev_b32 v43, 16, v43
    v_add_f32 v43, 0x3727c5ac, v43
    v_cvt_pk_bf16_f32 v43, v43, v43
    v_lshlrev_b32 v43, 16, v43
    v_sqrt_f32 v43, v43
    s_nop 0
    v_cvt_pk_bf16_f32 v43, v43, v43
    v_lshlrev_b32 v43, 16, v43
    v_rcp_f32 v46, v43
    s_nop 0
    v_mul_f32 v47, v42, v46
    v_sub_f32 v47, 0, v47
    s_lshl_b32 s3, s6, 4
    s_add_u32 s3, s3, 147520
    v_mov_b32 v48, s3
    ds_write_b128 v48, v[44:47]
    s_lshl_b32 s7, s70, 11
    s_lshl_b32 s3, s71, 7
    s_add_u32 s7, s7, s3
    s_add_u32 s37, s7, 31555584
    s_lshl_b32 s7, s70, 11
    s_lshl_b32 s3, s71, 7
    s_add_u32 s7, s7, s3
    s_add_u32 s38, s7, 31588352
    s_lshl_b32 s7, s70, 11
    s_lshl_b32 s3, s71, 7
    s_add_u32 s7, s7, s3
    s_add_u32 s39, s7, 31621120
    s_sub_u32 s40, s39, 98304
    s_cmp_eq_u32 s6, 0
    s_cselect_b32 s37, s40, s37
    s_cmp_eq_u32 s6, 2
    s_cselect_b32 s37, s38, s37
    s_cmp_eq_u32 s6, 3
    s_cselect_b32 s37, s39, s37
    v_lshlrev_b32 v54, 4, v1
    v_add_u32 v54, s37, v54
    v_mov_b32 v56, 0
    v_mov_b32 v57, 0
    v_mov_b32 v58, 0
    v_mov_b32 v59, 0
    s_mov_b64 exec, 0xff
    global_store_dwordx4 v54, v[56:59], s[68:69] sc1
    s_mov_b64 exec, -1
    s_cmp_eq_u32 s34, 1
    s_cbranch_scc1 P1_r1
    s_mov_b32 s42, 0
    s_mov_b32 s46, 4294868992
    s_mov_b32 s47, 49152
    s_mov_b32 s43, 16
    s_waitcnt lgkmcnt(0)
    s_barrier
    ds_read_b128 v[196:199], v5 offset:0
    ds_read_b128 v[200:203], v5 offset:2048
    ds_read_b128 v[204:207], v5 offset:4096
    ds_read_b128 v[208:211], v5 offset:6144
    ds_read_b64_tr_b16 v[172:173], v15 offset:0
    ds_read_b64_tr_b16 v[174:175], v15 offset:512
    ds_read_b64_tr_b16 v[176:177], v16 offset:0
    ds_read_b64_tr_b16 v[178:179], v16 offset:512
    ds_read_b128 v[212:215], v7
    ds_read_b64_tr_b16 v[180:181], v15 offset:8192
    s_waitcnt lgkmcnt(4)
    v_mfma_f32_16x16x32_bf16 v[68:71], v[172:175], v[196:199], v[68:71]
    ds_read_b64_tr_b16 v[182:183], v15 offset:8704
    ds_read_b64_tr_b16 v[184:185], v16 offset:8192
    v_mfma_f32_16x16x32_bf16 v[72:75], v[172:175], v[200:203], v[72:75]
    ds_read_b64_tr_b16 v[186:187], v16 offset:8704
    ds_read_b64_tr_b16 v[188:189], v15 offset:16384
    v_mfma_f32_16x16x32_bf16 v[76:79], v[172:175], v[204:207], v[76:79]
    ds_read_b64_tr_b16 v[190:191], v15 offset:16896
    ds_read_b64_tr_b16 v[192:193], v16 offset:16384
    v_mfma_f32_16x16x32_bf16 v[80:83], v[172:175], v[208:211], v[80:83]
    ds_read_b64_tr_b16 v[194:195], v16 offset:16896
    ds_read_b128 v[48:51], v6 offset:0
    s_waitcnt lgkmcnt(10)
    v_mfma_f32_16x16x32_bf16 v[96:99], v[176:179], v[208:211], v[96:99]
    ds_read_b128 v[52:55], v6 offset:2048
    ds_read_b128 v[56:59], v6 offset:4096
    v_mfma_f32_16x16x32_bf16 v[92:95], v[176:179], v[204:207], v[92:95]
    ds_read_b128 v[60:63], v6 offset:6144
    ds_read_b64_tr_b16 v[24:25], v15 offset:4096
    v_mfma_f32_16x16x32_bf16 v[88:91], v[176:179], v[200:203], v[88:91]
    s_waitcnt lgkmcnt(8)
    ds_read_b64_tr_b16 v[26:27], v15 offset:4608
    ds_read_b64_tr_b16 v[28:29], v16 offset:4096
    v_mfma_f32_16x16x32_bf16 v[84:87], v[176:179], v[196:199], v[84:87]
    ds_read_b64_tr_b16 v[30:31], v16 offset:4608
    ds_read_b128 v[64:67], v8
    s_waitcnt lgkmcnt(14)
    v_mfma_f32_16x16x32_bf16 v[100:103], v[180:183], v[196:199], v[100:103]
    ds_read_b64_tr_b16 v[32:33], v15 offset:12288
    ds_read_b64_tr_b16 v[34:35], v15 offset:12800
    v_mfma_f32_16x16x32_bf16 v[104:107], v[180:183], v[200:203], v[104:107]
    s_waitcnt lgkmcnt(8)
    ds_read_b64_tr_b16 v[36:37], v16 offset:12288
    ds_read_b64_tr_b16 v[38:39], v16 offset:12800
    v_mfma_f32_16x16x32_bf16 v[108:111], v[180:183], v[204:207], v[108:111]
    ds_read_b64_tr_b16 v[40:41], v15 offset:20480
    ds_read_b64_tr_b16 v[42:43], v15 offset:20992
    v_mfma_f32_16x16x32_bf16 v[112:115], v[180:183], v[208:211], v[112:115]
    ds_read_b64_tr_b16 v[44:45], v16 offset:20480
    ds_read_b64_tr_b16 v[46:47], v16 offset:20992
    v_mfma_f32_16x16x32_bf16 v[164:167], v[180:183], v[212:215], v[164:167]
    s_cmp_eq_u32 s42, 2
    s_cselect_b32 s44, s46, s47
    s_waitcnt lgkmcnt(14)
    v_mfma_f32_16x16x32_bf16 v[128:131], v[184:187], v[208:211], v[128:131]
    v_add_u32 v5, s44, v5
    v_add_u32 v6, s44, v6
    v_mfma_f32_16x16x32_bf16 v[124:127], v[184:187], v[204:207], v[124:127]
    v_add_u32 v7, s44, v7
    v_add_u32 v8, s44, v8
    v_mfma_f32_16x16x32_bf16 v[120:123], v[184:187], v[200:203], v[120:123]
    v_add_u32 v15, s44, v15
    v_add_u32 v16, s44, v16
    v_mfma_f32_16x16x32_bf16 v[116:119], v[184:187], v[196:199], v[116:119]
    v_mfma_f32_16x16x32_bf16 v[168:171], v[184:187], v[212:215], v[168:171]
    s_waitcnt lgkmcnt(14)
    v_mfma_f32_16x16x32_bf16 v[132:135], v[196:199], v[188:191], v[132:135]
    v_mfma_f32_16x16x32_bf16 v[136:139], v[200:203], v[188:191], v[136:139]
    v_mfma_f32_16x16x32_bf16 v[140:143], v[204:207], v[188:191], v[140:143]
    v_mfma_f32_16x16x32_bf16 v[144:147], v[208:211], v[188:191], v[144:147]
    s_waitcnt lgkmcnt(14)
    v_mfma_f32_16x16x32_bf16 v[160:163], v[208:211], v[192:195], v[160:163]
    v_mfma_f32_16x16x32_bf16 v[156:159], v[204:207], v[192:195], v[156:159]
    v_mfma_f32_16x16x32_bf16 v[152:155], v[200:203], v[192:195], v[152:155]
    v_mfma_f32_16x16x32_bf16 v[148:151], v[196:199], v[192:195], v[148:151]
    s_branch P1a_h1
P1a_loop:
    s_waitcnt lgkmcnt(0)
    v_mfma_f32_16x16x32_bf16 v[68:71], v[172:175], v[196:199], v[68:71]
    ds_read_b128 v[48:51], v6 offset:0
    v_mfma_f32_16x16x32_bf16 v[72:75], v[172:175], v[200:203], v[72:75]
    ds_read_b128 v[52:55], v6 offset:2048
    v_mfma_f32_16x16x32_bf16 v[76:79], v[172:175], v[204:207], v[76:79]
    ds_read_b128 v[56:59], v6 offset:4096
    v_mfma_f32_16x16x32_bf16 v[80:83], v[172:175], v[208:211], v[80:83]
    ds_read_b128 v[60:63], v6 offset:6144
    v_mfma_f32_16x16x32_bf16 v[96:99], v[176:179], v[208:211], v[96:99]
    ds_read_b64_tr_b16 v[24:25], v15 offset:4096
    v_mfma_f32_16x16x32_bf16 v[92:95], v[176:179], v[204:207], v[92:95]
    ds_read_b64_tr_b16 v[26:27], v15 offset:4608
    v_mfma_f32_16x16x32_bf16 v[88:91], v[176:179], v[200:203], v[88:91]
    ds_read_b64_tr_b16 v[28:29], v16 offset:4096
    v_mfma_f32_16x16x32_bf16 v[84:87], v[176:179], v[196:199], v[84:87]
    ds_read_b64_tr_b16 v[30:31], v16 offset:4608
    v_mfma_f32_16x16x32_bf16 v[100:103], v[180:183], v[196:199], v[100:103]
    ds_read_b128 v[64:67], v8
    v_mfma_f32_16x16x32_bf16 v[104:107], v[180:183], v[200:203], v[104:107]
    ds_read_b64_tr_b16 v[32:33], v15 offset:12288
    v_mfma_f32_16x16x32_bf16 v[108:111], v[180:183], v[204:207], v[108:111]
    ds_read_b64_tr_b16 v[34:35], v15 offset:12800
    v_mfma_f32_16x16x32_bf16 v[112:115], v[180:183], v[208:211], v[112:115]
    ds_read_b64_tr_b16 v[36:37], v16 offset:12288
    v_mfma_f32_16x16x32_bf16 v[164:167], v[180:183], v[212:215], v[164:167]
    ds_read_b64_tr_b16 v[38:39], v16 offset:12800
    v_mfma_f32_16x16x32_bf16 v[128:131], v[184:187], v[208:211], v[128:131]
    ds_read_b64_tr_b16 v[40:41], v15 offset:20480
    v_mfma_f32_16x16x32_bf16 v[124:127], v[184:187], v[204:207], v[124:127]
    s_waitcnt lgkmcnt(8)
    ds_read_b64_tr_b16 v[42:43], v15 offset:20992
    v_mfma_f32_16x16x32_bf16 v[120:123], v[184:187], v[200:203], v[120:123]
    ds_read_b64_tr_b16 v[44:45], v16 offset:20480
    v_mfma_f32_16x16x32_bf16 v[116:119], v[184:187], v[196:199], v[116:119]
    ds_read_b64_tr_b16 v[46:47], v16 offset:20992
    v_mfma_f32_16x16x32_bf16 v[168:171], v[184:187], v[212:215], v[168:171]
    s_cmp_eq_u32 s42, 2
    v_mfma_f32_16x16x32_bf16 v[132:135], v[196:199], v[188:191], v[132:135]
    s_cselect_b32 s44, s46, s47
    v_mfma_f32_16x16x32_bf16 v[136:139], v[200:203], v[188:191], v[136:139]
    v_add_u32 v5, s44, v5
    v_mfma_f32_16x16x32_bf16 v[140:143], v[204:207], v[188:191], v[140:143]
    v_add_u32 v6, s44, v6
    v_mfma_f32_16x16x32_bf16 v[144:147], v[208:211], v[188:191], v[144:147]
    v_add_u32 v7, s44, v7
    v_mfma_f32_16x16x32_bf16 v[160:163], v[208:211], v[192:195], v[160:163]
    v_add_u32 v8, s44, v8
    v_mfma_f32_16x16x32_bf16 v[156:159], v[204:207], v[192:195], v[156:159]
    v_add_u32 v15, s44, v15
    v_mfma_f32_16x16x32_bf16 v[152:155], v[200:203], v[192:195], v[152:155]
    v_add_u32 v16, s44, v16
    v_mfma_f32_16x16x32_bf16 v[148:151], v[196:199], v[192:195], v[148:151]
P1a_h1:
    s_waitcnt lgkmcnt(0)
    v_mfma_f32_16x16x32_bf16 v[68:71], v[24:27], v[48:51], v[68:71]
    s_barrier
    v_mfma_f32_16x16x32_bf16 v[72:75], v[24:27], v[52:55], v[72:75]
    ds_read_b128 v[196:199], v5 offset:0
    v_mfma_f32_16x16x32_bf16 v[76:79], v[24:27], v[56:59], v[76:79]
    ds_read_b128 v[200:203], v5 offset:2048
    v_mfma_f32_16x16x32_bf16 v[80:83], v[24:27], v[60:63], v[80:83]
    ds_read_b128 v[204:207], v5 offset:4096
    v_mfma_f32_16x16x32_bf16 v[96:99], v[28:31], v[60:63], v[96:99]
    ds_read_b128 v[208:211], v5 offset:6144
    v_mfma_f32_16x16x32_bf16 v[92:95], v[28:31], v[56:59], v[92:95]
    ds_read_b64_tr_b16 v[172:173], v15 offset:0
    v_mfma_f32_16x16x32_bf16 v[88:91], v[28:31], v[52:55], v[88:91]
    ds_read_b64_tr_b16 v[174:175], v15 offset:512
    v_mfma_f32_16x16x32_bf16 v[84:87], v[28:31], v[48:51], v[84:87]
    ds_read_b64_tr_b16 v[176:177], v16 offset:0
    v_mfma_f32_16x16x32_bf16 v[100:103], v[32:35], v[48:51], v[100:103]
    ds_read_b64_tr_b16 v[178:179], v16 offset:512
    v_mfma_f32_16x16x32_bf16 v[104:107], v[32:35], v[52:55], v[104:107]
    ds_read_b128 v[212:215], v7
    v_mfma_f32_16x16x32_bf16 v[108:111], v[32:35], v[56:59], v[108:111]
    ds_read_b64_tr_b16 v[180:181], v15 offset:8192
    v_mfma_f32_16x16x32_bf16 v[112:115], v[32:35], v[60:63], v[112:115]
    ds_read_b64_tr_b16 v[182:183], v15 offset:8704
    v_mfma_f32_16x16x32_bf16 v[164:167], v[32:35], v[64:67], v[164:167]
    ds_read_b64_tr_b16 v[184:185], v16 offset:8192
    v_mfma_f32_16x16x32_bf16 v[128:131], v[36:39], v[60:63], v[128:131]
    ds_read_b64_tr_b16 v[186:187], v16 offset:8704
    v_mfma_f32_16x16x32_bf16 v[124:127], v[36:39], v[56:59], v[124:127]
    ds_read_b64_tr_b16 v[188:189], v15 offset:16384
    v_mfma_f32_16x16x32_bf16 v[120:123], v[36:39], v[52:55], v[120:123]
    s_waitcnt lgkmcnt(8)
    ds_read_b64_tr_b16 v[190:191], v15 offset:16896
    v_mfma_f32_16x16x32_bf16 v[116:119], v[36:39], v[48:51], v[116:119]
    ds_read_b64_tr_b16 v[192:193], v16 offset:16384
    v_mfma_f32_16x16x32_bf16 v[168:171], v[36:39], v[64:67], v[168:171]
    ds_read_b64_tr_b16 v[194:195], v16 offset:16896
    v_mfma_f32_16x16x32_bf16 v[132:135], v[48:51], v[40:43], v[132:135]
    s_add_u32 s42, s42, 1
    v_mfma_f32_16x16x32_bf16 v[136:139], v[52:55], v[40:43], v[136:139]
    s_cmp_eq_u32 s42, 3
    v_mfma_f32_16x16x32_bf16 v[140:143], v[56:59], v[40:43], v[140:143]
    s_cselect_b32 s42, 0, s42
    v_mfma_f32_16x16x32_bf16 v[144:147], v[60:63], v[40:43], v[144:147]
    s_sub_u32 s43, s43, 1
    v_mfma_f32_16x16x32_bf16 v[160:163], v[60:63], v[44:47], v[160:163]
    v_mfma_f32_16x16x32_bf16 v[156:159], v[56:59], v[44:47], v[156:159]
    v_mfma_f32_16x16x32_bf16 v[152:155], v[52:55], v[44:47], v[152:155]
    v_mfma_f32_16x16x32_bf16 v[148:151], v[48:51], v[44:47], v[148:151]
    s_waitcnt lgkmcnt(0)
    v_mfma_f32_16x16x32_bf16 v[68:71], v[172:175], v[196:199], v[68:71]
    ds_read_b128 v[48:51], v6 offset:0
    v_mfma_f32_16x16x32_bf16 v[72:75], v[172:175], v[200:203], v[72:75]
    ds_read_b128 v[52:55], v6 offset:2048
    v_mfma_f32_16x16x32_bf16 v[76:79], v[172:175], v[204:207], v[76:79]
    ds_read_b128 v[56:59], v6 offset:4096
    v_mfma_f32_16x16x32_bf16 v[80:83], v[172:175], v[208:211], v[80:83]
    ds_read_b128 v[60:63], v6 offset:6144
    v_mfma_f32_16x16x32_bf16 v[96:99], v[176:179], v[208:211], v[96:99]
    ds_read_b64_tr_b16 v[24:25], v15 offset:4096
    v_mfma_f32_16x16x32_bf16 v[92:95], v[176:179], v[204:207], v[92:95]
    ds_read_b64_tr_b16 v[26:27], v15 offset:4608
    v_mfma_f32_16x16x32_bf16 v[88:91], v[176:179], v[200:203], v[88:91]
    ds_read_b64_tr_b16 v[28:29], v16 offset:4096
    v_mfma_f32_16x16x32_bf16 v[84:87], v[176:179], v[196:199], v[84:87]
    ds_read_b64_tr_b16 v[30:31], v16 offset:4608
    v_mfma_f32_16x16x32_bf16 v[100:103], v[180:183], v[196:199], v[100:103]
    ds_read_b128 v[64:67], v8
    v_mfma_f32_16x16x32_bf16 v[104:107], v[180:183], v[200:203], v[104:107]
    ds_read_b64_tr_b16 v[32:33], v15 offset:12288
    v_mfma_f32_16x16x32_bf16 v[108:111], v[180:183], v[204:207], v[108:111]
    ds_read_b64_tr_b16 v[34:35], v15 offset:12800
    v_mfma_f32_16x16x32_bf16 v[112:115], v[180:183], v[208:211], v[112:115]
    ds_read_b64_tr_b16 v[36:37], v16 offset:12288
    v_mfma_f32_16x16x32_bf16 v[164:167], v[180:183], v[212:215], v[164:167]
    ds_read_b64_tr_b16 v[38:39], v16 offset:12800
    v_mfma_f32_16x16x32_bf16 v[128:131], v[184:187], v[208:211], v[128:131]
    ds_read_b64_tr_b16 v[40:41], v15 offset:20480
    v_mfma_f32_16x16x32_bf16 v[124:127], v[184:187], v[204:207], v[124:127]
    s_waitcnt lgkmcnt(8)
    ds_read_b64_tr_b16 v[42:43], v15 offset:20992
    v_mfma_f32_16x16x32_bf16 v[120:123], v[184:187], v[200:203], v[120:123]
    ds_read_b64_tr_b16 v[44:45], v16 offset:20480
    v_mfma_f32_16x16x32_bf16 v[116:119], v[184:187], v[196:199], v[116:119]
    ds_read_b64_tr_b16 v[46:47], v16 offset:20992
    v_mfma_f32_16x16x32_bf16 v[168:171], v[184:187], v[212:215], v[168:171]
    s_cmp_eq_u32 s42, 2
    v_mfma_f32_16x16x32_bf16 v[132:135], v[196:199], v[188:191], v[132:135]
    s_cselect_b32 s44, s46, s47
    v_mfma_f32_16x16x32_bf16 v[136:139], v[200:203], v[188:191], v[136:139]
    v_add_u32 v5, s44, v5
    v_mfma_f32_16x16x32_bf16 v[140:143], v[204:207], v[188:191], v[140:143]
    v_add_u32 v6, s44, v6
    v_mfma_f32_16x16x32_bf16 v[144:147], v[208:211], v[188:191], v[144:147]
    v_add_u32 v7, s44, v7
    v_mfma_f32_16x16x32_bf16 v[160:163], v[208:211], v[192:195], v[160:163]
    v_add_u32 v8, s44, v8
    v_mfma_f32_16x16x32_bf16 v[156:159], v[204:207], v[192:195], v[156:159]
    v_add_u32 v15, s44, v15
    v_mfma_f32_16x16x32_bf16 v[152:155], v[200:203], v[192:195], v[152:155]
    v_add_u32 v16, s44, v16
    v_mfma_f32_16x16x32_bf16 v[148:151], v[196:199], v[192:195], v[148:151]
    s_waitcnt lgkmcnt(0)
    v_mfma_f32_16x16x32_bf16 v[68:71], v[24:27], v[48:51], v[68:71]
    s_barrier
    v_mfma_f32_16x16x32_bf16 v[72:75], v[24:27], v[52:55], v[72:75]
    ds_read_b128 v[196:199], v5 offset:0
    v_mfma_f32_16x16x32_bf16 v[76:79], v[24:27], v[56:59], v[76:79]
    ds_read_b128 v[200:203], v5 offset:2048
    v_mfma_f32_16x16x32_bf16 v[80:83], v[24:27], v[60:63], v[80:83]
    ds_read_b128 v[204:207], v5 offset:4096
    v_mfma_f32_16x16x32_bf16 v[96:99], v[28:31], v[60:63], v[96:99]
    ds_read_b128 v[208:211], v5 offset:6144
    v_mfma_f32_16x16x32_bf16 v[92:95], v[28:31], v[56:59], v[92:95]
    ds_read_b64_tr_b16 v[172:173], v15 offset:0
    v_mfma_f32_16x16x32_bf16 v[88:91], v[28:31], v[52:55], v[88:91]
    ds_read_b64_tr_b16 v[174:175], v15 offset:512
    v_mfma_f32_16x16x32_bf16 v[84:87], v[28:31], v[48:51], v[84:87]
    ds_read_b64_tr_b16 v[176:177], v16 offset:0
    v_mfma_f32_16x16x32_bf16 v[100:103], v[32:35], v[48:51], v[100:103]
    ds_read_b64_tr_b16 v[178:179], v16 offset:512
    v_mfma_f32_16x16x32_bf16 v[104:107], v[32:35], v[52:55], v[104:107]
    ds_read_b128 v[212:215], v7
    v_mfma_f32_16x16x32_bf16 v[108:111], v[32:35], v[56:59], v[108:111]
    ds_read_b64_tr_b16 v[180:181], v15 offset:8192
    v_mfma_f32_16x16x32_bf16 v[112:115], v[32:35], v[60:63], v[112:115]
    ds_read_b64_tr_b16 v[182:183], v15 offset:8704
    v_mfma_f32_16x16x32_bf16 v[164:167], v[32:35], v[64:67], v[164:167]
    ds_read_b64_tr_b16 v[184:185], v16 offset:8192
    v_mfma_f32_16x16x32_bf16 v[128:131], v[36:39], v[60:63], v[128:131]
    ds_read_b64_tr_b16 v[186:187], v16 offset:8704
    v_mfma_f32_16x16x32_bf16 v[124:127], v[36:39], v[56:59], v[124:127]
    ds_read_b64_tr_b16 v[188:189], v15 offset:16384
    v_mfma_f32_16x16x32_bf16 v[120:123], v[36:39], v[52:55], v[120:123]
    s_waitcnt lgkmcnt(8)
    ds_read_b64_tr_b16 v[190:191], v15 offset:16896
    v_mfma_f32_16x16x32_bf16 v[116:119], v[36:39], v[48:51], v[116:119]
    ds_read_b64_tr_b16 v[192:193], v16 offset:16384
    v_mfma_f32_16x16x32_bf16 v[168:171], v[36:39], v[64:67], v[168:171]
    ds_read_b64_tr_b16 v[194:195], v16 offset:16896
    v_mfma_f32_16x16x32_bf16 v[132:135], v[48:51], v[40:43], v[132:135]
    s_add_u32 s42, s42, 1
    v_mfma_f32_16x16x32_bf16 v[136:139], v[52:55], v[40:43], v[136:139]
    s_cmp_eq_u32 s42, 3
    v_mfma_f32_16x16x32_bf16 v[140:143], v[56:59], v[40:43], v[140:143]
    s_cselect_b32 s42, 0, s42
    v_mfma_f32_16x16x32_bf16 v[144:147], v[60:63], v[40:43], v[144:147]
    s_sub_u32 s43, s43, 1
    v_mfma_f32_16x16x32_bf16 v[160:163], v[60:63], v[44:47], v[160:163]
    s_cmp_lg_u32 s43, 0
    v_mfma_f32_16x16x32_bf16 v[156:159], v[56:59], v[44:47], v[156:159]
    v_mfma_f32_16x16x32_bf16 v[152:155], v[52:55], v[44:47], v[152:155]
    v_mfma_f32_16x16x32_bf16 v[148:151], v[48:51], v[44:47], v[148:151]
    s_cbranch_scc1 P1a_loop
    s_waitcnt lgkmcnt(0)
    s_branch P1_epi
P1_r1:
    s_mov_b32 s42, 0
    s_mov_b32 s46, 4294868992
    s_mov_b32 s47, 49152
    s_mov_b32 s43, 16
    s_waitcnt lgkmcnt(0)
    s_barrier
    ds_read_b128 v[196:199], v5 offset:0
    ds_read_b128 v[200:203], v5 offset:2048
    ds_read_b128 v[204:207], v5 offset:4096
    ds_read_b128 v[208:211], v5 offset:6144
    ds_read_b64_tr_b16 v[172:173], v15 offset:0
    ds_read_b64_tr_b16 v[174:175], v15 offset:512
    ds_read_b64_tr_b16 v[176:177], v16 offset:0
    ds_read_b64_tr_b16 v[178:179], v16 offset:512
    ds_read_b128 v[212:215], v7
    ds_read_b64_tr_b16 v[180:181], v15 offset:8192
    s_waitcnt lgkmcnt(4)
    v_mfma_f32_16x16x32_bf16 v[68:71], v[172:175], v[196:199], v[68:71]
    ds_read_b64_tr_b16 v[182:183], v15 offset:8704
    ds_read_b64_tr_b16 v[184:185], v16 offset:8192
    v_mfma_f32_16x16x32_bf16 v[72:75], v[172:175], v[200:203], v[72:75]
    ds_read_b64_tr_b16 v[186:187], v16 offset:8704
    ds_read_b64_tr_b16 v[188:189], v15 offset:16384
    v_mfma_f32_16x16x32_bf16 v[76:79], v[172:175], v[204:207], v[76:79]
    ds_read_b64_tr_b16 v[190:191], v15 offset:16896
    ds_read_b64_tr_b16 v[192:193], v16 offset:16384
    v_mfma_f32_16x16x32_bf16 v[80:83], v[172:175], v[208:211], v[80:83]
    ds_read_b64_tr_b16 v[194:195], v16 offset:16896
    ds_read_b128 v[48:51], v6 offset:0
    s_waitcnt lgkmcnt(10)
    v_mfma_f32_16x16x32_bf16 v[96:99], v[176:179], v[208:211], v[96:99]
    ds_read_b128 v[52:55], v6 offset:2048
    ds_read_b128 v[56:59], v6 offset:4096
    v_mfma_f32_16x16x32_bf16 v[92:95], v[176:179], v[204:207], v[92:95]
    ds_read_b128 v[60:63], v6 offset:6144
    ds_read_b64_tr_b16 v[24:25], v15 offset:4096
    v_mfma_f32_16x16x32_bf16 v[88:91], v[176:179], v[200:203], v[88:91]
    s_waitcnt lgkmcnt(8)
    ds_read_b64_tr_b16 v[26:27], v15 offset:4608
    ds_read_b64_tr_b16 v[28:29], v16 offset:4096
    v_mfma_f32_16x16x32_bf16 v[84:87], v[176:179], v[196:199], v[84:87]
    ds_read_b64_tr_b16 v[30:31], v16 offset:4608
    ds_read_b128 v[64:67], v8
    s_waitcnt lgkmcnt(14)
    v_mfma_f32_16x16x32_bf16 v[100:103], v[180:183], v[196:199], v[100:103]
    ds_read_b64_tr_b16 v[32:33], v15 offset:12288
    ds_read_b64_tr_b16 v[34:35], v15 offset:12800
    v_mfma_f32_16x16x32_bf16 v[104:107], v[180:183], v[200:203], v[104:107]
    s_waitcnt lgkmcnt(8)
    ds_read_b64_tr_b16 v[36:37], v16 offset:12288
    ds_read_b64_tr_b16 v[38:39], v16 offset:12800
    v_mfma_f32_16x16x32_bf16 v[108:111], v[180:183], v[204:207], v[108:111]
    ds_read_b64_tr_b16 v[40:41], v15 offset:20480
    ds_read_b64_tr_b16 v[42:43], v15 offset:20992
    v_mfma_f32_16x16x32_bf16 v[112:115], v[180:183], v[208:211], v[112:115]
    ds_read_b64_tr_b16 v[44:45], v16 offset:20480
    ds_read_b64_tr_b16 v[46:47], v16 offset:20992
    s_waitcnt lgkmcnt(14)
    v_mfma_f32_16x16x32_bf16 v[128:131], v[184:187], v[208:211], v[128:131]
    s_cmp_eq_u32 s42, 2
    s_cselect_b32 s44, s46, s47
    v_mfma_f32_16x16x32_bf16 v[124:127], v[184:187], v[204:207], v[124:127]
    v_add_u32 v5, s44, v5
    v_add_u32 v6, s44, v6
    v_mfma_f32_16x16x32_bf16 v[120:123], v[184:187], v[200:203], v[120:123]
    v_add_u32 v7, s44, v7
    v_add_u32 v8, s44, v8
    v_mfma_f32_16x16x32_bf16 v[116:119], v[184:187], v[196:199], v[116:119]
    v_add_u32 v15, s44, v15
    v_add_u32 v16, s44, v16
    s_waitcnt lgkmcnt(14)
    v_mfma_f32_16x16x32_bf16 v[132:135], v[196:199], v[188:191], v[132:135]
    v_mfma_f32_16x16x32_bf16 v[136:139], v[200:203], v[188:191], v[136:139]
    v_mfma_f32_16x16x32_bf16 v[140:143], v[204:207], v[188:191], v[140:143]
    v_mfma_f32_16x16x32_bf16 v[144:147], v[208:211], v[188:191], v[144:147]
    v_mfma_f32_16x16x32_bf16 v[164:167], v[212:215], v[188:191], v[164:167]
    s_waitcnt lgkmcnt(14)
    v_mfma_f32_16x16x32_bf16 v[160:163], v[208:211], v[192:195], v[160:163]
    v_mfma_f32_16x16x32_bf16 v[156:159], v[204:207], v[192:195], v[156:159]
    v_mfma_f32_16x16x32_bf16 v[152:155], v[200:203], v[192:195], v[152:155]
    v_mfma_f32_16x16x32_bf16 v[148:151], v[196:199], v[192:195], v[148:151]
    v_mfma_f32_16x16x32_bf16 v[168:171], v[212:215], v[192:195], v[168:171]
    s_branch P1b_h1
P1b_loop:
    s_waitcnt lgkmcnt(0)
    v_mfma_f32_16x16x32_bf16 v[68:71], v[172:175], v[196:199], v[68:71]
    ds_read_b128 v[48:51], v6 offset:0
    v_mfma_f32_16x16x32_bf16 v[72:75], v[172:175], v[200:203], v[72:75]
    ds_read_b128 v[52:55], v6 offset:2048
    v_mfma_f32_16x16x32_bf16 v[76:79], v[172:175], v[204:207], v[76:79]
    ds_read_b128 v[56:59], v6 offset:4096
    v_mfma_f32_16x16x32_bf16 v[80:83], v[172:175], v[208:211], v[80:83]
    ds_read_b128 v[60:63], v6 offset:6144
    v_mfma_f32_16x16x32_bf16 v[96:99], v[176:179], v[208:211], v[96:99]
    ds_read_b64_tr_b16 v[24:25], v15 offset:4096
    v_mfma_f32_16x16x32_bf16 v[92:95], v[176:179], v[204:207], v[92:95]
    ds_read_b64_tr_b16 v[26:27], v15 offset:4608
    v_mfma_f32_16x16x32_bf16 v[88:91], v[176:179], v[200:203], v[88:91]
    ds_read_b64_tr_b16 v[28:29], v16 offset:4096
    v_mfma_f32_16x16x32_bf16 v[84:87], v[176:179], v[196:199], v[84:87]
    ds_read_b64_tr_b16 v[30:31], v16 offset:4608
    v_mfma_f32_16x16x32_bf16 v[100:103], v[180:183], v[196:199], v[100:103]
    ds_read_b128 v[64:67], v8
    v_mfma_f32_16x16x32_bf16 v[104:107], v[180:183], v[200:203], v[104:107]
    ds_read_b64_tr_b16 v[32:33], v15 offset:12288
    v_mfma_f32_16x16x32_bf16 v[108:111], v[180:183], v[204:207], v[108:111]
    ds_read_b64_tr_b16 v[34:35], v15 offset:12800
    v_mfma_f32_16x16x32_bf16 v[112:115], v[180:183], v[208:211], v[112:115]
    ds_read_b64_tr_b16 v[36:37], v16 offset:12288
    v_mfma_f32_16x16x32_bf16 v[128:131], v[184:187], v[208:211], v[128:131]
    ds_read_b64_tr_b16 v[38:39], v16 offset:12800
    v_mfma_f32_16x16x32_bf16 v[124:127], v[184:187], v[204:207], v[124:127]
    ds_read_b64_tr_b16 v[40:41], v15 offset:20480
    v_mfma_f32_16x16x32_bf16 v[120:123], v[184:187], v[200:203], v[120:123]
    s_waitcnt lgkmcnt(8)
    ds_read_b64_tr_b16 v[42:43], v15 offset:20992
    v_mfma_f32_16x16x32_bf16 v[116:119], v[184:187], v[196:199], v[116:119]
    ds_read_b64_tr_b16 v[44:45], v16 offset:20480
    v_mfma_f32_16x16x32_bf16 v[132:135], v[196:199], v[188:191], v[132:135]
    ds_read_b64_tr_b16 v[46:47], v16 offset:20992
    v_mfma_f32_16x16x32_bf16 v[136:139], v[200:203], v[188:191], v[136:139]
    s_cmp_eq_u32 s42, 2
    v_mfma_f32_16x16x32_bf16 v[140:143], v[204:207], v[188:191], v[140:143]
    s_cselect_b32 s44, s46, s47
    v_mfma_f32_16x16x32_bf16 v[144:147], v[208:211], v[188:191], v[144:147]
    v_add_u32 v5, s44, v5
    v_mfma_f32_16x16x32_bf16 v[164:167], v[212:215], v[188:191], v[164:167]
    v_add_u32 v6, s44, v6
    v_mfma_f32_16x16x32_bf16 v[160:163], v[208:211], v[192:195], v[160:163]
    v_add_u32 v7, s44, v7
    v_mfma_f32_16x16x32_bf16 v[156:159], v[204:207], v[192:195], v[156:159]
    v_add_u32 v8, s44, v8
    v_mfma_f32_16x16x32_bf16 v[152:155], v[200:203], v[192:195], v[152:155]
    v_add_u32 v15, s44, v15
    v_mfma_f32_16x16x32_bf16 v[148:151], v[196:199], v[192:195], v[148:151]
    v_add_u32 v16, s44, v16
    v_mfma_f32_16x16x32_bf16 v[168:171], v[212:215], v[192:195], v[168:171]
P1b_h1:
    s_waitcnt lgkmcnt(0)
    v_mfma_f32_16x16x32_bf16 v[68:71], v[24:27], v[48:51], v[68:71]
    s_barrier
    v_mfma_f32_16x16x32_bf16 v[72:75], v[24:27], v[52:55], v[72:75]
    ds_read_b128 v[196:199], v5 offset:0
    v_mfma_f32_16x16x32_bf16 v[76:79], v[24:27], v[56:59], v[76:79]
    ds_read_b128 v[200:203], v5 offset:2048
    v_mfma_f32_16x16x32_bf16 v[80:83], v[24:27], v[60:63], v[80:83]
    ds_read_b128 v[204:207], v5 offset:4096
    v_mfma_f32_16x16x32_bf16 v[96:99], v[28:31], v[60:63], v[96:99]
    ds_read_b128 v[208:211], v5 offset:6144
    v_mfma_f32_16x16x32_bf16 v[92:95], v[28:31], v[56:59], v[92:95]
    ds_read_b64_tr_b16 v[172:173], v15 offset:0
    v_mfma_f32_16x16x32_bf16 v[88:91], v[28:31], v[52:55], v[88:91]
    ds_read_b64_tr_b16 v[174:175], v15 offset:512
    v_mfma_f32_16x16x32_bf16 v[84:87], v[28:31], v[48:51], v[84:87]
    ds_read_b64_tr_b16 v[176:177], v16 offset:0
    v_mfma_f32_16x16x32_bf16 v[100:103], v[32:35], v[48:51], v[100:103]
    ds_read_b64_tr_b16 v[178:179], v16 offset:512
    v_mfma_f32_16x16x32_bf16 v[104:107], v[32:35], v[52:55], v[104:107]
    ds_read_b128 v[212:215], v7
    v_mfma_f32_16x16x32_bf16 v[108:111], v[32:35], v[56:59], v[108:111]
    ds_read_b64_tr_b16 v[180:181], v15 offset:8192
    v_mfma_f32_16x16x32_bf16 v[112:115], v[32:35], v[60:63], v[112:115]
    ds_read_b64_tr_b16 v[182:183], v15 offset:8704
    v_mfma_f32_16x16x32_bf16 v[128:131], v[36:39], v[60:63], v[128:131]
    ds_read_b64_tr_b16 v[184:185], v16 offset:8192
    v_mfma_f32_16x16x32_bf16 v[124:127], v[36:39], v[56:59], v[124:127]
    ds_read_b64_tr_b16 v[186:187], v16 offset:8704
    v_mfma_f32_16x16x32_bf16 v[120:123], v[36:39], v[52:55], v[120:123]
    ds_read_b64_tr_b16 v[188:189], v15 offset:16384
    v_mfma_f32_16x16x32_bf16 v[116:119], v[36:39], v[48:51], v[116:119]
    s_waitcnt lgkmcnt(8)
    ds_read_b64_tr_b16 v[190:191], v15 offset:16896
    v_mfma_f32_16x16x32_bf16 v[132:135], v[48:51], v[40:43], v[132:135]
    ds_read_b64_tr_b16 v[192:193], v16 offset:16384
    v_mfma_f32_16x16x32_bf16 v[136:139], v[52:55], v[40:43], v[136:139]
    ds_read_b64_tr_b16 v[194:195], v16 offset:16896
    v_mfma_f32_16x16x32_bf16 v[140:143], v[56:59], v[40:43], v[140:143]
    s_add_u32 s42, s42, 1
    v_mfma_f32_16x16x32_bf16 v[144:147], v[60:63], v[40:43], v[144:147]
    s_cmp_eq_u32 s42, 3
    v_mfma_f32_16x16x32_bf16 v[164:167], v[64:67], v[40:43], v[164:167]
    s_cselect_b32 s42, 0, s42
    v_mfma_f32_16x16x32_bf16 v[160:163], v[60:63], v[44:47], v[160:163]
    s_sub_u32 s43, s43, 1
    v_mfma_f32_16x16x32_bf16 v[156:159], v[56:59], v[44:47], v[156:159]
    v_mfma_f32_16x16x32_bf16 v[152:155], v[52:55], v[44:47], v[152:155]
    v_mfma_f32_16x16x32_bf16 v[148:151], v[48:51], v[44:47], v[148:151]
    v_mfma_f32_16x16x32_bf16 v[168:171], v[64:67], v[44:47], v[168:171]
    s_waitcnt lgkmcnt(0)
    v_mfma_f32_16x16x32_bf16 v[68:71], v[172:175], v[196:199], v[68:71]
    ds_read_b128 v[48:51], v6 offset:0
    v_mfma_f32_16x16x32_bf16 v[72:75], v[172:175], v[200:203], v[72:75]
    ds_read_b128 v[52:55], v6 offset:2048
    v_mfma_f32_16x16x32_bf16 v[76:79], v[172:175], v[204:207], v[76:79]
    ds_read_b128 v[56:59], v6 offset:4096
    v_mfma_f32_16x16x32_bf16 v[80:83], v[172:175], v[208:211], v[80:83]
    ds_read_b128 v[60:63], v6 offset:6144
    v_mfma_f32_16x16x32_bf16 v[96:99], v[176:179], v[208:211], v[96:99]
    ds_read_b64_tr_b16 v[24:25], v15 offset:4096
    v_mfma_f32_16x16x32_bf16 v[92:95], v[176:179], v[204:207], v[92:95]
    ds_read_b64_tr_b16 v[26:27], v15 offset:4608
    v_mfma_f32_16x16x32_bf16 v[88:91], v[176:179], v[200:203], v[88:91]
    ds_read_b64_tr_b16 v[28:29], v16 offset:4096
    v_mfma_f32_16x16x32_bf16 v[84:87], v[176:179], v[196:199], v[84:87]
    ds_read_b64_tr_b16 v[30:31], v16 offset:4608
    v_mfma_f32_16x16x32_bf16 v[100:103], v[180:183], v[196:199], v[100:103]
    ds_read_b128 v[64:67], v8
    v_mfma_f32_16x16x32_bf16 v[104:107], v[180:183], v[200:203], v[104:107]
    ds_read_b64_tr_b16 v[32:33], v15 offset:12288
    v_mfma_f32_16x16x32_bf16 v[108:111], v[180:183], v[204:207], v[108:111]
    ds_read_b64_tr_b16 v[34:35], v15 offset:12800
    v_mfma_f32_16x16x32_bf16 v[112:115], v[180:183], v[208:211], v[112:115]
    ds_read_b64_tr_b16 v[36:37], v16 offset:12288
    v_mfma_f32_16x16x32_bf16 v[128:131], v[184:187], v[208:211], v[128:131]
    ds_read_b64_tr_b16 v[38:39], v16 offset:12800
    v_mfma_f32_16x16x32_bf16 v[124:127], v[184:187], v[204:207], v[124:127]
    ds_read_b64_tr_b16 v[40:41], v15 offset:20480
    v_mfma_f32_16x16x32_bf16 v[120:123], v[184:187], v[200:203], v[120:123]
    s_waitcnt lgkmcnt(8)
    ds_read_b64_tr_b16 v[42:43], v15 offset:20992
    v_mfma_f32_16x16x32_bf16 v[116:119], v[184:187], v[196:199], v[116:119]
    ds_read_b64_tr_b16 v[44:45], v16 offset:20480
    v_mfma_f32_16x16x32_bf16 v[132:135], v[196:199], v[188:191], v[132:135]
    ds_read_b64_tr_b16 v[46:47], v16 offset:20992
    v_mfma_f32_16x16x32_bf16 v[136:139], v[200:203], v[188:191], v[136:139]
    s_cmp_eq_u32 s42, 2
    v_mfma_f32_16x16x32_bf16 v[140:143], v[204:207], v[188:191], v[140:143]
    s_cselect_b32 s44, s46, s47
    v_mfma_f32_16x16x32_bf16 v[144:147], v[208:211], v[188:191], v[144:147]
    v_add_u32 v5, s44, v5
    v_mfma_f32_16x16x32_bf16 v[164:167], v[212:215], v[188:191], v[164:167]
    v_add_u32 v6, s44, v6
    v_mfma_f32_16x16x32_bf16 v[160:163], v[208:211], v[192:195], v[160:163]
    v_add_u32 v7, s44, v7
    v_mfma_f32_16x16x32_bf16 v[156:159], v[204:207], v[192:195], v[156:159]
    v_add_u32 v8, s44, v8
    v_mfma_f32_16x16x32_bf16 v[152:155], v[200:203], v[192:195], v[152:155]
    v_add_u32 v15, s44, v15
    v_mfma_f32_16x16x32_bf16 v[148:151], v[196:199], v[192:195], v[148:151]
    v_add_u32 v16, s44, v16
    v_mfma_f32_16x16x32_bf16 v[168:171], v[212:215], v[192:195], v[168:171]
    s_waitcnt lgkmcnt(0)
    v_mfma_f32_16x16x32_bf16 v[68:71], v[24:27], v[48:51], v[68:71]
    s_barrier
    v_mfma_f32_16x16x32_bf16 v[72:75], v[24:27], v[52:55], v[72:75]
    ds_read_b128 v[196:199], v5 offset:0
    v_mfma_f32_16x16x32_bf16 v[76:79], v[24:27], v[56:59], v[76:79]
    ds_read_b128 v[200:203], v5 offset:2048
    v_mfma_f32_16x16x32_bf16 v[80:83], v[24:27], v[60:63], v[80:83]
    ds_read_b128 v[204:207], v5 offset:4096
    v_mfma_f32_16x16x32_bf16 v[96:99], v[28:31], v[60:63], v[96:99]
    ds_read_b128 v[208:211], v5 offset:6144
    v_mfma_f32_16x16x32_bf16 v[92:95], v[28:31], v[56:59], v[92:95]
    ds_read_b64_tr_b16 v[172:173], v15 offset:0
    v_mfma_f32_16x16x32_bf16 v[88:91], v[28:31], v[52:55], v[88:91]
    ds_read_b64_tr_b16 v[174:175], v15 offset:512
    v_mfma_f32_16x16x32_bf16 v[84:87], v[28:31], v[48:51], v[84:87]
    ds_read_b64_tr_b16 v[176:177], v16 offset:0
    v_mfma_f32_16x16x32_bf16 v[100:103], v[32:35], v[48:51], v[100:103]
    ds_read_b64_tr_b16 v[178:179], v16 offset:512
    v_mfma_f32_16x16x32_bf16 v[104:107], v[32:35], v[52:55], v[104:107]
    ds_read_b128 v[212:215], v7
    v_mfma_f32_16x16x32_bf16 v[108:111], v[32:35], v[56:59], v[108:111]
    ds_read_b64_tr_b16 v[180:181], v15 offset:8192
    v_mfma_f32_16x16x32_bf16 v[112:115], v[32:35], v[60:63], v[112:115]
    ds_read_b64_tr_b16 v[182:183], v15 offset:8704
    v_mfma_f32_16x16x32_bf16 v[128:131], v[36:39], v[60:63], v[128:131]
    ds_read_b64_tr_b16 v[184:185], v16 offset:8192
    v_mfma_f32_16x16x32_bf16 v[124:127], v[36:39], v[56:59], v[124:127]
    ds_read_b64_tr_b16 v[186:187], v16 offset:8704
    v_mfma_f32_16x16x32_bf16 v[120:123], v[36:39], v[52:55], v[120:123]
    ds_read_b64_tr_b16 v[188:189], v15 offset:16384
    v_mfma_f32_16x16x32_bf16 v[116:119], v[36:39], v[48:51], v[116:119]
    s_waitcnt lgkmcnt(8)
    ds_read_b64_tr_b16 v[190:191], v15 offset:16896
    v_mfma_f32_16x16x32_bf16 v[132:135], v[48:51], v[40:43], v[132:135]
    ds_read_b64_tr_b16 v[192:193], v16 offset:16384
    v_mfma_f32_16x16x32_bf16 v[136:139], v[52:55], v[40:43], v[136:139]
    ds_read_b64_tr_b16 v[194:195], v16 offset:16896
    v_mfma_f32_16x16x32_bf16 v[140:143], v[56:59], v[40:43], v[140:143]
    s_add_u32 s42, s42, 1
    v_mfma_f32_16x16x32_bf16 v[144:147], v[60:63], v[40:43], v[144:147]
    s_cmp_eq_u32 s42, 3
    v_mfma_f32_16x16x32_bf16 v[164:167], v[64:67], v[40:43], v[164:167]
    s_cselect_b32 s42, 0, s42
    v_mfma_f32_16x16x32_bf16 v[160:163], v[60:63], v[44:47], v[160:163]
    s_sub_u32 s43, s43, 1
    v_mfma_f32_16x16x32_bf16 v[156:159], v[56:59], v[44:47], v[156:159]
    s_cmp_lg_u32 s43, 0
    v_mfma_f32_16x16x32_bf16 v[152:155], v[52:55], v[44:47], v[152:155]
    v_mfma_f32_16x16x32_bf16 v[148:151], v[48:51], v[44:47], v[148:151]
    v_mfma_f32_16x16x32_bf16 v[168:171], v[64:67], v[44:47], v[168:171]
    s_cbranch_scc1 P1b_loop
CT_e1:
    s_waitcnt lgkmcnt(0)
P1_epi:
    s_lshl_b32 s36, s34, 9
    s_add_u32 s36, s36, 147840
    v_lshlrev_b32 v4, 3, v2
    v_add_u32 v5, 147712, v4
    v_add_u32 v4, s36, v4
    ds_read_b64 v[32:33], v5
    v_mov_b32 v16, 147488
    ds_read_b64 v[16:17], v16
    v_lshlrev_b32 v6, 4, v3
    s_lshl_b32 s36, s35, 7
    s_add_u32 s36, s36, 151808
    v_add_u32 v7, s36, v6
    ds_read_b128 v[44:47], v7 offset:256
    ds_read_b128 v[48:51], v7 offset:320
    v_lshlrev_b32 v8, 2, v2
    v_add_u32 v8, s36, v8
    ds_read2_b32 v[34:35], v8 offset0:128 offset1:144
    v_add_u32 v9, 149760, v6
    ds_read_b128 v[188:191], v9
    ds_read_b128 v[208:211], v9 offset:1024
    ds_read_b64 v[30:31], v4 offset:384
    ds_read_b64 v[28:29], v4 offset:256
    ds_read_b64 v[26:27], v4 offset:128
    ds_read_b64 v[24:25], v4 offset:0
    s_lshl_b32 s36, s34, 8
    v_add_u32 v9, s36, v9
    ds_read_b128 v[184:187], v9 offset:256
    ds_read_b128 v[204:207], v9 offset:1280
    ds_read_b128 v[180:183], v9 offset:192
    s_waitcnt lgkmcnt(8)
    ds_read_b128 v[200:203], v9 offset:1216
    ds_read_b128 v[176:179], v9 offset:128
    ds_read_b128 v[196:199], v9 offset:1152
    ds_read_b128 v[172:175], v9 offset:64
    ds_read_b128 v[192:195], v9 offset:1088
    ds_read_b128 v[36:39], v7 offset:0
    s_waitcnt lgkmcnt(8)
    ds_read_b128 v[40:43], v7 offset:64
    s_lshl_b32 s36, s70, 7
    s_lshl_b32 s37, s34, 6
    s_add_u32 s36, s36, s37
    s_lshl_b32 s37, s35, 5
    s_add_u32 s36, s36, s37
    v_add_u32 v10, s36, v2
    v_lshlrev_b32 v10, 11, v10
    v_lshl_add_u32 v10, v3, 3, v10
    s_lshl_b32 s36, s71, 7
    s_add_u32 s37, s36, 32768
    buffer_load_dwordx2 v[216:217], v10, s[8:11], s36 offen offset:0
    buffer_load_dwordx2 v[218:219], v10, s[8:11], s36 offen offset:32
    buffer_load_dwordx2 v[220:221], v10, s[8:11], s36 offen offset:64
    buffer_load_dwordx2 v[222:223], v10, s[8:11], s36 offen offset:96
    buffer_load_dwordx2 v[224:225], v10, s[8:11], s37 offen offset:0
    buffer_load_dwordx2 v[226:227], v10, s[8:11], s37 offen offset:32
    buffer_load_dwordx2 v[228:229], v10, s[8:11], s37 offen offset:64
    buffer_load_dwordx2 v[230:231], v10, s[8:11], s37 offen offset:96
    v_lshlrev_b32 v12, 4, v1
    s_mul_i32 s36, s35, 3072
    s_add_u32 s36, s36, 0
    v_add_u32 v12, s36, v12
    s_waitcnt lgkmcnt(0)
    v_readfirstlane_b32 s74, v16
    v_readfirstlane_b32 s75, v17
    s_cmp_eq_u32 s34, 1
    s_cbranch_scc1 P1_ex1
    v_pk_mul_f32 v[52:53], v[44:45], v[30:31] op_sel:[0,1] op_sel_hi:[1,1]
    v_pk_mul_f32 v[54:55], v[46:47], v[30:31] op_sel:[0,1] op_sel_hi:[1,1]
    v_pk_fma_f32 v[112:113], v[112:113], v[30:31], v[52:53] op_sel:[0,0,0] op_sel_hi:[1,0,1]
    v_pk_fma_f32 v[114:115], v[114:115], v[30:31], v[54:55] op_sel:[0,0,0] op_sel_hi:[1,0,1]
    v_pk_mul_f32 v[52:53], v[204:205], v[34:35] op_sel:[0,0] op_sel_hi:[1,0]
    v_pk_mul_f32 v[54:55], v[206:207], v[34:35] op_sel:[0,0] op_sel_hi:[1,0]
    v_pk_fma_f32 v[144:145], v[144:145], v[184:185], v[52:53]
    v_pk_fma_f32 v[146:147], v[146:147], v[186:187], v[54:55]
    v_pk_mul_f32 v[52:53], v[48:49], v[30:31] op_sel:[0,1] op_sel_hi:[1,1]
    v_pk_mul_f32 v[54:55], v[50:51], v[30:31] op_sel:[0,1] op_sel_hi:[1,1]
    v_pk_fma_f32 v[128:129], v[128:129], v[30:31], v[52:53] op_sel:[0,0,0] op_sel_hi:[1,0,1]
    v_pk_fma_f32 v[130:131], v[130:131], v[30:31], v[54:55] op_sel:[0,0,0] op_sel_hi:[1,0,1]
    v_pk_mul_f32 v[52:53], v[204:205], v[34:35] op_sel:[0,1] op_sel_hi:[1,1]
    v_pk_mul_f32 v[54:55], v[206:207], v[34:35] op_sel:[0,1] op_sel_hi:[1,1]
    v_pk_fma_f32 v[160:161], v[160:161], v[184:185], v[52:53]
    v_pk_fma_f32 v[162:163], v[162:163], v[186:187], v[54:55]
    v_cvt_pk_bf16_f32 v60, v112, v113
    v_cvt_pk_bf16_f32 v61, v114, v115
    v_cvt_pk_bf16_f32 v64, v144, v145
    v_cvt_pk_bf16_f32 v65, v146, v147
    v_cvt_pk_bf16_f32 v62, v128, v129
    v_cvt_pk_bf16_f32 v63, v130, v131
    v_cvt_pk_bf16_f32 v66, v160, v161
    v_cvt_pk_bf16_f32 v67, v162, v163
    ds_write_b128 v12, v[60:63]
    ds_write_b128 v12, v[64:67] offset:1024
    s_lshl_b32 s3, s6, 2
    s_add_u32 s3, s3, 147456
    v_mov_b32 v14, s3
    v_mov_b32 v15, 1
    s_waitcnt lgkmcnt(0)
    ds_write_b32 v14, v15
    v_pk_mul_f32 v[52:53], v[44:45], v[32:33] op_sel:[0,1] op_sel_hi:[1,1]
    v_pk_mul_f32 v[54:55], v[46:47], v[32:33] op_sel:[0,1] op_sel_hi:[1,1]
    v_pk_fma_f32 v[164:165], v[164:165], v[32:33], v[52:53] op_sel:[0,0,0] op_sel_hi:[1,0,1]
    v_pk_fma_f32 v[166:167], v[166:167], v[32:33], v[54:55] op_sel:[0,0,0] op_sel_hi:[1,0,1]
    v_pk_mul_f32 v[52:53], v[48:49], v[32:33] op_sel:[0,1] op_sel_hi:[1,1]
    v_pk_mul_f32 v[54:55], v[50:51], v[32:33] op_sel:[0,1] op_sel_hi:[1,1]
    v_pk_fma_f32 v[168:169], v[168:169], v[32:33], v[52:53] op_sel:[0,0,0] op_sel_hi:[1,0,1]
    v_pk_fma_f32 v[170:171], v[170:171], v[32:33], v[54:55] op_sel:[0,0,0] op_sel_hi:[1,0,1]
    s_branch P1_ex2
P1_ex1:
    v_pk_mul_f32 v[52:53], v[208:209], v[34:35] op_sel:[0,0] op_sel_hi:[1,0]
    v_pk_mul_f32 v[54:55], v[210:211], v[34:35] op_sel:[0,0] op_sel_hi:[1,0]
    v_pk_fma_f32 v[164:165], v[164:165], v[188:189], v[52:53]
    v_pk_fma_f32 v[166:167], v[166:167], v[190:191], v[54:55]
    v_pk_mul_f32 v[52:53], v[208:209], v[34:35] op_sel:[0,1] op_sel_hi:[1,1]
    v_pk_mul_f32 v[54:55], v[210:211], v[34:35] op_sel:[0,1] op_sel_hi:[1,1]
    v_pk_fma_f32 v[168:169], v[168:169], v[188:189], v[52:53]
    v_pk_fma_f32 v[170:171], v[170:171], v[190:191], v[54:55]
    v_cvt_pk_bf16_f32 v60, v164, v165
    v_cvt_pk_bf16_f32 v61, v166, v167
    v_cvt_pk_bf16_f32 v62, v168, v169
    v_cvt_pk_bf16_f32 v63, v170, v171
    ds_write_b128 v12, v[60:63] offset:2048
    s_lshl_b32 s3, s6, 2
    s_add_u32 s3, s3, 147456
    v_mov_b32 v14, s3
    v_mov_b32 v15, 1
    s_waitcnt lgkmcnt(0)
    ds_write_b32 v14, v15
    v_pk_mul_f32 v[52:53], v[44:45], v[30:31] op_sel:[0,1] op_sel_hi:[1,1]
    v_pk_mul_f32 v[54:55], v[46:47], v[30:31] op_sel:[0,1] op_sel_hi:[1,1]
    v_pk_fma_f32 v[112:113], v[112:113], v[30:31], v[52:53] op_sel:[0,0,0] op_sel_hi:[1,0,1]
    v_pk_fma_f32 v[114:115], v[114:115], v[30:31], v[54:55] op_sel:[0,0,0] op_sel_hi:[1,0,1]
    v_pk_mul_f32 v[52:53], v[204:205], v[34:35] op_sel:[0,0] op_sel_hi:[1,0]
    v_pk_mul_f32 v[54:55], v[206:207], v[34:35] op_sel:[0,0] op_sel_hi:[1,0]
    v_pk_fma_f32 v[144:145], v[144:145], v[184:185], v[52:53]
    v_pk_fma_f32 v[146:147], v[146:147], v[186:187], v[54:55]
    v_pk_mul_f32 v[52:53], v[48:49], v[30:31] op_sel:[0,1] op_sel_hi:[1,1]
    v_pk_mul_f32 v[54:55], v[50:51], v[30:31] op_sel:[0,1] op_sel_hi:[1,1]
    v_pk_fma_f32 v[128:129], v[128:129], v[30:31], v[52:53] op_sel:[0,0,0] op_sel_hi:[1,0,1]
    v_pk_fma_f32 v[130:131], v[130:131], v[30:31], v[54:55] op_sel:[0,0,0] op_sel_hi:[1,0,1]
    v_pk_mul_f32 v[52:53], v[204:205], v[34:35] op_sel:[0,1] op_sel_hi:[1,1]
    v_pk_mul_f32 v[54:55], v[206:207], v[34:35] op_sel:[0,1] op_sel_hi:[1,1]
    v_pk_fma_f32 v[160:161], v[160:161], v[184:185], v[52:53]
    v_pk_fma_f32 v[162:163], v[162:163], v[186:187], v[54:55]
P1_ex2:
    v_pk_mul_f32 v[52:53], v[44:45], v[24:25] op_sel:[0,1] op_sel_hi:[1,1]
    v_pk_mul_f32 v[54:55], v[46:47], v[24:25] op_sel:[0,1] op_sel_hi:[1,1]
    v_pk_fma_f32 v[100:101], v[100:101], v[24:25], v[52:53] op_sel:[0,0,0] op_sel_hi:[1,0,1]
    v_pk_fma_f32 v[102:103], v[102:103], v[24:25], v[54:55] op_sel:[0,0,0] op_sel_hi:[1,0,1]
    v_pk_mul_f32 v[52:53], v[192:193], v[34:35] op_sel:[0,0] op_sel_hi:[1,0]
    v_pk_mul_f32 v[54:55], v[194:195], v[34:35] op_sel:[0,0] op_sel_hi:[1,0]
    v_pk_fma_f32 v[132:133], v[132:133], v[172:173], v[52:53]
    v_pk_fma_f32 v[134:135], v[134:135], v[174:175], v[54:55]
    v_pk_mul_f32 v[52:53], v[48:49], v[24:25] op_sel:[0,1] op_sel_hi:[1,1]
    v_pk_mul_f32 v[54:55], v[50:51], v[24:25] op_sel:[0,1] op_sel_hi:[1,1]
    v_pk_fma_f32 v[116:117], v[116:117], v[24:25], v[52:53] op_sel:[0,0,0] op_sel_hi:[1,0,1]
    v_pk_fma_f32 v[118:119], v[118:119], v[24:25], v[54:55] op_sel:[0,0,0] op_sel_hi:[1,0,1]
    v_pk_mul_f32 v[52:53], v[192:193], v[34:35] op_sel:[0,1] op_sel_hi:[1,1]
    v_pk_mul_f32 v[54:55], v[194:195], v[34:35] op_sel:[0,1] op_sel_hi:[1,1]
    v_pk_fma_f32 v[148:149], v[148:149], v[172:173], v[52:53]
    v_pk_fma_f32 v[150:151], v[150:151], v[174:175], v[54:55]
    v_pk_mul_f32 v[52:53], v[44:45], v[26:27] op_sel:[0,1] op_sel_hi:[1,1]
    v_pk_mul_f32 v[54:55], v[46:47], v[26:27] op_sel:[0,1] op_sel_hi:[1,1]
    v_pk_fma_f32 v[104:105], v[104:105], v[26:27], v[52:53] op_sel:[0,0,0] op_sel_hi:[1,0,1]
    v_pk_fma_f32 v[106:107], v[106:107], v[26:27], v[54:55] op_sel:[0,0,0] op_sel_hi:[1,0,1]
    v_pk_mul_f32 v[52:53], v[196:197], v[34:35] op_sel:[0,0] op_sel_hi:[1,0]
    v_pk_mul_f32 v[54:55], v[198:199], v[34:35] op_sel:[0,0] op_sel_hi:[1,0]
    v_pk_fma_f32 v[136:137], v[136:137], v[176:177], v[52:53]
    v_pk_fma_f32 v[138:139], v[138:139], v[178:179], v[54:55]
    v_pk_mul_f32 v[52:53], v[48:49], v[26:27] op_sel:[0,1] op_sel_hi:[1,1]
    v_pk_mul_f32 v[54:55], v[50:51], v[26:27] op_sel:[0,1] op_sel_hi:[1,1]
    v_pk_fma_f32 v[120:121], v[120:121], v[26:27], v[52:53] op_sel:[0,0,0] op_sel_hi:[1,0,1]
    v_pk_fma_f32 v[122:123], v[122:123], v[26:27], v[54:55] op_sel:[0,0,0] op_sel_hi:[1,0,1]
    v_pk_mul_f32 v[52:53], v[196:197], v[34:35] op_sel:[0,1] op_sel_hi:[1,1]
    v_pk_mul_f32 v[54:55], v[198:199], v[34:35] op_sel:[0,1] op_sel_hi:[1,1]
    v_pk_fma_f32 v[152:153], v[152:153], v[176:177], v[52:53]
    v_pk_fma_f32 v[154:155], v[154:155], v[178:179], v[54:55]
    v_pk_mul_f32 v[52:53], v[44:45], v[28:29] op_sel:[0,1] op_sel_hi:[1,1]
    v_pk_mul_f32 v[54:55], v[46:47], v[28:29] op_sel:[0,1] op_sel_hi:[1,1]
    v_pk_fma_f32 v[108:109], v[108:109], v[28:29], v[52:53] op_sel:[0,0,0] op_sel_hi:[1,0,1]
    v_pk_fma_f32 v[110:111], v[110:111], v[28:29], v[54:55] op_sel:[0,0,0] op_sel_hi:[1,0,1]
    v_pk_mul_f32 v[52:53], v[200:201], v[34:35] op_sel:[0,0] op_sel_hi:[1,0]
    v_pk_mul_f32 v[54:55], v[202:203], v[34:35] op_sel:[0,0] op_sel_hi:[1,0]
    v_pk_fma_f32 v[140:141], v[140:141], v[180:181], v[52:53]
    v_pk_fma_f32 v[142:143], v[142:143], v[182:183], v[54:55]
    v_pk_mul_f32 v[52:53], v[48:49], v[28:29] op_sel:[0,1] op_sel_hi:[1,1]
    v_pk_mul_f32 v[54:55], v[50:51], v[28:29] op_sel:[0,1] op_sel_hi:[1,1]
    v_pk_fma_f32 v[124:125], v[124:125], v[28:29], v[52:53] op_sel:[0,0,0] op_sel_hi:[1,0,1]
    v_pk_fma_f32 v[126:127], v[126:127], v[28:29], v[54:55] op_sel:[0,0,0] op_sel_hi:[1,0,1]
    v_pk_mul_f32 v[52:53], v[200:201], v[34:35] op_sel:[0,1] op_sel_hi:[1,1]
    v_pk_mul_f32 v[54:55], v[202:203], v[34:35] op_sel:[0,1] op_sel_hi:[1,1]
    v_pk_fma_f32 v[156:157], v[156:157], v[180:181], v[52:53]
    v_pk_fma_f32 v[158:159], v[158:159], v[182:183], v[54:55]
    s_mov_b32 s36, 0x3e8293ee
    s_mov_b32 s37, s36
    v_pk_mul_f32 v[24:25], v[24:25], s[36:37]
    v_pk_mul_f32 v[26:27], v[26:27], s[36:37]
    v_pk_mul_f32 v[28:29], v[28:29], s[36:37]
    v_pk_mul_f32 v[30:31], v[30:31], s[36:37]
    v_pk_mul_f32 v[52:53], v[36:37], v[24:25] op_sel:[0,1] op_sel_hi:[1,1]
    v_pk_mul_f32 v[54:55], v[38:39], v[24:25] op_sel:[0,1] op_sel_hi:[1,1]
    v_pk_fma_f32 v[68:69], v[68:69], v[24:25], v[52:53] op_sel:[0,0,0] op_sel_hi:[1,0,1]
    v_pk_fma_f32 v[70:71], v[70:71], v[24:25], v[54:55] op_sel:[0,0,0] op_sel_hi:[1,0,1]
    v_pk_mul_f32 v[52:53], v[40:41], v[24:25] op_sel:[0,1] op_sel_hi:[1,1]
    v_pk_mul_f32 v[54:55], v[42:43], v[24:25] op_sel:[0,1] op_sel_hi:[1,1]
    v_pk_fma_f32 v[84:85], v[84:85], v[24:25], v[52:53] op_sel:[0,0,0] op_sel_hi:[1,0,1]
    v_pk_fma_f32 v[86:87], v[86:87], v[24:25], v[54:55] op_sel:[0,0,0] op_sel_hi:[1,0,1]
    v_pk_mul_f32 v[52:53], v[36:37], v[26:27] op_sel:[0,1] op_sel_hi:[1,1]
    v_pk_mul_f32 v[54:55], v[38:39], v[26:27] op_sel:[0,1] op_sel_hi:[1,1]
    v_pk_fma_f32 v[72:73], v[72:73], v[26:27], v[52:53] op_sel:[0,0,0] op_sel_hi:[1,0,1]
    v_pk_fma_f32 v[74:75], v[74:75], v[26:27], v[54:55] op_sel:[0,0,0] op_sel_hi:[1,0,1]
    v_pk_mul_f32 v[52:53], v[40:41], v[26:27] op_sel:[0,1] op_sel_hi:[1,1]
    v_pk_mul_f32 v[54:55], v[42:43], v[26:27] op_sel:[0,1] op_sel_hi:[1,1]
    v_pk_fma_f32 v[88:89], v[88:89], v[26:27], v[52:53] op_sel:[0,0,0] op_sel_hi:[1,0,1]
    v_pk_fma_f32 v[90:91], v[90:91], v[26:27], v[54:55] op_sel:[0,0,0] op_sel_hi:[1,0,1]
    v_pk_mul_f32 v[52:53], v[36:37], v[28:29] op_sel:[0,1] op_sel_hi:[1,1]
    v_pk_mul_f32 v[54:55], v[38:39], v[28:29] op_sel:[0,1] op_sel_hi:[1,1]
    v_pk_fma_f32 v[76:77], v[76:77], v[28:29], v[52:53] op_sel:[0,0,0] op_sel_hi:[1,0,1]
    v_pk_fma_f32 v[78:79], v[78:79], v[28:29], v[54:55] op_sel:[0,0,0] op_sel_hi:[1,0,1]
    v_pk_mul_f32 v[52:53], v[40:41], v[28:29] op_sel:[0,1] op_sel_hi:[1,1]
    v_pk_mul_f32 v[54:55], v[42:43], v[28:29] op_sel:[0,1] op_sel_hi:[1,1]
    v_pk_fma_f32 v[92:93], v[92:93], v[28:29], v[52:53] op_sel:[0,0,0] op_sel_hi:[1,0,1]
    v_pk_fma_f32 v[94:95], v[94:95], v[28:29], v[54:55] op_sel:[0,0,0] op_sel_hi:[1,0,1]
    v_pk_mul_f32 v[52:53], v[36:37], v[30:31] op_sel:[0,1] op_sel_hi:[1,1]
    v_pk_mul_f32 v[54:55], v[38:39], v[30:31] op_sel:[0,1] op_sel_hi:[1,1]
    v_pk_fma_f32 v[80:81], v[80:81], v[30:31], v[52:53] op_sel:[0,0,0] op_sel_hi:[1,0,1]
    v_pk_fma_f32 v[82:83], v[82:83], v[30:31], v[54:55] op_sel:[0,0,0] op_sel_hi:[1,0,1]
    v_pk_mul_f32 v[52:53], v[40:41], v[30:31] op_sel:[0,1] op_sel_hi:[1,1]
    v_pk_mul_f32 v[54:55], v[42:43], v[30:31] op_sel:[0,1] op_sel_hi:[1,1]
    v_pk_fma_f32 v[96:97], v[96:97], v[30:31], v[52:53] op_sel:[0,0,0] op_sel_hi:[1,0,1]
    v_pk_fma_f32 v[98:99], v[98:99], v[30:31], v[54:55] op_sel:[0,0,0] op_sel_hi:[1,0,1]
    v_cvt_pk_bf16_f32 v176, v100, v101
    v_cvt_pk_bf16_f32 v177, v102, v103
    v_cvt_pk_bf16_f32 v194, v132, v133
    v_cvt_pk_bf16_f32 v195, v134, v135
    v_cvt_pk_bf16_f32 v24, v68, v69
    v_cvt_pk_bf16_f32 v25, v70, v71
    v_cvt_pk_bf16_f32 v178, v116, v117
    v_cvt_pk_bf16_f32 v179, v118, v119
    v_cvt_pk_bf16_f32 v204, v148, v149
    v_cvt_pk_bf16_f32 v205, v150, v151
    v_cvt_pk_bf16_f32 v26, v84, v85
    v_cvt_pk_bf16_f32 v27, v86, v87
    v_cvt_pk_bf16_f32 v180, v104, v105
    v_cvt_pk_bf16_f32 v181, v106, v107
    v_cvt_pk_bf16_f32 v196, v136, v137
    v_cvt_pk_bf16_f32 v197, v138, v139
    v_cvt_pk_bf16_f32 v28, v72, v73
    v_cvt_pk_bf16_f32 v29, v74, v75
    v_cvt_pk_bf16_f32 v182, v120, v121
    v_cvt_pk_bf16_f32 v183, v122, v123
    v_cvt_pk_bf16_f32 v206, v152, v153
    v_cvt_pk_bf16_f32 v207, v154, v155
    v_cvt_pk_bf16_f32 v30, v88, v89
    v_cvt_pk_bf16_f32 v31, v90, v91
    v_cvt_pk_bf16_f32 v184, v108, v109
    v_cvt_pk_bf16_f32 v185, v110, v111
    v_cvt_pk_bf16_f32 v198, v140, v141
    v_cvt_pk_bf16_f32 v199, v142, v143
    v_cvt_pk_bf16_f32 v32, v76, v77
    v_cvt_pk_bf16_f32 v33, v78, v79
    v_cvt_pk_bf16_f32 v186, v124, v125
    v_cvt_pk_bf16_f32 v187, v126, v127
    v_cvt_pk_bf16_f32 v208, v156, v157
    v_cvt_pk_bf16_f32 v209, v158, v159
    v_cvt_pk_bf16_f32 v34, v92, v93
    v_cvt_pk_bf16_f32 v35, v94, v95
    v_cvt_pk_bf16_f32 v188, v112, v113
    v_cvt_pk_bf16_f32 v189, v114, v115
    v_cvt_pk_bf16_f32 v200, v144, v145
    v_cvt_pk_bf16_f32 v201, v146, v147
    v_cvt_pk_bf16_f32 v36, v80, v81
    v_cvt_pk_bf16_f32 v37, v82, v83
    v_cvt_pk_bf16_f32 v190, v128, v129
    v_cvt_pk_bf16_f32 v191, v130, v131
    v_cvt_pk_bf16_f32 v210, v160, v161
    v_cvt_pk_bf16_f32 v211, v162, v163
    v_cvt_pk_bf16_f32 v38, v96, v97
    v_cvt_pk_bf16_f32 v39, v98, v99
    s_cmp_eq_u32 s34, 1
    s_cbranch_scc1 P1_ex3
    v_cvt_pk_bf16_f32 v172, v164, v165
    v_cvt_pk_bf16_f32 v173, v166, v167
    v_cvt_pk_bf16_f32 v174, v168, v169
    v_cvt_pk_bf16_f32 v175, v170, v171
    v_xor_b32 v14, 4, v14
P1a_ps:
    ds_read_b32 v15, v14
    s_waitcnt lgkmcnt(0)
    v_readfirstlane_b32 s3, v15
    s_nop 0
    s_cmp_lg_u32 s3, 1
    s_cbranch_scc1 P1a_ps
    ds_read_b64 v[192:193], v12 offset:2048
    ds_read_b64 v[202:203], v12 offset:2056
    s_branch P1_ex4
P1_ex3:
    v_xor_b32 v14, 4, v14
P1b_ps:
    ds_read_b32 v15, v14
    s_waitcnt lgkmcnt(0)
    v_readfirstlane_b32 s3, v15
    s_nop 0
    s_cmp_lg_u32 s3, 1
    s_cbranch_scc1 P1b_ps
    ds_read_b128 v[172:175], v12
    ds_read_b64 v[192:193], v12 offset:1024
    ds_read_b64 v[202:203], v12 offset:1032
P1_ex4:
    v_and_b32 v68, 1, v2
    v_cmp_eq_u32 s[76:77], 1, v68
    v_lshl_add_u32 v68, v3, 2, v68
    v_cmp_le_u32 s[78:79], v68, v2
    v_add_u32 v68, 2, v68
    v_cmp_le_u32 s[80:81], v68, v2
    v_mov_b32 v68, 0xffff
    v_mov_b32 v69, 0xffff0000
    v_cndmask_b32 v68, v68, v69, s[76:77]
    v_cndmask_b32 v70, v68, 0, s[78:79]
    v_cndmask_b32 v71, 0, v68, s[78:79]
    v_cndmask_b32 v72, v68, 0, s[80:81]
    v_cndmask_b32 v73, 0, v68, s[80:81]
    s_or_b32 s36, s70, s34
    s_cmp_eq_u32 s36, 0
    s_cselect_b64 s[82:83], s[78:79], -1
    s_cselect_b64 s[84:85], s[80:81], -1
    v_and_b32 v68, 1, v3
    v_lshlrev_b32 v74, 9, v68
    v_lshrrev_b32 v68, 1, v3
    v_lshl_add_u32 v74, v68, 8, v74
    v_lshl_add_u32 v74, v2, 4, v74
    s_lshl_b32 s36, s70, 3
    s_lshl_b32 s37, s34, 2
    s_add_u32 s36, s36, s37
    s_lshl_b32 s36, s36, 5
    s_lshl_b32 s37, s71, 1
    s_add_u32 s36, s36, s37
    s_add_u32 s36, s36, s35
    s_lshl_b32 s36, s36, 10
    v_add_u32 v74, s36, v74
    v_mov_b32 v75, 0xff800000
    v_mfma_f32_16x16x32_bf16 v[84:87], v[176:179], v[28:31], 0
    v_mfma_f32_16x16x32_bf16 v[88:91], v[180:183], v[28:31], 0
    v_mfma_f32_16x16x32_bf16 v[92:95], v[180:183], v[32:35], 0
    v_mfma_f32_16x16x32_bf16 v[96:99], v[184:187], v[32:35], 0
    v_mfma_f32_16x16x32_bf16 v[100:103], v[184:187], v[36:39], 0
    v_mfma_f32_16x16x32_bf16 v[104:107], v[188:191], v[36:39], 0
    s_waitcnt lgkmcnt(0)
    v_mfma_f32_16x16x32_bf16 v[80:83], v[176:179], v[24:27], 0
    v_mfma_f32_16x16x32_bf16 v[76:79], v[172:175], v[24:27], 0
    v_cndmask_b32 v84, v84, v85, s[76:77]
    v_cndmask_b32 v88, v88, v89, s[76:77]
    v_cndmask_b32 v86, v86, v87, s[76:77]
    v_cndmask_b32 v90, v90, v91, s[76:77]
    v_cndmask_b32 v109, v84, v88, s[78:79]
    v_cndmask_b32 v113, v86, v90, s[80:81]
    v_cndmask_b32 v92, v92, v93, s[76:77]
    v_cndmask_b32 v96, v96, v97, s[76:77]
    v_cndmask_b32 v94, v94, v95, s[76:77]
    v_cndmask_b32 v98, v98, v99, s[76:77]
    v_cndmask_b32 v110, v92, v96, s[78:79]
    v_cndmask_b32 v114, v94, v98, s[80:81]
    v_cndmask_b32 v100, v100, v101, s[76:77]
    v_cndmask_b32 v104, v104, v105, s[76:77]
    v_cndmask_b32 v102, v102, v103, s[76:77]
    v_cndmask_b32 v106, v106, v107, s[76:77]
    v_cndmask_b32 v111, v100, v104, s[78:79]
    v_cndmask_b32 v115, v102, v106, s[80:81]
    v_cndmask_b32 v76, v76, v77, s[76:77]
    v_cndmask_b32 v80, v80, v81, s[76:77]
    v_cndmask_b32 v78, v78, v79, s[76:77]
    v_cndmask_b32 v82, v82, v83, s[76:77]
    v_cndmask_b32 v108, v76, v80, s[78:79]
    v_cndmask_b32 v112, v78, v82, s[80:81]
    v_cndmask_b32 v108, v75, v108, s[82:83]
    v_cndmask_b32 v112, v75, v112, s[84:85]
    v_max_f32 v117, v109, v113
    v_max_f32 v118, v110, v114
    v_max_f32 v119, v111, v115
    v_max_f32 v116, v108, v112
    v_mov_b32 v121, v117
    v_mov_b32 v122, v118
    v_mov_b32 v123, v119
    v_mov_b32 v120, v116
    v_permlane16_swap_b32 v117, v121
    v_permlane16_swap_b32 v118, v122
    v_permlane16_swap_b32 v119, v123
    v_permlane16_swap_b32 v116, v120
    v_max_f32 v117, v117, v121
    v_max_f32 v118, v118, v122
    v_max_f32 v119, v119, v123
    v_max_f32 v116, v116, v120
    v_mov_b32 v121, v117
    v_mov_b32 v122, v118
    v_mov_b32 v123, v119
    v_mov_b32 v120, v116
    v_permlane32_swap_b32 v117, v121
    v_permlane32_swap_b32 v118, v122
    v_permlane32_swap_b32 v119, v123
    v_permlane32_swap_b32 v116, v120
    v_max_f32 v117, v117, v121
    v_max_f32 v118, v118, v122
    v_max_f32 v119, v119, v123
    v_max_f32 v116, v116, v120
    v_sub_f32 v109, v109, v117
    v_sub_f32 v113, v113, v117
    v_sub_f32 v110, v110, v118
    v_sub_f32 v114, v114, v118
    v_sub_f32 v111, v111, v119
    v_sub_f32 v115, v115, v119
    v_sub_f32 v108, v108, v116
    v_sub_f32 v112, v112, v116
    v_exp_f32 v109, v109
    v_exp_f32 v113, v113
    v_exp_f32 v110, v110
    v_exp_f32 v114, v114
    v_exp_f32 v111, v111
    v_exp_f32 v115, v115
    v_exp_f32 v108, v108
    v_exp_f32 v112, v112
    v_add_f32 v117, v109, v113
    v_add_f32 v118, v110, v114
    v_add_f32 v119, v111, v115
    v_add_f32 v116, v108, v112
    v_mov_b32 v121, v117
    v_mov_b32 v122, v118
    v_mov_b32 v123, v119
    v_mov_b32 v120, v116
    v_permlane16_swap_b32 v117, v121
    v_permlane16_swap_b32 v118, v122
    v_permlane16_swap_b32 v119, v123
    v_permlane16_swap_b32 v116, v120
    v_add_f32 v117, v117, v121
    v_add_f32 v118, v118, v122
    v_add_f32 v119, v119, v123
    v_add_f32 v116, v116, v120
    v_mov_b32 v121, v117
    v_mov_b32 v122, v118
    v_mov_b32 v123, v119
    v_mov_b32 v120, v116
    v_permlane32_swap_b32 v117, v121
    v_permlane32_swap_b32 v118, v122
    v_permlane32_swap_b32 v119, v123
    v_permlane32_swap_b32 v116, v120
    v_add_f32 v117, v117, v121
    v_add_f32 v118, v118, v122
    v_add_f32 v119, v119, v123
    v_add_f32 v116, v116, v120
    v_rcp_f32 v117, v117
    v_rcp_f32 v118, v118
    v_rcp_f32 v119, v119
    v_rcp_f32 v116, v116
    v_mul_f32 v109, v109, v117
    v_mul_f32 v113, v113, v117
    v_mul_f32 v110, v110, v118
    v_mul_f32 v114, v114, v118
    v_mul_f32 v111, v111, v119
    v_mul_f32 v115, v115, v119
    v_mul_f32 v108, v108, v116
    v_mul_f32 v112, v112, v116
    v_cvt_pk_bf16_f32 v109, v109, v109
    v_cvt_pk_bf16_f32 v113, v113, v113
    v_cvt_pk_bf16_f32 v110, v110, v110
    v_cvt_pk_bf16_f32 v114, v114, v114
    v_cvt_pk_bf16_f32 v111, v111, v111
    v_cvt_pk_bf16_f32 v115, v115, v115
    v_cvt_pk_bf16_f32 v108, v108, v108
    v_cvt_pk_bf16_f32 v112, v112, v112
    v_and_b32 v128, v109, v70
    v_and_b32 v129, v113, v72
    v_and_b32 v130, v109, v71
    v_and_b32 v131, v113, v73
    v_and_b32 v132, v110, v70
    v_and_b32 v133, v114, v72
    v_and_b32 v134, v110, v71
    v_and_b32 v135, v114, v73
    v_and_b32 v136, v111, v70
    v_and_b32 v137, v115, v72
    v_and_b32 v138, v111, v71
    v_and_b32 v139, v115, v73
    v_and_b32 v124, v108, v70
    v_and_b32 v125, v112, v72
    v_and_b32 v126, v108, v71
    v_and_b32 v127, v112, v73
    v_mfma_f32_16x16x32_bf16 v[148:151], v[194:197], v[128:131], 0
    v_mfma_f32_16x16x32_bf16 v[152:155], v[204:207], v[128:131], 0
    v_mfma_f32_16x16x32_bf16 v[156:159], v[196:199], v[132:135], 0
    v_mfma_f32_16x16x32_bf16 v[160:163], v[206:209], v[132:135], 0
    v_mfma_f32_16x16x32_bf16 v[164:167], v[198:201], v[136:139], 0
    v_mfma_f32_16x16x32_bf16 v[168:171], v[208:211], v[136:139], 0
    v_mfma_f32_16x16x32_bf16 v[140:143], v[192:195], v[124:127], 0
    v_mfma_f32_16x16x32_bf16 v[144:147], v[202:205], v[124:127], 0
    s_mov_b32 s76, 0
    s_mov_b32 s77, 32768
    s_mov_b32 s78, 65536
    s_mov_b32 s79, 98304
    v_cvt_pk_bf16_f32 v80, v148, v149
    v_cvt_pk_bf16_f32 v81, v150, v151
    v_cvt_pk_bf16_f32 v82, v152, v153
    v_cvt_pk_bf16_f32 v83, v154, v155
    v_cvt_pk_bf16_f32 v84, v156, v157
    v_cvt_pk_bf16_f32 v85, v158, v159
    v_cvt_pk_bf16_f32 v86, v160, v161
    v_cvt_pk_bf16_f32 v87, v162, v163
    v_cvt_pk_bf16_f32 v88, v164, v165
    v_cvt_pk_bf16_f32 v89, v166, v167
    v_cvt_pk_bf16_f32 v90, v168, v169
    v_cvt_pk_bf16_f32 v91, v170, v171
    v_cvt_pk_bf16_f32 v76, v140, v141
    v_cvt_pk_bf16_f32 v77, v142, v143
    v_cvt_pk_bf16_f32 v78, v144, v145
    v_cvt_pk_bf16_f32 v79, v146, v147
    v_permlane16_swap_b32 v80, v82
    v_permlane16_swap_b32 v81, v83
    buffer_store_dwordx4 v[80:83], v74, s[20:23], s77 offen sc1
    v_permlane16_swap_b32 v84, v86
    v_permlane16_swap_b32 v85, v87
    buffer_store_dwordx4 v[84:87], v74, s[20:23], s78 offen sc1
    v_permlane16_swap_b32 v88, v90
    v_permlane16_swap_b32 v89, v91
    buffer_store_dwordx4 v[88:91], v74, s[20:23], s79 offen sc1
    v_permlane16_swap_b32 v76, v78
    v_permlane16_swap_b32 v77, v79
    buffer_store_dwordx4 v[76:79], v74, s[20:23], s76 offen sc1
    s_lshl_b32 s7, s70, 11
    s_lshl_b32 s3, s71, 7
    s_add_u32 s7, s7, s3
    s_add_u32 s7, s7, 31555584
    v_mov_b32 v108, 147472
    v_mov_b32 v109, 1
    v_mov_b32 v110, s74
    v_mov_b32 v111, s75
    s_mov_b64 exec, 1
    s_waitcnt vmcnt(0)
    ds_add_rtn_u32 v109, v108, v109
    v_mov_b32 v108, s7
    s_waitcnt lgkmcnt(0)
    v_readfirstlane_b32 s3, v109
    s_nop 0
    s_cmp_lg_u32 s3, 3
    s_cbranch_scc1 FIN1
    global_store_dwordx2 v108, v[110:111], s[68:69] sc1
FIN1:
    s_mov_b64 exec, -1
    s_add_u32 s16, s68, 8388608
    s_addc_u32 s17, s69, 0
    s_mov_b32 s18, 4194304
    s_mov_b32 s19, 0x20000
    s_add_u32 s24, s68, 29360128
    s_addc_u32 s25, s69, 0
    s_mov_b32 s26, 262144
    s_mov_b32 s27, 0x20000
    s_and_b32 s34, s6, 1
    s_lshr_b32 s35, s6, 1
    s_lshl_b32 s36, s34, 14
    s_lshl_b32 s37, s35, 11
    s_add_u32 s36, s36, s37
    s_add_u32 s36, s36, 49152
    v_lshlrev_b32 v4, 4, v1
    v_add_u32 v4, s36, v4
    s_lshl_b32 s37, s35, 13
    s_sub_u32 s38, 8192, s37
    v_add_u32 v5, s38, v4
    v_add_u32 v4, s37, v4
    s_lshl_b32 s36, s35, 13
    s_add_u32 s36, s36, 81920
    v_bfe_u32 v7, v2, 3, 1
    v_and_b32 v6, 1, v3
    v_lshl_or_b32 v7, v6, 1, v7
    v_lshrrev_b32 v6, 2, v2
    v_lshl_add_u32 v6, v3, 3, v6
    v_lshlrev_b32 v8, 7, v6
    v_and_b32 v6, 3, v2
    v_lshl_add_u32 v8, v6, 3, v8
    v_add_u32 v8, s36, v8
    v_xor_b32 v6, 0, v7
    v_lshl_add_u32 v9, v6, 5, v8
    v_xor_b32 v6, 1, v7
    v_lshl_add_u32 v10, v6, 5, v8
    v_xor_b32 v6, 2, v7
    v_lshl_add_u32 v11, v6, 5, v8
    v_xor_b32 v6, 3, v7
    v_lshl_add_u32 v12, v6, 5, v8
    s_lshl_b32 s36, s70, 7
    s_lshl_b32 s37, s34, 6
    s_add_u32 s36, s36, s37
    s_lshl_b32 s37, s35, 5
    s_add_u32 s36, s36, s37
    v_add_u32 v146, s36, v2
    v_lshlrev_b32 v146, 3, v146
    v_cmp_eq_u32 vcc, 0, v3
    v_mov_b32 v145, 0x7ffffff0
    s_nop 0
    v_cndmask_b32 v146, v145, v146, vcc
    v_and_b32 v145, 1, v3
    v_lshlrev_b32 v144, 9, v145
    v_lshrrev_b32 v145, 1, v3
    v_lshl_add_u32 v144, v145, 8, v144
    v_lshl_add_u32 v144, v2, 4, v144
    s_lshl_b32 s36, s36, 11
    s_lshl_b32 s37, s71, 11
    s_add_u32 s36, s36, s37
    v_add_u32 v144, s36, v144
    s_mov_b32 s45, 32768
    v_lshlrev_b32 v147, 4, v1
    s_lshl_b32 s36, s6, 13
    v_add_u32 v147, s36, v147
    v_xor_b32 v148, 16384, v147
    v_add_u32 v147, 98304, v147
    v_add_u32 v148, 98304, v148
    v_lshlrev_b32 v16, 16, v216
    v_and_b32 v17, 0xffff0000, v216
    v_lshlrev_b32 v18, 16, v217
    v_and_b32 v19, 0xffff0000, v217
    v_lshlrev_b32 v20, 16, v224
    v_and_b32 v21, 0xffff0000, v224
    v_lshlrev_b32 v22, 16, v225
    v_and_b32 v23, 0xffff0000, v225
    v_mov_b32 v24, 0
    v_mov_b32 v25, 0
    v_mov_b32 v26, 0
    v_mov_b32 v27, 0
    v_mov_b32 v28, 0
    v_mov_b32 v29, 0
    v_mov_b32 v30, 0
    v_mov_b32 v31, 0
    v_lshlrev_b32 v32, 16, v218
    v_and_b32 v33, 0xffff0000, v218
    v_lshlrev_b32 v34, 16, v219
    v_and_b32 v35, 0xffff0000, v219
    v_lshlrev_b32 v36, 16, v226
    v_and_b32 v37, 0xffff0000, v226
    v_lshlrev_b32 v38, 16, v227
    v_and_b32 v39, 0xffff0000, v227
    v_mov_b32 v40, 0
    v_mov_b32 v41, 0
    v_mov_b32 v42, 0
    v_mov_b32 v43, 0
    v_mov_b32 v44, 0
    v_mov_b32 v45, 0
    v_mov_b32 v46, 0
    v_mov_b32 v47, 0
    v_lshlrev_b32 v48, 16, v220
    v_and_b32 v49, 0xffff0000, v220
    v_lshlrev_b32 v50, 16, v221
    v_and_b32 v51, 0xffff0000, v221
    v_lshlrev_b32 v52, 16, v228
    v_and_b32 v53, 0xffff0000, v228
    v_lshlrev_b32 v54, 16, v229
    v_and_b32 v55, 0xffff0000, v229
    v_mov_b32 v56, 0
    v_mov_b32 v57, 0
    v_mov_b32 v58, 0
    v_mov_b32 v59, 0
    v_mov_b32 v60, 0
    v_mov_b32 v61, 0
    v_mov_b32 v62, 0
    v_mov_b32 v63, 0
    v_lshlrev_b32 v64, 16, v222
    v_and_b32 v65, 0xffff0000, v222
    v_lshlrev_b32 v66, 16, v223
    v_and_b32 v67, 0xffff0000, v223
    v_lshlrev_b32 v68, 16, v230
    v_and_b32 v69, 0xffff0000, v230
    v_lshlrev_b32 v70, 16, v231
    v_and_b32 v71, 0xffff0000, v231
    v_mov_b32 v72, 0
    v_mov_b32 v73, 0
    v_mov_b32 v74, 0
    v_mov_b32 v75, 0
    v_mov_b32 v76, 0
    v_mov_b32 v77, 0
    v_mov_b32 v78, 0
    v_mov_b32 v79, 0
    s_mov_b32 s42, 1
    s_mov_b32 s46, 4294868992
    s_mov_b32 s47, 49152
    s_mov_b32 s43, 8
    s_waitcnt lgkmcnt(0)
    s_barrier
    ds_read_b128 v[80:83], v4 offset:0
    ds_read_b128 v[84:87], v4 offset:4096
    ds_read_b128 v[88:91], v5 offset:0
    ds_read_b128 v[92:95], v5 offset:4096
    ds_read_b64_tr_b16 v[112:113], v9 offset:0
    ds_read_b64_tr_b16 v[114:115], v9 offset:512
    ds_read_b64_tr_b16 v[116:117], v10 offset:0
    ds_read_b64_tr_b16 v[118:119], v10 offset:512
    ds_read_b64_tr_b16 v[120:121], v11 offset:0
    ds_read_b64_tr_b16 v[122:123], v11 offset:512
    s_waitcnt lgkmcnt(4)
    v_mfma_f32_16x16x32_bf16 v[24:27], v[112:115], v[88:91], v[24:27]
    ds_read_b64_tr_b16 v[124:125], v12 offset:0
    ds_read_b64_tr_b16 v[126:127], v12 offset:512
    v_mfma_f32_16x16x32_bf16 v[28:31], v[112:115], v[92:95], v[28:31]
    ds_read_b128 v[96:99], v4 offset:1024
    ds_read_b128 v[100:103], v4 offset:5120
    v_mfma_f32_16x16x32_bf16 v[16:19], v[112:115], v[80:83], v[16:19]
    ds_read_b128 v[104:107], v5 offset:1024
    ds_read_b128 v[108:111], v5 offset:5120
    v_mfma_f32_16x16x32_bf16 v[20:23], v[112:115], v[84:87], v[20:23]
    ds_read_b64_tr_b16 v[128:129], v9 offset:4096
    ds_read_b64_tr_b16 v[130:131], v9 offset:4608
    s_waitcnt lgkmcnt(10)
    v_mfma_f32_16x16x32_bf16 v[36:39], v[116:119], v[84:87], v[36:39]
    ds_read_b64_tr_b16 v[132:133], v10 offset:4096
    ds_read_b64_tr_b16 v[134:135], v10 offset:4608
    v_mfma_f32_16x16x32_bf16 v[32:35], v[116:119], v[80:83], v[32:35]
    ds_read_b64_tr_b16 v[136:137], v11 offset:4096
    ds_read_b64_tr_b16 v[138:139], v11 offset:4608
    v_mfma_f32_16x16x32_bf16 v[44:47], v[116:119], v[92:95], v[44:47]
    s_waitcnt lgkmcnt(8)
    ds_read_b64_tr_b16 v[140:141], v12 offset:4096
    ds_read_b64_tr_b16 v[142:143], v12 offset:4608
    v_mfma_f32_16x16x32_bf16 v[40:43], v[116:119], v[88:91], v[40:43]
    s_cmp_eq_u32 s42, 2
    s_cselect_b32 s44, s46, s47
    s_waitcnt lgkmcnt(14)
    v_mfma_f32_16x16x32_bf16 v[56:59], v[120:123], v[88:91], v[56:59]
    v_add_u32 v4, s44, v4
    v_add_u32 v5, s44, v5
    v_mfma_f32_16x16x32_bf16 v[60:63], v[120:123], v[92:95], v[60:63]
    v_add_u32 v9, s44, v9
    v_add_u32 v10, s44, v10
    v_mfma_f32_16x16x32_bf16 v[48:51], v[120:123], v[80:83], v[48:51]
    v_add_u32 v11, s44, v11
    v_add_u32 v12, s44, v12
    v_mfma_f32_16x16x32_bf16 v[52:55], v[120:123], v[84:87], v[52:55]
    s_waitcnt lgkmcnt(12)
    v_mfma_f32_16x16x32_bf16 v[68:71], v[124:127], v[84:87], v[68:71]
    v_mfma_f32_16x16x32_bf16 v[64:67], v[124:127], v[80:83], v[64:67]
    v_mfma_f32_16x16x32_bf16 v[76:79], v[124:127], v[92:95], v[76:79]
    v_mfma_f32_16x16x32_bf16 v[72:75], v[124:127], v[88:91], v[72:75]
    s_branch P2_h1
P2_loop:
    s_waitcnt lgkmcnt(0)
    v_mfma_f32_16x16x32_bf16 v[24:27], v[112:115], v[88:91], v[24:27]
    ds_read_b128 v[96:99], v4 offset:1024
    ds_read_b128 v[100:103], v4 offset:5120
    v_mfma_f32_16x16x32_bf16 v[28:31], v[112:115], v[92:95], v[28:31]
    ds_read_b128 v[104:107], v5 offset:1024
    ds_read_b128 v[108:111], v5 offset:5120
    v_mfma_f32_16x16x32_bf16 v[16:19], v[112:115], v[80:83], v[16:19]
    ds_read_b64_tr_b16 v[128:129], v9 offset:4096
    ds_read_b64_tr_b16 v[130:131], v9 offset:4608
    v_mfma_f32_16x16x32_bf16 v[20:23], v[112:115], v[84:87], v[20:23]
    ds_read_b64_tr_b16 v[132:133], v10 offset:4096
    ds_read_b64_tr_b16 v[134:135], v10 offset:4608
    v_mfma_f32_16x16x32_bf16 v[36:39], v[116:119], v[84:87], v[36:39]
    ds_read_b64_tr_b16 v[136:137], v11 offset:4096
    v_mfma_f32_16x16x32_bf16 v[32:35], v[116:119], v[80:83], v[32:35]
    ds_read_b64_tr_b16 v[138:139], v11 offset:4608
    v_mfma_f32_16x16x32_bf16 v[44:47], v[116:119], v[92:95], v[44:47]
    ds_read_b64_tr_b16 v[140:141], v12 offset:4096
    v_mfma_f32_16x16x32_bf16 v[40:43], v[116:119], v[88:91], v[40:43]
    ds_read_b64_tr_b16 v[142:143], v12 offset:4608
    v_mfma_f32_16x16x32_bf16 v[56:59], v[120:123], v[88:91], v[56:59]
    s_cmp_eq_u32 s42, 2
    v_mfma_f32_16x16x32_bf16 v[60:63], v[120:123], v[92:95], v[60:63]
    s_cselect_b32 s44, s46, s47
    v_mfma_f32_16x16x32_bf16 v[48:51], v[120:123], v[80:83], v[48:51]
    v_add_u32 v4, s44, v4
    v_mfma_f32_16x16x32_bf16 v[52:55], v[120:123], v[84:87], v[52:55]
    v_add_u32 v5, s44, v5
    v_mfma_f32_16x16x32_bf16 v[68:71], v[124:127], v[84:87], v[68:71]
    v_add_u32 v9, s44, v9
    v_mfma_f32_16x16x32_bf16 v[64:67], v[124:127], v[80:83], v[64:67]
    v_add_u32 v10, s44, v10
    v_mfma_f32_16x16x32_bf16 v[76:79], v[124:127], v[92:95], v[76:79]
    v_add_u32 v11, s44, v11
    v_mfma_f32_16x16x32_bf16 v[72:75], v[124:127], v[88:91], v[72:75]
    v_add_u32 v12, s44, v12
P2_h1:
    s_waitcnt lgkmcnt(0)
    v_mfma_f32_16x16x32_bf16 v[24:27], v[128:131], v[104:107], v[24:27]
    s_barrier
    v_mfma_f32_16x16x32_bf16 v[28:31], v[128:131], v[108:111], v[28:31]
    ds_read_b128 v[80:83], v4 offset:0
    ds_read_b128 v[84:87], v4 offset:4096
    v_mfma_f32_16x16x32_bf16 v[16:19], v[128:131], v[96:99], v[16:19]
    ds_read_b128 v[88:91], v5 offset:0
    v_mfma_f32_16x16x32_bf16 v[20:23], v[128:131], v[100:103], v[20:23]
    ds_read_b128 v[92:95], v5 offset:4096
    v_mfma_f32_16x16x32_bf16 v[36:39], v[132:135], v[100:103], v[36:39]
    ds_read_b64_tr_b16 v[112:113], v9 offset:0
    v_mfma_f32_16x16x32_bf16 v[32:35], v[132:135], v[96:99], v[32:35]
    ds_read_b64_tr_b16 v[114:115], v9 offset:512
    v_mfma_f32_16x16x32_bf16 v[44:47], v[132:135], v[108:111], v[44:47]
    ds_read_b64_tr_b16 v[116:117], v10 offset:0
    v_mfma_f32_16x16x32_bf16 v[40:43], v[132:135], v[104:107], v[40:43]
    ds_read_b64_tr_b16 v[118:119], v10 offset:512
    v_mfma_f32_16x16x32_bf16 v[56:59], v[136:139], v[104:107], v[56:59]
    ds_read_b64_tr_b16 v[120:121], v11 offset:0
    v_mfma_f32_16x16x32_bf16 v[60:63], v[136:139], v[108:111], v[60:63]
    ds_read_b64_tr_b16 v[122:123], v11 offset:512
    v_mfma_f32_16x16x32_bf16 v[48:51], v[136:139], v[96:99], v[48:51]
    ds_read_b64_tr_b16 v[124:125], v12 offset:0
    v_mfma_f32_16x16x32_bf16 v[52:55], v[136:139], v[100:103], v[52:55]
    ds_read_b64_tr_b16 v[126:127], v12 offset:512
    v_mfma_f32_16x16x32_bf16 v[68:71], v[140:143], v[100:103], v[68:71]
    s_add_u32 s42, s42, 1
    v_mfma_f32_16x16x32_bf16 v[64:67], v[140:143], v[96:99], v[64:67]
    s_cmp_eq_u32 s42, 3
    v_mfma_f32_16x16x32_bf16 v[76:79], v[140:143], v[108:111], v[76:79]
    s_cselect_b32 s42, 0, s42
    v_mfma_f32_16x16x32_bf16 v[72:75], v[140:143], v[104:107], v[72:75]
    s_sub_u32 s43, s43, 1
    s_waitcnt lgkmcnt(0)
    v_mfma_f32_16x16x32_bf16 v[24:27], v[112:115], v[88:91], v[24:27]
    ds_read_b128 v[96:99], v4 offset:1024
    ds_read_b128 v[100:103], v4 offset:5120
    v_mfma_f32_16x16x32_bf16 v[28:31], v[112:115], v[92:95], v[28:31]
    ds_read_b128 v[104:107], v5 offset:1024
    ds_read_b128 v[108:111], v5 offset:5120
    v_mfma_f32_16x16x32_bf16 v[16:19], v[112:115], v[80:83], v[16:19]
    ds_read_b64_tr_b16 v[128:129], v9 offset:4096
    ds_read_b64_tr_b16 v[130:131], v9 offset:4608
    v_mfma_f32_16x16x32_bf16 v[20:23], v[112:115], v[84:87], v[20:23]
    ds_read_b64_tr_b16 v[132:133], v10 offset:4096
    ds_read_b64_tr_b16 v[134:135], v10 offset:4608
    v_mfma_f32_16x16x32_bf16 v[36:39], v[116:119], v[84:87], v[36:39]
    ds_read_b64_tr_b16 v[136:137], v11 offset:4096
    v_mfma_f32_16x16x32_bf16 v[32:35], v[116:119], v[80:83], v[32:35]
    ds_read_b64_tr_b16 v[138:139], v11 offset:4608
    v_mfma_f32_16x16x32_bf16 v[44:47], v[116:119], v[92:95], v[44:47]
    ds_read_b64_tr_b16 v[140:141], v12 offset:4096
    v_mfma_f32_16x16x32_bf16 v[40:43], v[116:119], v[88:91], v[40:43]
    ds_read_b64_tr_b16 v[142:143], v12 offset:4608
    v_mfma_f32_16x16x32_bf16 v[56:59], v[120:123], v[88:91], v[56:59]
    s_cmp_eq_u32 s42, 2
    v_mfma_f32_16x16x32_bf16 v[60:63], v[120:123], v[92:95], v[60:63]
    s_cselect_b32 s44, s46, s47
    v_mfma_f32_16x16x32_bf16 v[48:51], v[120:123], v[80:83], v[48:51]
    v_add_u32 v4, s44, v4
    v_mfma_f32_16x16x32_bf16 v[52:55], v[120:123], v[84:87], v[52:55]
    v_add_u32 v5, s44, v5
    v_mfma_f32_16x16x32_bf16 v[68:71], v[124:127], v[84:87], v[68:71]
    v_add_u32 v9, s44, v9
    v_mfma_f32_16x16x32_bf16 v[64:67], v[124:127], v[80:83], v[64:67]
    v_add_u32 v10, s44, v10
    v_mfma_f32_16x16x32_bf16 v[76:79], v[124:127], v[92:95], v[76:79]
    v_add_u32 v11, s44, v11
    v_mfma_f32_16x16x32_bf16 v[72:75], v[124:127], v[88:91], v[72:75]
    v_add_u32 v12, s44, v12
    s_waitcnt lgkmcnt(0)
    v_mfma_f32_16x16x32_bf16 v[24:27], v[128:131], v[104:107], v[24:27]
    s_barrier
    v_mfma_f32_16x16x32_bf16 v[28:31], v[128:131], v[108:111], v[28:31]
    ds_read_b128 v[80:83], v4 offset:0
    ds_read_b128 v[84:87], v4 offset:4096
    v_mfma_f32_16x16x32_bf16 v[16:19], v[128:131], v[96:99], v[16:19]
    ds_read_b128 v[88:91], v5 offset:0
    ds_read_b128 v[92:95], v5 offset:4096
    v_mfma_f32_16x16x32_bf16 v[20:23], v[128:131], v[100:103], v[20:23]
    ds_read_b64_tr_b16 v[112:113], v9 offset:0
    v_mfma_f32_16x16x32_bf16 v[36:39], v[132:135], v[100:103], v[36:39]
    ds_read_b64_tr_b16 v[114:115], v9 offset:512
    v_mfma_f32_16x16x32_bf16 v[32:35], v[132:135], v[96:99], v[32:35]
    ds_read_b64_tr_b16 v[116:117], v10 offset:0
    v_mfma_f32_16x16x32_bf16 v[44:47], v[132:135], v[108:111], v[44:47]
    ds_read_b64_tr_b16 v[118:119], v10 offset:512
    v_mfma_f32_16x16x32_bf16 v[40:43], v[132:135], v[104:107], v[40:43]
    ds_read_b64_tr_b16 v[120:121], v11 offset:0
    v_mfma_f32_16x16x32_bf16 v[56:59], v[136:139], v[104:107], v[56:59]
    ds_read_b64_tr_b16 v[122:123], v11 offset:512
    v_mfma_f32_16x16x32_bf16 v[60:63], v[136:139], v[108:111], v[60:63]
    ds_read_b64_tr_b16 v[124:125], v12 offset:0
    v_mfma_f32_16x16x32_bf16 v[48:51], v[136:139], v[96:99], v[48:51]
    ds_read_b64_tr_b16 v[126:127], v12 offset:512
    v_mfma_f32_16x16x32_bf16 v[52:55], v[136:139], v[100:103], v[52:55]
    s_add_u32 s42, s42, 1
    v_mfma_f32_16x16x32_bf16 v[68:71], v[140:143], v[100:103], v[68:71]
    s_cmp_eq_u32 s42, 3
    v_mfma_f32_16x16x32_bf16 v[64:67], v[140:143], v[96:99], v[64:67]
    s_cselect_b32 s42, 0, s42
    v_mfma_f32_16x16x32_bf16 v[76:79], v[140:143], v[108:111], v[76:79]
    s_sub_u32 s43, s43, 1
    v_mfma_f32_16x16x32_bf16 v[72:75], v[140:143], v[104:107], v[72:75]
    s_cmp_lg_u32 s43, 0
    s_cbranch_scc1 P2_loop
CT_e2:
    s_waitcnt lgkmcnt(0)
    ds_write_b128 v147, v[24:27] offset:0
    ds_write_b128 v147, v[28:31] offset:1024
    ds_write_b128 v147, v[40:43] offset:2048
    ds_write_b128 v147, v[44:47] offset:3072
    ds_write_b128 v147, v[56:59] offset:4096
    ds_write_b128 v147, v[60:63] offset:5120
    ds_write_b128 v147, v[72:75] offset:6144
    ds_write_b128 v147, v[76:79] offset:7168
    s_lshl_b32 s3, s6, 2
    s_add_u32 s3, s3, 147456
    v_mov_b32 v149, s3
    v_mov_b32 v150, 2
    s_waitcnt lgkmcnt(0)
    ds_write_b32 v149, v150
    v_xor_b32 v149, 8, v149
P2_ps:
    ds_read_b32 v150, v149
    s_waitcnt lgkmcnt(0)
    v_readfirstlane_b32 s3, v150
    s_nop 0
    s_cmp_lg_u32 s3, 2
    s_cbranch_scc1 P2_ps
    ds_read_b128 v[80:83], v148 offset:0
    ds_read_b128 v[88:91], v148 offset:2048
    ds_read_b128 v[96:99], v148 offset:4096
    ds_read_b128 v[104:107], v148 offset:6144
    ds_read_b128 v[84:87], v148 offset:1024
    ds_read_b128 v[92:95], v148 offset:3072
    ds_read_b128 v[100:103], v148 offset:5120
    ds_read_b128 v[108:111], v148 offset:7168
    s_waitcnt lgkmcnt(7)
    v_pk_add_f32 v[16:17], v[16:17], v[80:81]
    v_pk_add_f32 v[18:19], v[18:19], v[82:83]
    v_cvt_pk_bf16_f32 v112, v16, v17
    v_cvt_pk_bf16_f32 v113, v18, v19
    s_waitcnt lgkmcnt(6)
    v_pk_add_f32 v[32:33], v[32:33], v[88:89]
    v_pk_add_f32 v[34:35], v[34:35], v[90:91]
    v_cvt_pk_bf16_f32 v114, v32, v33
    v_cvt_pk_bf16_f32 v115, v34, v35
    s_nop 0
    v_permlane16_swap_b32 v112, v114
    v_permlane16_swap_b32 v113, v115
    buffer_store_dwordx4 v[112:115], v144, s[16:19], 0 offen offset:0 sc1
    s_waitcnt lgkmcnt(5)
    v_pk_add_f32 v[48:49], v[48:49], v[96:97]
    v_pk_add_f32 v[50:51], v[50:51], v[98:99]
    v_cvt_pk_bf16_f32 v116, v48, v49
    v_cvt_pk_bf16_f32 v117, v50, v51
    s_waitcnt lgkmcnt(4)
    v_pk_add_f32 v[64:65], v[64:65], v[104:105]
    v_pk_add_f32 v[66:67], v[66:67], v[106:107]
    v_cvt_pk_bf16_f32 v118, v64, v65
    v_cvt_pk_bf16_f32 v119, v66, v67
    s_nop 0
    v_permlane16_swap_b32 v116, v118
    v_permlane16_swap_b32 v117, v119
    buffer_store_dwordx4 v[116:119], v144, s[16:19], 0 offen offset:1024 sc1
    s_waitcnt lgkmcnt(3)
    v_pk_add_f32 v[20:21], v[20:21], v[84:85]
    v_pk_add_f32 v[22:23], v[22:23], v[86:87]
    v_cvt_pk_bf16_f32 v120, v20, v21
    v_cvt_pk_bf16_f32 v121, v22, v23
    s_waitcnt lgkmcnt(2)
    v_pk_add_f32 v[36:37], v[36:37], v[92:93]
    v_pk_add_f32 v[38:39], v[38:39], v[94:95]
    v_cvt_pk_bf16_f32 v122, v36, v37
    v_cvt_pk_bf16_f32 v123, v38, v39
    s_nop 0
    v_permlane16_swap_b32 v120, v122
    v_permlane16_swap_b32 v121, v123
    buffer_store_dwordx4 v[120:123], v144, s[16:19], s45 offen offset:0 sc1
    s_waitcnt lgkmcnt(1)
    v_pk_add_f32 v[52:53], v[52:53], v[100:101]
    v_pk_add_f32 v[54:55], v[54:55], v[102:103]
    v_cvt_pk_bf16_f32 v124, v52, v53
    v_cvt_pk_bf16_f32 v125, v54, v55
    s_waitcnt lgkmcnt(0)
    v_pk_add_f32 v[68:69], v[68:69], v[108:109]
    v_pk_add_f32 v[70:71], v[70:71], v[110:111]
    v_cvt_pk_bf16_f32 v126, v68, v69
    v_cvt_pk_bf16_f32 v127, v70, v71
    s_nop 0
    v_permlane16_swap_b32 v124, v126
    v_permlane16_swap_b32 v125, v127
    buffer_store_dwordx4 v[124:127], v144, s[16:19], s45 offen offset:1024 sc1
    v_pk_add_f32 v[88:89], v[16:17], v[18:19]
    v_pk_mul_f32 v[92:93], v[16:17], v[16:17]
    v_pk_add_f32 v[90:91], v[20:21], v[22:23]
    v_pk_mul_f32 v[94:95], v[20:21], v[20:21]
    v_pk_fma_f32 v[92:93], v[18:19], v[18:19], v[92:93]
    v_pk_fma_f32 v[94:95], v[22:23], v[22:23], v[94:95]
    v_pk_add_f32 v[88:89], v[88:89], v[32:33]
    v_pk_fma_f32 v[92:93], v[32:33], v[32:33], v[92:93]
    v_pk_add_f32 v[90:91], v[90:91], v[36:37]
    v_pk_fma_f32 v[94:95], v[36:37], v[36:37], v[94:95]
    v_pk_add_f32 v[88:89], v[88:89], v[34:35]
    v_pk_fma_f32 v[92:93], v[34:35], v[34:35], v[92:93]
    v_pk_add_f32 v[90:91], v[90:91], v[38:39]
    v_pk_fma_f32 v[94:95], v[38:39], v[38:39], v[94:95]
    v_pk_add_f32 v[88:89], v[88:89], v[48:49]
    v_pk_fma_f32 v[92:93], v[48:49], v[48:49], v[92:93]
    v_pk_add_f32 v[90:91], v[90:91], v[52:53]
    v_pk_fma_f32 v[94:95], v[52:53], v[52:53], v[94:95]
    v_pk_add_f32 v[88:89], v[88:89], v[50:51]
    v_pk_fma_f32 v[92:93], v[50:51], v[50:51], v[92:93]
    v_pk_add_f32 v[90:91], v[90:91], v[54:55]
    v_pk_fma_f32 v[94:95], v[54:55], v[54:55], v[94:95]
    v_pk_add_f32 v[88:89], v[88:89], v[64:65]
    v_pk_fma_f32 v[92:93], v[64:65], v[64:65], v[92:93]
    v_pk_add_f32 v[90:91], v[90:91], v[68:69]
    v_pk_fma_f32 v[94:95], v[68:69], v[68:69], v[94:95]
    v_pk_add_f32 v[88:89], v[88:89], v[66:67]
    v_pk_fma_f32 v[92:93], v[66:67], v[66:67], v[92:93]
    v_pk_add_f32 v[90:91], v[90:91], v[70:71]
    v_pk_fma_f32 v[94:95], v[70:71], v[70:71], v[94:95]
    v_add_f32 v80, v88, v89
    v_add_f32 v81, v92, v93
    v_add_f32 v82, v90, v91
    v_add_f32 v83, v94, v95
    v_mov_b32 v84, v80
    v_mov_b32 v85, v81
    v_mov_b32 v86, v82
    v_mov_b32 v87, v83
    v_permlane16_swap_b32 v80, v84
    v_permlane16_swap_b32 v81, v85
    v_permlane16_swap_b32 v82, v86
    v_permlane16_swap_b32 v83, v87
    v_add_f32 v80, v80, v84
    v_add_f32 v81, v81, v85
    v_add_f32 v82, v82, v86
    v_add_f32 v83, v83, v87
    v_mov_b32 v84, v80
    v_mov_b32 v85, v81
    v_mov_b32 v86, v82
    v_mov_b32 v87, v83
    v_permlane32_swap_b32 v80, v84
    v_permlane32_swap_b32 v81, v85
    v_permlane32_swap_b32 v82, v86
    v_permlane32_swap_b32 v83, v87
    v_add_f32 v80, v80, v84
    v_add_f32 v81, v81, v85
    v_add_f32 v82, v82, v86
    v_add_f32 v83, v83, v87
    s_lshl_b32 s36, s71, 14
    buffer_store_dwordx2 v[80:81], v146, s[24:27], s36 offen offset:0 sc1
    buffer_store_dwordx2 v[82:83], v146, s[24:27], s36 offen offset:128 sc1
    s_lshl_b32 s7, s70, 11
    s_lshl_b32 s3, s71, 7
    s_add_u32 s7, s7, s3
    s_add_u32 s7, s7, 31588352
    v_mov_b32 v96, 147472
    v_mov_b32 v97, 1
    v_mov_b32 v98, s74
    v_mov_b32 v99, s75
    s_mov_b64 exec, 1
    s_waitcnt vmcnt(0)
    ds_add_rtn_u32 v97, v96, v97
    v_mov_b32 v96, s7
    s_waitcnt lgkmcnt(0)
    v_readfirstlane_b32 s3, v97
    s_nop 0
    s_cmp_lg_u32 s3, 7
    s_cbranch_scc1 FIN2
    global_store_dwordx2 v96, v[98:99], s[68:69] sc1
FIN2:
    s_mov_b64 exec, -1
    s_add_u32 s16, s68, 12582912
    s_addc_u32 s17, s69, 0
    s_mov_b32 s18, 14680064
    s_mov_b32 s19, 0x20000
    s_mov_b32 s20, s62
    s_mov_b32 s21, s63
    s_mov_b32 s22, 2048
    s_mov_b32 s23, 0x20000
    s_and_b32 s34, s6, 1
    s_lshr_b32 s35, s6, 1
    s_lshl_b32 s36, s34, 13
    s_add_u32 s36, s36, 0
    v_lshlrev_b32 v204, 4, v1
    v_add_u32 v204, s36, v204
    v_lshrrev_b32 v116, 2, v2
    v_and_b32 v118, 1, v3
    v_lshl_or_b32 v118, v118, 2, v116
    v_lshl_add_u32 v116, v3, 3, v116
    v_lshlrev_b32 v117, 9, v116
    v_and_b32 v116, 3, v2
    v_lshl_add_u32 v117, v116, 3, v117
    v_add_u32 v117, 16384, v117
    s_and_b32 s36, s71, 1
    s_lshl_b32 s36, s36, 1
    s_add_u32 s37, s36, s35
    s_add_u32 s37, s37, 12
    s_mul_i32 s38, s35, 6
    s_add_u32 s36, s36, s38
    v_xor_b32 v116, s36, v118
    v_lshl_add_u32 v205, v116, 5, v117
    s_add_u32 s36, s36, 1
    v_xor_b32 v116, s36, v118
    v_lshl_add_u32 v206, v116, 5, v117
    s_add_u32 s36, s36, 1
    v_xor_b32 v116, s36, v118
    v_lshl_add_u32 v207, v116, 5, v117
    s_add_u32 s36, s36, 1
    v_xor_b32 v116, s36, v118
    v_lshl_add_u32 v208, v116, 5, v117
    s_add_u32 s36, s36, 1
    v_xor_b32 v116, s36, v118
    v_lshl_add_u32 v209, v116, 5, v117
    s_add_u32 s36, s36, 1
    v_xor_b32 v116, s36, v118
    v_lshl_add_u32 v210, v116, 5, v117
    v_xor_b32 v116, s37, v118
    v_lshl_add_u32 v211, v116, 5, v117
    s_lshl_b32 s36, s34, 9
    s_add_u32 s36, s36, 147712
    v_lshlrev_b32 v240, 3, v2
    v_add_u32 v240, s36, v240
    v_lshlrev_b32 v241, 4, v3
    s_lshl_b32 s36, s35, 6
    s_add_u32 s36, s36, 152576
    v_add_u32 v242, s36, v241
    s_mul_i32 s36, s35, 384
    s_add_u32 s36, s36, 151808
    v_add_u32 v241, s36, v241
    v_lshlrev_b32 v243, 3, v3
    s_lshl_b32 s82, s4, 8
    s_lshl_b32 s36, s35, 7
    s_add_u32 s82, s82, s36
    s_add_u32 s24, s68, 8388608
    s_addc_u32 s25, s69, 0
    s_mov_b32 s26, 4194304
    s_mov_b32 s27, 0x20000
    v_lshrrev_b32 v250, 1, v3
    v_lshlrev_b32 v250, 8, v250
    v_lshl_add_u32 v250, v2, 4, v250
    v_and_b32 v119, 1, v3
    v_lshl_add_u32 v250, v119, 3, v250
    s_lshl_b32 s36, s70, 3
    s_lshl_b32 s37, s34, 2
    s_add_u32 s36, s36, s37
    s_lshl_b32 s37, s5, 1
    s_add_u32 s36, s36, s37
    s_lshl_b32 s36, s36, 5
    s_lshl_b32 s37, s4, 2
    s_add_u32 s36, s36, s37
    s_lshl_b32 s37, s35, 1
    s_add_u32 s36, s36, s37
    s_lshl_b32 s83, s36, 10
    s_add_u32 s84, s83, 32768
    s_lshl_b32 s85, s70, 11
    s_lshl_b32 s36, s71, 7
    s_add_u32 s85, s85, s36
    s_add_u32 s85, s85, 31522816
    v_and_b32 v119, 1, v3
    v_lshlrev_b32 v244, 9, v119
    v_lshrrev_b32 v119, 1, v3
    v_lshl_add_u32 v244, v119, 8, v244
    v_lshl_add_u32 v244, v2, 4, v244
    s_lshl_b32 s36, s70, 3
    s_lshl_b32 s37, s34, 2
    s_add_u32 s36, s36, s37
    s_mul_i32 s36, s36, 112
    s_mul_i32 s37, s71, 7
    s_add_u32 s36, s36, s37
    s_lshl_b32 s36, s36, 10
    v_add_u32 v244, s36, v244
    s_mul_i32 s36, s35, 3072
    s_add_u32 s76, s36, 0
    s_add_u32 s77, s36, 114688
    s_add_u32 s78, s36, 229376
    s_add_u32 s79, s36, 344064
    s_mul_i32 s36, s35, 229376
    s_add_u32 s80, s36, 6144
    s_add_u32 s81, s80, 114688
    v_lshlrev_b32 v246, 4, v1
    s_lshl_b32 s36, s34, 12
    s_add_u32 s36, s36, 0
    v_add_u32 v246, s36, v246
    s_lshl_b32 s36, s35, 3
    v_add_u32 v247, s36, v246
    s_lshl_b32 s36, s35, 11
    v_add_u32 v246, s36, v246
    v_mov_b32 v248, 0xbdd2d3e8
    v_mov_b32 v249, 0xc0135761
    v_mov_b32 v4, 0
    v_mov_b32 v5, 0
    v_mov_b32 v6, 0
    v_mov_b32 v7, 0
    v_mov_b32 v8, 0
    v_mov_b32 v9, 0
    v_mov_b32 v10, 0
    v_mov_b32 v11, 0
    v_mov_b32 v12, 0
    v_mov_b32 v13, 0
    v_mov_b32 v14, 0
    v_mov_b32 v15, 0
    v_mov_b32 v16, 0
    v_mov_b32 v17, 0
    v_mov_b32 v18, 0
    v_mov_b32 v19, 0
    v_mov_b32 v20, 0
    v_mov_b32 v21, 0
    v_mov_b32 v22, 0
    v_mov_b32 v23, 0
    v_mov_b32 v24, 0
    v_mov_b32 v25, 0
    v_mov_b32 v26, 0
    v_mov_b32 v27, 0
    v_mov_b32 v28, 0
    v_mov_b32 v29, 0
    v_mov_b32 v30, 0
    v_mov_b32 v31, 0
    v_mov_b32 v32, 0
    v_mov_b32 v33, 0
    v_mov_b32 v34, 0
    v_mov_b32 v35, 0
    v_mov_b32 v36, 0
    v_mov_b32 v37, 0
    v_mov_b32 v38, 0
    v_mov_b32 v39, 0
    v_mov_b32 v40, 0
    v_mov_b32 v41, 0
    v_mov_b32 v42, 0
    v_mov_b32 v43, 0
    v_mov_b32 v44, 0
    v_mov_b32 v45, 0
    v_mov_b32 v46, 0
    v_mov_b32 v47, 0
    v_mov_b32 v48, 0
    v_mov_b32 v49, 0
    v_mov_b32 v50, 0
    v_mov_b32 v51, 0
    v_mov_b32 v52, 0
    v_mov_b32 v53, 0
    v_mov_b32 v54, 0
    v_mov_b32 v55, 0
    v_mov_b32 v56, 0
    v_mov_b32 v57, 0
    v_mov_b32 v58, 0
    v_mov_b32 v59, 0
    v_mov_b32 v60, 0
    v_mov_b32 v61, 0
    v_mov_b32 v62, 0
    v_mov_b32 v63, 0
    v_mov_b32 v64, 0
    v_mov_b32 v65, 0
    v_mov_b32 v66, 0
    v_mov_b32 v67, 0
    v_mov_b32 v68, 0
    v_mov_b32 v69, 0
    v_mov_b32 v70, 0
    v_mov_b32 v71, 0
    v_mov_b32 v72, 0
    v_mov_b32 v73, 0
    v_mov_b32 v74, 0
    v_mov_b32 v75, 0
    v_mov_b32 v76, 0
    v_mov_b32 v77, 0
    v_mov_b32 v78, 0
    v_mov_b32 v79, 0
    v_mov_b32 v80, 0
    v_mov_b32 v81, 0
    v_mov_b32 v82, 0
    v_mov_b32 v83, 0
    v_mov_b32 v84, 0
    v_mov_b32 v85, 0
    v_mov_b32 v86, 0
    v_mov_b32 v87, 0
    v_mov_b32 v88, 0
    v_mov_b32 v89, 0
    v_mov_b32 v90, 0
    v_mov_b32 v91, 0
    v_mov_b32 v92, 0
    v_mov_b32 v93, 0
    v_mov_b32 v94, 0
    v_mov_b32 v95, 0
    v_mov_b32 v96, 0
    v_mov_b32 v97, 0
    v_mov_b32 v98, 0
    v_mov_b32 v99, 0
    v_mov_b32 v100, 0
    v_mov_b32 v101, 0
    v_mov_b32 v102, 0
    v_mov_b32 v103, 0
    v_mov_b32 v104, 0
    v_mov_b32 v105, 0
    v_mov_b32 v106, 0
    v_mov_b32 v107, 0
    v_mov_b32 v108, 0
    v_mov_b32 v109, 0
    v_mov_b32 v110, 0
    v_mov_b32 v111, 0
    v_mov_b32 v112, 0
    v_mov_b32 v113, 0
    v_mov_b32 v114, 0
    v_mov_b32 v115, 0
    s_mov_b32 s42, 0
    s_mov_b32 s46, 4294868992
    s_mov_b32 s47, 49152
    s_mov_b32 s43, 16
    s_waitcnt lgkmcnt(0)
    s_barrier
    ds_read_b128 v[116:119], v204 offset:0
    ds_read_b128 v[120:123], v204 offset:2048
    ds_read_b128 v[124:127], v204 offset:4096
    ds_read_b128 v[128:131], v204 offset:6144
    ds_read_b64_tr_b16 v[148:149], v205 offset:0
    ds_read_b64_tr_b16 v[150:151], v205 offset:2048
    ds_read_b64_tr_b16 v[152:153], v206 offset:0
    ds_read_b64_tr_b16 v[154:155], v206 offset:2048
    ds_read_b64_tr_b16 v[156:157], v207 offset:0
    ds_read_b64_tr_b16 v[158:159], v207 offset:2048
    s_waitcnt lgkmcnt(4)
    v_mfma_f32_16x16x32_bf16 v[4:7], v[148:151], v[116:119], v[4:7]
    ds_read_b64_tr_b16 v[160:161], v208 offset:0
    ds_read_b64_tr_b16 v[162:163], v208 offset:2048
    v_mfma_f32_16x16x32_bf16 v[8:11], v[148:151], v[120:123], v[8:11]
    ds_read_b64_tr_b16 v[164:165], v209 offset:0
    ds_read_b64_tr_b16 v[166:167], v209 offset:2048
    v_mfma_f32_16x16x32_bf16 v[12:15], v[148:151], v[124:127], v[12:15]
    ds_read_b64_tr_b16 v[168:169], v210 offset:0
    ds_read_b64_tr_b16 v[170:171], v210 offset:2048
    v_mfma_f32_16x16x32_bf16 v[16:19], v[148:151], v[128:131], v[16:19]
    ds_read_b64_tr_b16 v[172:173], v211 offset:0
    ds_read_b64_tr_b16 v[174:175], v211 offset:2048
    s_waitcnt lgkmcnt(10)
    v_mfma_f32_16x16x32_bf16 v[32:35], v[152:155], v[128:131], v[32:35]
    ds_read_b128 v[132:135], v204 offset:1024
    ds_read_b128 v[136:139], v204 offset:3072
    v_mfma_f32_16x16x32_bf16 v[28:31], v[152:155], v[124:127], v[28:31]
    ds_read_b128 v[140:143], v204 offset:5120
    ds_read_b128 v[144:147], v204 offset:7168
    v_mfma_f32_16x16x32_bf16 v[24:27], v[152:155], v[120:123], v[24:27]
    s_waitcnt lgkmcnt(8)
    ds_read_b64_tr_b16 v[176:177], v205 offset:16384
    ds_read_b64_tr_b16 v[178:179], v205 offset:18432
    v_mfma_f32_16x16x32_bf16 v[20:23], v[152:155], v[116:119], v[20:23]
    ds_read_b64_tr_b16 v[180:181], v206 offset:16384
    ds_read_b64_tr_b16 v[182:183], v206 offset:18432
    s_waitcnt lgkmcnt(14)
    v_mfma_f32_16x16x32_bf16 v[36:39], v[156:159], v[116:119], v[36:39]
    ds_read_b64_tr_b16 v[184:185], v207 offset:16384
    ds_read_b64_tr_b16 v[186:187], v207 offset:18432
    v_mfma_f32_16x16x32_bf16 v[40:43], v[156:159], v[120:123], v[40:43]
    s_waitcnt lgkmcnt(8)
    ds_read_b64_tr_b16 v[188:189], v208 offset:16384
    ds_read_b64_tr_b16 v[190:191], v208 offset:18432
    v_mfma_f32_16x16x32_bf16 v[44:47], v[156:159], v[124:127], v[44:47]
    ds_read_b64_tr_b16 v[192:193], v209 offset:16384
    ds_read_b64_tr_b16 v[194:195], v209 offset:18432
    v_mfma_f32_16x16x32_bf16 v[48:51], v[156:159], v[128:131], v[48:51]
    ds_read_b64_tr_b16 v[196:197], v210 offset:16384
    ds_read_b64_tr_b16 v[198:199], v210 offset:18432
    s_waitcnt lgkmcnt(14)
    v_mfma_f32_16x16x32_bf16 v[64:67], v[160:163], v[128:131], v[64:67]
    s_waitcnt lgkmcnt(8)
    ds_read_b64_tr_b16 v[200:201], v211 offset:16384
    ds_read_b64_tr_b16 v[202:203], v211 offset:18432
    v_mfma_f32_16x16x32_bf16 v[60:63], v[160:163], v[124:127], v[60:63]
    s_cmp_eq_u32 s42, 2
    s_cselect_b32 s44, s46, s47
    v_mfma_f32_16x16x32_bf16 v[56:59], v[160:163], v[120:123], v[56:59]
    v_add_u32 v204, s44, v204
    v_add_u32 v205, s44, v205
    v_mfma_f32_16x16x32_bf16 v[52:55], v[160:163], v[116:119], v[52:55]
    v_add_u32 v206, s44, v206
    v_add_u32 v207, s44, v207
    s_waitcnt lgkmcnt(14)
    v_mfma_f32_16x16x32_bf16 v[68:71], v[164:167], v[116:119], v[68:71]
    v_add_u32 v208, s44, v208
    v_add_u32 v209, s44, v209
    v_mfma_f32_16x16x32_bf16 v[72:75], v[164:167], v[120:123], v[72:75]
    v_add_u32 v210, s44, v210
    v_add_u32 v211, s44, v211
    v_mfma_f32_16x16x32_bf16 v[76:79], v[164:167], v[124:127], v[76:79]
    v_mfma_f32_16x16x32_bf16 v[80:83], v[164:167], v[128:131], v[80:83]
    s_waitcnt lgkmcnt(14)
    v_mfma_f32_16x16x32_bf16 v[96:99], v[168:171], v[128:131], v[96:99]
    v_mfma_f32_16x16x32_bf16 v[92:95], v[168:171], v[124:127], v[92:95]
    v_mfma_f32_16x16x32_bf16 v[88:91], v[168:171], v[120:123], v[88:91]
    v_mfma_f32_16x16x32_bf16 v[84:87], v[168:171], v[116:119], v[84:87]
    s_waitcnt lgkmcnt(14)
    v_mfma_f32_16x16x32_bf16 v[100:103], v[172:175], v[116:119], v[100:103]
    v_mfma_f32_16x16x32_bf16 v[104:107], v[172:175], v[120:123], v[104:107]
    v_mfma_f32_16x16x32_bf16 v[108:111], v[172:175], v[124:127], v[108:111]
    v_mfma_f32_16x16x32_bf16 v[112:115], v[172:175], v[128:131], v[112:115]
    s_branch P3_h1
P3_loop:
    s_waitcnt lgkmcnt(0)
    v_mfma_f32_16x16x32_bf16 v[4:7], v[148:151], v[116:119], v[4:7]
    ds_read_b128 v[132:135], v204 offset:1024
    v_mfma_f32_16x16x32_bf16 v[8:11], v[148:151], v[120:123], v[8:11]
    ds_read_b128 v[136:139], v204 offset:3072
    v_mfma_f32_16x16x32_bf16 v[12:15], v[148:151], v[124:127], v[12:15]
    ds_read_b128 v[140:143], v204 offset:5120
    v_mfma_f32_16x16x32_bf16 v[16:19], v[148:151], v[128:131], v[16:19]
    ds_read_b128 v[144:147], v204 offset:7168
    v_mfma_f32_16x16x32_bf16 v[32:35], v[152:155], v[128:131], v[32:35]
    ds_read_b64_tr_b16 v[176:177], v205 offset:16384
    v_mfma_f32_16x16x32_bf16 v[28:31], v[152:155], v[124:127], v[28:31]
    ds_read_b64_tr_b16 v[178:179], v205 offset:18432
    v_mfma_f32_16x16x32_bf16 v[24:27], v[152:155], v[120:123], v[24:27]
    ds_read_b64_tr_b16 v[180:181], v206 offset:16384
    v_mfma_f32_16x16x32_bf16 v[20:23], v[152:155], v[116:119], v[20:23]
    ds_read_b64_tr_b16 v[182:183], v206 offset:18432
    v_mfma_f32_16x16x32_bf16 v[36:39], v[156:159], v[116:119], v[36:39]
    ds_read_b64_tr_b16 v[184:185], v207 offset:16384
    v_mfma_f32_16x16x32_bf16 v[40:43], v[156:159], v[120:123], v[40:43]
    ds_read_b64_tr_b16 v[186:187], v207 offset:18432
    v_mfma_f32_16x16x32_bf16 v[44:47], v[156:159], v[124:127], v[44:47]
    ds_read_b64_tr_b16 v[188:189], v208 offset:16384
    v_mfma_f32_16x16x32_bf16 v[48:51], v[156:159], v[128:131], v[48:51]
    ds_read_b64_tr_b16 v[190:191], v208 offset:18432
    v_mfma_f32_16x16x32_bf16 v[64:67], v[160:163], v[128:131], v[64:67]
    ds_read_b64_tr_b16 v[192:193], v209 offset:16384
    v_mfma_f32_16x16x32_bf16 v[60:63], v[160:163], v[124:127], v[60:63]
    ds_read_b64_tr_b16 v[194:195], v209 offset:18432
    v_mfma_f32_16x16x32_bf16 v[56:59], v[160:163], v[120:123], v[56:59]
    s_waitcnt lgkmcnt(8)
    ds_read_b64_tr_b16 v[196:197], v210 offset:16384
    v_mfma_f32_16x16x32_bf16 v[52:55], v[160:163], v[116:119], v[52:55]
    ds_read_b64_tr_b16 v[198:199], v210 offset:18432
    v_mfma_f32_16x16x32_bf16 v[68:71], v[164:167], v[116:119], v[68:71]
    ds_read_b64_tr_b16 v[200:201], v211 offset:16384
    v_mfma_f32_16x16x32_bf16 v[72:75], v[164:167], v[120:123], v[72:75]
    ds_read_b64_tr_b16 v[202:203], v211 offset:18432
    v_mfma_f32_16x16x32_bf16 v[76:79], v[164:167], v[124:127], v[76:79]
    s_cmp_eq_u32 s42, 2
    v_mfma_f32_16x16x32_bf16 v[80:83], v[164:167], v[128:131], v[80:83]
    s_cselect_b32 s44, s46, s47
    v_mfma_f32_16x16x32_bf16 v[96:99], v[168:171], v[128:131], v[96:99]
    v_add_u32 v204, s44, v204
    v_mfma_f32_16x16x32_bf16 v[92:95], v[168:171], v[124:127], v[92:95]
    v_add_u32 v205, s44, v205
    v_mfma_f32_16x16x32_bf16 v[88:91], v[168:171], v[120:123], v[88:91]
    v_add_u32 v206, s44, v206
    v_mfma_f32_16x16x32_bf16 v[84:87], v[168:171], v[116:119], v[84:87]
    v_add_u32 v207, s44, v207
    v_mfma_f32_16x16x32_bf16 v[100:103], v[172:175], v[116:119], v[100:103]
    v_add_u32 v208, s44, v208
    v_mfma_f32_16x16x32_bf16 v[104:107], v[172:175], v[120:123], v[104:107]
    v_add_u32 v209, s44, v209
    v_mfma_f32_16x16x32_bf16 v[108:111], v[172:175], v[124:127], v[108:111]
    v_add_u32 v210, s44, v210
    v_mfma_f32_16x16x32_bf16 v[112:115], v[172:175], v[128:131], v[112:115]
    v_add_u32 v211, s44, v211
P3_h1:
    s_waitcnt lgkmcnt(0)
    v_mfma_f32_16x16x32_bf16 v[4:7], v[176:179], v[132:135], v[4:7]
    s_barrier
    v_mfma_f32_16x16x32_bf16 v[8:11], v[176:179], v[136:139], v[8:11]
    ds_read_b128 v[116:119], v204 offset:0
    v_mfma_f32_16x16x32_bf16 v[12:15], v[176:179], v[140:143], v[12:15]
    ds_read_b128 v[120:123], v204 offset:2048
    v_mfma_f32_16x16x32_bf16 v[16:19], v[176:179], v[144:147], v[16:19]
    ds_read_b128 v[124:127], v204 offset:4096
    v_mfma_f32_16x16x32_bf16 v[32:35], v[180:183], v[144:147], v[32:35]
    ds_read_b128 v[128:131], v204 offset:6144
    v_mfma_f32_16x16x32_bf16 v[28:31], v[180:183], v[140:143], v[28:31]
    ds_read_b64_tr_b16 v[148:149], v205 offset:0
    v_mfma_f32_16x16x32_bf16 v[24:27], v[180:183], v[136:139], v[24:27]
    ds_read_b64_tr_b16 v[150:151], v205 offset:2048
    v_mfma_f32_16x16x32_bf16 v[20:23], v[180:183], v[132:135], v[20:23]
    ds_read_b64_tr_b16 v[152:153], v206 offset:0
    v_mfma_f32_16x16x32_bf16 v[36:39], v[184:187], v[132:135], v[36:39]
    ds_read_b64_tr_b16 v[154:155], v206 offset:2048
    v_mfma_f32_16x16x32_bf16 v[40:43], v[184:187], v[136:139], v[40:43]
    ds_read_b64_tr_b16 v[156:157], v207 offset:0
    v_mfma_f32_16x16x32_bf16 v[44:47], v[184:187], v[140:143], v[44:47]
    ds_read_b64_tr_b16 v[158:159], v207 offset:2048
    v_mfma_f32_16x16x32_bf16 v[48:51], v[184:187], v[144:147], v[48:51]
    ds_read_b64_tr_b16 v[160:161], v208 offset:0
    v_mfma_f32_16x16x32_bf16 v[64:67], v[188:191], v[144:147], v[64:67]
    ds_read_b64_tr_b16 v[162:163], v208 offset:2048
    v_mfma_f32_16x16x32_bf16 v[60:63], v[188:191], v[140:143], v[60:63]
    ds_read_b64_tr_b16 v[164:165], v209 offset:0
    v_mfma_f32_16x16x32_bf16 v[56:59], v[188:191], v[136:139], v[56:59]
    ds_read_b64_tr_b16 v[166:167], v209 offset:2048
    v_mfma_f32_16x16x32_bf16 v[52:55], v[188:191], v[132:135], v[52:55]
    s_waitcnt lgkmcnt(8)
    ds_read_b64_tr_b16 v[168:169], v210 offset:0
    v_mfma_f32_16x16x32_bf16 v[68:71], v[192:195], v[132:135], v[68:71]
    ds_read_b64_tr_b16 v[170:171], v210 offset:2048
    v_mfma_f32_16x16x32_bf16 v[72:75], v[192:195], v[136:139], v[72:75]
    ds_read_b64_tr_b16 v[172:173], v211 offset:0
    v_mfma_f32_16x16x32_bf16 v[76:79], v[192:195], v[140:143], v[76:79]
    ds_read_b64_tr_b16 v[174:175], v211 offset:2048
    v_mfma_f32_16x16x32_bf16 v[80:83], v[192:195], v[144:147], v[80:83]
    s_add_u32 s42, s42, 1
    v_mfma_f32_16x16x32_bf16 v[96:99], v[196:199], v[144:147], v[96:99]
    s_cmp_eq_u32 s42, 3
    v_mfma_f32_16x16x32_bf16 v[92:95], v[196:199], v[140:143], v[92:95]
    s_cselect_b32 s42, 0, s42
    v_mfma_f32_16x16x32_bf16 v[88:91], v[196:199], v[136:139], v[88:91]
    s_sub_u32 s43, s43, 1
    v_mfma_f32_16x16x32_bf16 v[84:87], v[196:199], v[132:135], v[84:87]
    v_mfma_f32_16x16x32_bf16 v[100:103], v[200:203], v[132:135], v[100:103]
    v_mfma_f32_16x16x32_bf16 v[104:107], v[200:203], v[136:139], v[104:107]
    v_mfma_f32_16x16x32_bf16 v[108:111], v[200:203], v[140:143], v[108:111]
    v_mfma_f32_16x16x32_bf16 v[112:115], v[200:203], v[144:147], v[112:115]
    s_waitcnt lgkmcnt(0)
    v_mfma_f32_16x16x32_bf16 v[4:7], v[148:151], v[116:119], v[4:7]
    ds_read_b128 v[132:135], v204 offset:1024
    v_mfma_f32_16x16x32_bf16 v[8:11], v[148:151], v[120:123], v[8:11]
    ds_read_b128 v[136:139], v204 offset:3072
    v_mfma_f32_16x16x32_bf16 v[12:15], v[148:151], v[124:127], v[12:15]
    ds_read_b128 v[140:143], v204 offset:5120
    v_mfma_f32_16x16x32_bf16 v[16:19], v[148:151], v[128:131], v[16:19]
    ds_read_b128 v[144:147], v204 offset:7168
    v_mfma_f32_16x16x32_bf16 v[32:35], v[152:155], v[128:131], v[32:35]
    ds_read_b64_tr_b16 v[176:177], v205 offset:16384
    v_mfma_f32_16x16x32_bf16 v[28:31], v[152:155], v[124:127], v[28:31]
    ds_read_b64_tr_b16 v[178:179], v205 offset:18432
    v_mfma_f32_16x16x32_bf16 v[24:27], v[152:155], v[120:123], v[24:27]
    ds_read_b64_tr_b16 v[180:181], v206 offset:16384
    v_mfma_f32_16x16x32_bf16 v[20:23], v[152:155], v[116:119], v[20:23]
    ds_read_b64_tr_b16 v[182:183], v206 offset:18432
    v_mfma_f32_16x16x32_bf16 v[36:39], v[156:159], v[116:119], v[36:39]
    ds_read_b64_tr_b16 v[184:185], v207 offset:16384
    v_mfma_f32_16x16x32_bf16 v[40:43], v[156:159], v[120:123], v[40:43]
    ds_read_b64_tr_b16 v[186:187], v207 offset:18432
    v_mfma_f32_16x16x32_bf16 v[44:47], v[156:159], v[124:127], v[44:47]
    ds_read_b64_tr_b16 v[188:189], v208 offset:16384
    v_mfma_f32_16x16x32_bf16 v[48:51], v[156:159], v[128:131], v[48:51]
    ds_read_b64_tr_b16 v[190:191], v208 offset:18432
    v_mfma_f32_16x16x32_bf16 v[64:67], v[160:163], v[128:131], v[64:67]
    ds_read_b64_tr_b16 v[192:193], v209 offset:16384
    v_mfma_f32_16x16x32_bf16 v[60:63], v[160:163], v[124:127], v[60:63]
    ds_read_b64_tr_b16 v[194:195], v209 offset:18432
    v_mfma_f32_16x16x32_bf16 v[56:59], v[160:163], v[120:123], v[56:59]
    s_waitcnt lgkmcnt(8)
    ds_read_b64_tr_b16 v[196:197], v210 offset:16384
    v_mfma_f32_16x16x32_bf16 v[52:55], v[160:163], v[116:119], v[52:55]
    ds_read_b64_tr_b16 v[198:199], v210 offset:18432
    v_mfma_f32_16x16x32_bf16 v[68:71], v[164:167], v[116:119], v[68:71]
    ds_read_b64_tr_b16 v[200:201], v211 offset:16384
    v_mfma_f32_16x16x32_bf16 v[72:75], v[164:167], v[120:123], v[72:75]
    ds_read_b64_tr_b16 v[202:203], v211 offset:18432
    v_mfma_f32_16x16x32_bf16 v[76:79], v[164:167], v[124:127], v[76:79]
    s_cmp_eq_u32 s42, 2
    v_mfma_f32_16x16x32_bf16 v[80:83], v[164:167], v[128:131], v[80:83]
    s_cselect_b32 s44, s46, s47
    v_mfma_f32_16x16x32_bf16 v[96:99], v[168:171], v[128:131], v[96:99]
    v_add_u32 v204, s44, v204
    v_mfma_f32_16x16x32_bf16 v[92:95], v[168:171], v[124:127], v[92:95]
    v_add_u32 v205, s44, v205
    v_mfma_f32_16x16x32_bf16 v[88:91], v[168:171], v[120:123], v[88:91]
    v_add_u32 v206, s44, v206
    v_mfma_f32_16x16x32_bf16 v[84:87], v[168:171], v[116:119], v[84:87]
    v_add_u32 v207, s44, v207
    v_mfma_f32_16x16x32_bf16 v[100:103], v[172:175], v[116:119], v[100:103]
    v_add_u32 v208, s44, v208
    v_mfma_f32_16x16x32_bf16 v[104:107], v[172:175], v[120:123], v[104:107]
    v_add_u32 v209, s44, v209
    v_mfma_f32_16x16x32_bf16 v[108:111], v[172:175], v[124:127], v[108:111]
    v_add_u32 v210, s44, v210
    v_mfma_f32_16x16x32_bf16 v[112:115], v[172:175], v[128:131], v[112:115]
    v_add_u32 v211, s44, v211
    s_waitcnt lgkmcnt(0)
    v_mfma_f32_16x16x32_bf16 v[4:7], v[176:179], v[132:135], v[4:7]
    s_barrier
    v_mfma_f32_16x16x32_bf16 v[8:11], v[176:179], v[136:139], v[8:11]
    ds_read_b128 v[116:119], v204 offset:0
    v_mfma_f32_16x16x32_bf16 v[12:15], v[176:179], v[140:143], v[12:15]
    ds_read_b128 v[120:123], v204 offset:2048
    v_mfma_f32_16x16x32_bf16 v[16:19], v[176:179], v[144:147], v[16:19]
    ds_read_b128 v[124:127], v204 offset:4096
    v_mfma_f32_16x16x32_bf16 v[32:35], v[180:183], v[144:147], v[32:35]
    ds_read_b128 v[128:131], v204 offset:6144
    v_mfma_f32_16x16x32_bf16 v[28:31], v[180:183], v[140:143], v[28:31]
    ds_read_b64_tr_b16 v[148:149], v205 offset:0
    v_mfma_f32_16x16x32_bf16 v[24:27], v[180:183], v[136:139], v[24:27]
    ds_read_b64_tr_b16 v[150:151], v205 offset:2048
    v_mfma_f32_16x16x32_bf16 v[20:23], v[180:183], v[132:135], v[20:23]
    ds_read_b64_tr_b16 v[152:153], v206 offset:0
    v_mfma_f32_16x16x32_bf16 v[36:39], v[184:187], v[132:135], v[36:39]
    ds_read_b64_tr_b16 v[154:155], v206 offset:2048
    v_mfma_f32_16x16x32_bf16 v[40:43], v[184:187], v[136:139], v[40:43]
    ds_read_b64_tr_b16 v[156:157], v207 offset:0
    v_mfma_f32_16x16x32_bf16 v[44:47], v[184:187], v[140:143], v[44:47]
    ds_read_b64_tr_b16 v[158:159], v207 offset:2048
    v_mfma_f32_16x16x32_bf16 v[48:51], v[184:187], v[144:147], v[48:51]
    ds_read_b64_tr_b16 v[160:161], v208 offset:0
    v_mfma_f32_16x16x32_bf16 v[64:67], v[188:191], v[144:147], v[64:67]
    ds_read_b64_tr_b16 v[162:163], v208 offset:2048
    v_mfma_f32_16x16x32_bf16 v[60:63], v[188:191], v[140:143], v[60:63]
    ds_read_b64_tr_b16 v[164:165], v209 offset:0
    v_mfma_f32_16x16x32_bf16 v[56:59], v[188:191], v[136:139], v[56:59]
    ds_read_b64_tr_b16 v[166:167], v209 offset:2048
    v_mfma_f32_16x16x32_bf16 v[52:55], v[188:191], v[132:135], v[52:55]
    s_waitcnt lgkmcnt(8)
    ds_read_b64_tr_b16 v[168:169], v210 offset:0
    v_mfma_f32_16x16x32_bf16 v[68:71], v[192:195], v[132:135], v[68:71]
    ds_read_b64_tr_b16 v[170:171], v210 offset:2048
    v_mfma_f32_16x16x32_bf16 v[72:75], v[192:195], v[136:139], v[72:75]
    ds_read_b64_tr_b16 v[172:173], v211 offset:0
    v_mfma_f32_16x16x32_bf16 v[76:79], v[192:195], v[140:143], v[76:79]
    ds_read_b64_tr_b16 v[174:175], v211 offset:2048
    v_mfma_f32_16x16x32_bf16 v[80:83], v[192:195], v[144:147], v[80:83]
    s_add_u32 s42, s42, 1
    v_mfma_f32_16x16x32_bf16 v[96:99], v[196:199], v[144:147], v[96:99]
    s_cmp_eq_u32 s42, 3
    v_mfma_f32_16x16x32_bf16 v[92:95], v[196:199], v[140:143], v[92:95]
    s_cselect_b32 s42, 0, s42
    v_mfma_f32_16x16x32_bf16 v[88:91], v[196:199], v[136:139], v[88:91]
    s_sub_u32 s43, s43, 1
    v_mfma_f32_16x16x32_bf16 v[84:87], v[196:199], v[132:135], v[84:87]
    s_cmp_lg_u32 s43, 0
    v_mfma_f32_16x16x32_bf16 v[100:103], v[200:203], v[132:135], v[100:103]
    v_mfma_f32_16x16x32_bf16 v[104:107], v[200:203], v[136:139], v[104:107]
    v_mfma_f32_16x16x32_bf16 v[108:111], v[200:203], v[140:143], v[108:111]
    v_mfma_f32_16x16x32_bf16 v[112:115], v[200:203], v[144:147], v[112:115]
    s_cbranch_scc1 P3_loop
CT_e3:
    s_waitcnt lgkmcnt(0)
    ds_read_b64 v[116:117], v240 offset:0
    ds_read_b64 v[118:119], v240 offset:128
    ds_read_b64 v[120:121], v240 offset:256
    ds_read_b64 v[122:123], v240 offset:384
    ds_read_b128 v[148:151], v241 offset:0
    ds_read_b128 v[176:179], v241 offset:1024
    ds_read_b128 v[152:155], v241 offset:64
    ds_read_b128 v[180:183], v241 offset:1088
    ds_read_b128 v[172:175], v242
    ds_read_b128 v[200:203], v242 offset:1024
    ds_read_b128 v[156:159], v241 offset:128
    ds_read_b128 v[184:187], v241 offset:1152
    ds_read_b128 v[160:163], v241 offset:192
    ds_read_b128 v[188:191], v241 offset:1216
    s_waitcnt lgkmcnt(8)
    ds_read_b128 v[164:167], v241 offset:256
    ds_read_b128 v[192:195], v241 offset:1280
    ds_read_b128 v[168:171], v241 offset:320
    ds_read_b128 v[196:199], v241 offset:1344
    buffer_load_dwordx2 v[232:233], v243, s[20:23], s82 offen offset:0
    buffer_load_dwordx2 v[234:235], v243, s[20:23], s82 offen offset:32
    buffer_load_dwordx2 v[236:237], v243, s[20:23], s82 offen offset:64
    buffer_load_dwordx2 v[238:239], v243, s[20:23], s82 offen offset:96
    buffer_load_dwordx2 v[216:217], v250, s[24:27], s83 offen offset:0 sc1
    buffer_load_dwordx2 v[218:219], v250, s[24:27], s83 offen offset:512 sc1
    buffer_load_dwordx2 v[220:221], v250, s[24:27], s83 offen offset:1024 sc1
    buffer_load_dwordx2 v[222:223], v250, s[24:27], s83 offen offset:1536 sc1
    buffer_load_dwordx2 v[224:225], v250, s[24:27], s84 offen offset:0 sc1
    buffer_load_dwordx2 v[226:227], v250, s[24:27], s84 offen offset:512 sc1
    buffer_load_dwordx2 v[228:229], v250, s[24:27], s84 offen offset:1024 sc1
    buffer_load_dwordx2 v[230:231], v250, s[24:27], s84 offen offset:1536 sc1
    s_waitcnt lgkmcnt(8)
    v_pk_fma_f32 v[132:133], v[148:149], v[116:117], v[176:177] op_sel:[0,1,0] op_sel_hi:[1,1,1]
    v_pk_fma_f32 v[134:135], v[150:151], v[116:117], v[178:179] op_sel:[0,1,0] op_sel_hi:[1,1,1]
    v_pk_fma_f32 v[136:137], v[152:153], v[116:117], v[180:181] op_sel:[0,1,0] op_sel_hi:[1,1,1]
    v_pk_fma_f32 v[138:139], v[154:155], v[116:117], v[182:183] op_sel:[0,1,0] op_sel_hi:[1,1,1]
    v_pk_fma_f32 v[4:5], v[4:5], v[116:117], v[132:133] op_sel:[0,0,0] op_sel_hi:[1,0,1]
    v_pk_fma_f32 v[6:7], v[6:7], v[116:117], v[134:135] op_sel:[0,0,0] op_sel_hi:[1,0,1]
    v_pk_fma_f32 v[20:21], v[20:21], v[116:117], v[136:137] op_sel:[0,0,0] op_sel_hi:[1,0,1]
    v_pk_fma_f32 v[22:23], v[22:23], v[116:117], v[138:139] op_sel:[0,0,0] op_sel_hi:[1,0,1]
    v_pk_mul_f32 v[132:133], v[4:5], v[4:5]
    v_pk_mul_f32 v[134:135], v[6:7], v[6:7]
    v_pk_mul_f32 v[136:137], v[20:21], v[20:21]
    v_pk_mul_f32 v[138:139], v[22:23], v[22:23]
    v_pk_fma_f32 v[132:133], v[132:133], v[248:249], v[248:249] op_sel:[0,0,1] op_sel_hi:[1,0,1]
    v_pk_fma_f32 v[134:135], v[134:135], v[248:249], v[248:249] op_sel:[0,0,1] op_sel_hi:[1,0,1]
    v_pk_fma_f32 v[136:137], v[136:137], v[248:249], v[248:249] op_sel:[0,0,1] op_sel_hi:[1,0,1]
    v_pk_fma_f32 v[138:139], v[138:139], v[248:249], v[248:249] op_sel:[0,0,1] op_sel_hi:[1,0,1]
    v_pk_mul_f32 v[132:133], v[132:133], v[4:5]
    v_pk_mul_f32 v[134:135], v[134:135], v[6:7]
    v_pk_mul_f32 v[136:137], v[136:137], v[20:21]
    v_pk_mul_f32 v[138:139], v[138:139], v[22:23]
    v_exp_f32 v132, v132
    v_exp_f32 v133, v133
    v_exp_f32 v134, v134
    v_exp_f32 v135, v135
    v_exp_f32 v136, v136
    v_exp_f32 v137, v137
    v_exp_f32 v138, v138
    v_exp_f32 v139, v139
    v_pk_add_f32 v[132:133], v[132:133], 1.0 op_sel_hi:[1,0]
    v_pk_add_f32 v[134:135], v[134:135], 1.0 op_sel_hi:[1,0]
    v_pk_add_f32 v[136:137], v[136:137], 1.0 op_sel_hi:[1,0]
    v_pk_add_f32 v[138:139], v[138:139], 1.0 op_sel_hi:[1,0]
    v_rcp_f32 v132, v132
    v_rcp_f32 v133, v133
    v_rcp_f32 v134, v134
    v_rcp_f32 v135, v135
    v_rcp_f32 v136, v136
    v_rcp_f32 v137, v137
    v_rcp_f32 v138, v138
    v_rcp_f32 v139, v139
    v_pk_mul_f32 v[4:5], v[4:5], v[132:133]
    v_pk_mul_f32 v[6:7], v[6:7], v[134:135]
    v_pk_mul_f32 v[20:21], v[20:21], v[136:137]
    v_pk_mul_f32 v[22:23], v[22:23], v[138:139]
    v_cvt_pk_bf16_f32 v128, v4, v5
    v_cvt_pk_bf16_f32 v129, v6, v7
    v_cvt_pk_bf16_f32 v130, v20, v21
    v_cvt_pk_bf16_f32 v131, v22, v23
    s_nop 0
    v_permlane16_swap_b32 v128, v130
    v_permlane16_swap_b32 v129, v131
    buffer_store_dwordx4 v[128:131], v244, s[16:19], s76 offen offset:0 sc1
    v_pk_fma_f32 v[132:133], v[148:149], v[118:119], v[176:177] op_sel:[0,1,0] op_sel_hi:[1,1,1]
    v_pk_fma_f32 v[134:135], v[150:151], v[118:119], v[178:179] op_sel:[0,1,0] op_sel_hi:[1,1,1]
    v_pk_fma_f32 v[136:137], v[152:153], v[118:119], v[180:181] op_sel:[0,1,0] op_sel_hi:[1,1,1]
    v_pk_fma_f32 v[138:139], v[154:155], v[118:119], v[182:183] op_sel:[0,1,0] op_sel_hi:[1,1,1]
    v_pk_fma_f32 v[8:9], v[8:9], v[118:119], v[132:133] op_sel:[0,0,0] op_sel_hi:[1,0,1]
    v_pk_fma_f32 v[10:11], v[10:11], v[118:119], v[134:135] op_sel:[0,0,0] op_sel_hi:[1,0,1]
    v_pk_fma_f32 v[24:25], v[24:25], v[118:119], v[136:137] op_sel:[0,0,0] op_sel_hi:[1,0,1]
    v_pk_fma_f32 v[26:27], v[26:27], v[118:119], v[138:139] op_sel:[0,0,0] op_sel_hi:[1,0,1]
    v_pk_mul_f32 v[132:133], v[8:9], v[8:9]
    v_pk_mul_f32 v[134:135], v[10:11], v[10:11]
    v_pk_mul_f32 v[136:137], v[24:25], v[24:25]
    v_pk_mul_f32 v[138:139], v[26:27], v[26:27]
    v_pk_fma_f32 v[132:133], v[132:133], v[248:249], v[248:249] op_sel:[0,0,1] op_sel_hi:[1,0,1]
    v_pk_fma_f32 v[134:135], v[134:135], v[248:249], v[248:249] op_sel:[0,0,1] op_sel_hi:[1,0,1]
    v_pk_fma_f32 v[136:137], v[136:137], v[248:249], v[248:249] op_sel:[0,0,1] op_sel_hi:[1,0,1]
    v_pk_fma_f32 v[138:139], v[138:139], v[248:249], v[248:249] op_sel:[0,0,1] op_sel_hi:[1,0,1]
    v_pk_mul_f32 v[132:133], v[132:133], v[8:9]
    v_pk_mul_f32 v[134:135], v[134:135], v[10:11]
    v_pk_mul_f32 v[136:137], v[136:137], v[24:25]
    v_pk_mul_f32 v[138:139], v[138:139], v[26:27]
    v_exp_f32 v132, v132
    v_exp_f32 v133, v133
    v_exp_f32 v134, v134
    v_exp_f32 v135, v135
    v_exp_f32 v136, v136
    v_exp_f32 v137, v137
    v_exp_f32 v138, v138
    v_exp_f32 v139, v139
    v_pk_add_f32 v[132:133], v[132:133], 1.0 op_sel_hi:[1,0]
    v_pk_add_f32 v[134:135], v[134:135], 1.0 op_sel_hi:[1,0]
    v_pk_add_f32 v[136:137], v[136:137], 1.0 op_sel_hi:[1,0]
    v_pk_add_f32 v[138:139], v[138:139], 1.0 op_sel_hi:[1,0]
    v_rcp_f32 v132, v132
    v_rcp_f32 v133, v133
    v_rcp_f32 v134, v134
    v_rcp_f32 v135, v135
    v_rcp_f32 v136, v136
    v_rcp_f32 v137, v137
    v_rcp_f32 v138, v138
    v_rcp_f32 v139, v139
    v_pk_mul_f32 v[8:9], v[8:9], v[132:133]
    v_pk_mul_f32 v[10:11], v[10:11], v[134:135]
    v_pk_mul_f32 v[24:25], v[24:25], v[136:137]
    v_pk_mul_f32 v[26:27], v[26:27], v[138:139]
    v_cvt_pk_bf16_f32 v144, v8, v9
    v_cvt_pk_bf16_f32 v145, v10, v11
    v_cvt_pk_bf16_f32 v146, v24, v25
    v_cvt_pk_bf16_f32 v147, v26, v27
    s_nop 0
    v_permlane16_swap_b32 v144, v146
    v_permlane16_swap_b32 v145, v147
    buffer_store_dwordx4 v[144:147], v244, s[16:19], s77 offen offset:0 sc1
    v_pk_fma_f32 v[132:133], v[148:149], v[120:121], v[176:177] op_sel:[0,1,0] op_sel_hi:[1,1,1]
    v_pk_fma_f32 v[134:135], v[150:151], v[120:121], v[178:179] op_sel:[0,1,0] op_sel_hi:[1,1,1]
    v_pk_fma_f32 v[136:137], v[152:153], v[120:121], v[180:181] op_sel:[0,1,0] op_sel_hi:[1,1,1]
    v_pk_fma_f32 v[138:139], v[154:155], v[120:121], v[182:183] op_sel:[0,1,0] op_sel_hi:[1,1,1]
    v_pk_fma_f32 v[12:13], v[12:13], v[120:121], v[132:133] op_sel:[0,0,0] op_sel_hi:[1,0,1]
    v_pk_fma_f32 v[14:15], v[14:15], v[120:121], v[134:135] op_sel:[0,0,0] op_sel_hi:[1,0,1]
    v_pk_fma_f32 v[28:29], v[28:29], v[120:121], v[136:137] op_sel:[0,0,0] op_sel_hi:[1,0,1]
    v_pk_fma_f32 v[30:31], v[30:31], v[120:121], v[138:139] op_sel:[0,0,0] op_sel_hi:[1,0,1]
    v_pk_mul_f32 v[132:133], v[12:13], v[12:13]
    v_pk_mul_f32 v[134:135], v[14:15], v[14:15]
    v_pk_mul_f32 v[136:137], v[28:29], v[28:29]
    v_pk_mul_f32 v[138:139], v[30:31], v[30:31]
    v_pk_fma_f32 v[132:133], v[132:133], v[248:249], v[248:249] op_sel:[0,0,1] op_sel_hi:[1,0,1]
    v_pk_fma_f32 v[134:135], v[134:135], v[248:249], v[248:249] op_sel:[0,0,1] op_sel_hi:[1,0,1]
    v_pk_fma_f32 v[136:137], v[136:137], v[248:249], v[248:249] op_sel:[0,0,1] op_sel_hi:[1,0,1]
    v_pk_fma_f32 v[138:139], v[138:139], v[248:249], v[248:249] op_sel:[0,0,1] op_sel_hi:[1,0,1]
    v_pk_mul_f32 v[132:133], v[132:133], v[12:13]
    v_pk_mul_f32 v[134:135], v[134:135], v[14:15]
    v_pk_mul_f32 v[136:137], v[136:137], v[28:29]
    v_pk_mul_f32 v[138:139], v[138:139], v[30:31]
    v_exp_f32 v132, v132
    v_exp_f32 v133, v133
    v_exp_f32 v134, v134
    v_exp_f32 v135, v135
    v_exp_f32 v136, v136
    v_exp_f32 v137, v137
    v_exp_f32 v138, v138
    v_exp_f32 v139, v139
    v_pk_add_f32 v[132:133], v[132:133], 1.0 op_sel_hi:[1,0]
    v_pk_add_f32 v[134:135], v[134:135], 1.0 op_sel_hi:[1,0]
    v_pk_add_f32 v[136:137], v[136:137], 1.0 op_sel_hi:[1,0]
    v_pk_add_f32 v[138:139], v[138:139], 1.0 op_sel_hi:[1,0]
    v_rcp_f32 v132, v132
    v_rcp_f32 v133, v133
    v_rcp_f32 v134, v134
    v_rcp_f32 v135, v135
    v_rcp_f32 v136, v136
    v_rcp_f32 v137, v137
    v_rcp_f32 v138, v138
    v_rcp_f32 v139, v139
    v_pk_mul_f32 v[12:13], v[12:13], v[132:133]
    v_pk_mul_f32 v[14:15], v[14:15], v[134:135]
    v_pk_mul_f32 v[28:29], v[28:29], v[136:137]
    v_pk_mul_f32 v[30:31], v[30:31], v[138:139]
    v_cvt_pk_bf16_f32 v128, v12, v13
    v_cvt_pk_bf16_f32 v129, v14, v15
    v_cvt_pk_bf16_f32 v130, v28, v29
    v_cvt_pk_bf16_f32 v131, v30, v31
    s_nop 0
    v_permlane16_swap_b32 v128, v130
    v_permlane16_swap_b32 v129, v131
    buffer_store_dwordx4 v[128:131], v244, s[16:19], s78 offen offset:0 sc1
    v_pk_fma_f32 v[132:133], v[148:149], v[122:123], v[176:177] op_sel:[0,1,0] op_sel_hi:[1,1,1]
    v_pk_fma_f32 v[134:135], v[150:151], v[122:123], v[178:179] op_sel:[0,1,0] op_sel_hi:[1,1,1]
    v_pk_fma_f32 v[136:137], v[152:153], v[122:123], v[180:181] op_sel:[0,1,0] op_sel_hi:[1,1,1]
    v_pk_fma_f32 v[138:139], v[154:155], v[122:123], v[182:183] op_sel:[0,1,0] op_sel_hi:[1,1,1]
    v_pk_fma_f32 v[16:17], v[16:17], v[122:123], v[132:133] op_sel:[0,0,0] op_sel_hi:[1,0,1]
    v_pk_fma_f32 v[18:19], v[18:19], v[122:123], v[134:135] op_sel:[0,0,0] op_sel_hi:[1,0,1]
    v_pk_fma_f32 v[32:33], v[32:33], v[122:123], v[136:137] op_sel:[0,0,0] op_sel_hi:[1,0,1]
    v_pk_fma_f32 v[34:35], v[34:35], v[122:123], v[138:139] op_sel:[0,0,0] op_sel_hi:[1,0,1]
    v_pk_mul_f32 v[132:133], v[16:17], v[16:17]
    v_pk_mul_f32 v[134:135], v[18:19], v[18:19]
    v_pk_mul_f32 v[136:137], v[32:33], v[32:33]
    v_pk_mul_f32 v[138:139], v[34:35], v[34:35]
    v_pk_fma_f32 v[132:133], v[132:133], v[248:249], v[248:249] op_sel:[0,0,1] op_sel_hi:[1,0,1]
    v_pk_fma_f32 v[134:135], v[134:135], v[248:249], v[248:249] op_sel:[0,0,1] op_sel_hi:[1,0,1]
    v_pk_fma_f32 v[136:137], v[136:137], v[248:249], v[248:249] op_sel:[0,0,1] op_sel_hi:[1,0,1]
    v_pk_fma_f32 v[138:139], v[138:139], v[248:249], v[248:249] op_sel:[0,0,1] op_sel_hi:[1,0,1]
    v_pk_mul_f32 v[132:133], v[132:133], v[16:17]
    v_pk_mul_f32 v[134:135], v[134:135], v[18:19]
    v_pk_mul_f32 v[136:137], v[136:137], v[32:33]
    v_pk_mul_f32 v[138:139], v[138:139], v[34:35]
    v_exp_f32 v132, v132
    v_exp_f32 v133, v133
    v_exp_f32 v134, v134
    v_exp_f32 v135, v135
    v_exp_f32 v136, v136
    v_exp_f32 v137, v137
    v_exp_f32 v138, v138
    v_exp_f32 v139, v139
    v_pk_add_f32 v[132:133], v[132:133], 1.0 op_sel_hi:[1,0]
    v_pk_add_f32 v[134:135], v[134:135], 1.0 op_sel_hi:[1,0]
    v_pk_add_f32 v[136:137], v[136:137], 1.0 op_sel_hi:[1,0]
    v_pk_add_f32 v[138:139], v[138:139], 1.0 op_sel_hi:[1,0]
    v_rcp_f32 v132, v132
    v_rcp_f32 v133, v133
    v_rcp_f32 v134, v134
    v_rcp_f32 v135, v135
    v_rcp_f32 v136, v136
    v_rcp_f32 v137, v137
    v_rcp_f32 v138, v138
    v_rcp_f32 v139, v139
    v_pk_mul_f32 v[16:17], v[16:17], v[132:133]
    v_pk_mul_f32 v[18:19], v[18:19], v[134:135]
    v_pk_mul_f32 v[32:33], v[32:33], v[136:137]
    v_pk_mul_f32 v[34:35], v[34:35], v[138:139]
    v_cvt_pk_bf16_f32 v144, v16, v17
    v_cvt_pk_bf16_f32 v145, v18, v19
    v_cvt_pk_bf16_f32 v146, v32, v33
    v_cvt_pk_bf16_f32 v147, v34, v35
    s_nop 0
    v_permlane16_swap_b32 v144, v146
    v_permlane16_swap_b32 v145, v147
    buffer_store_dwordx4 v[144:147], v244, s[16:19], s79 offen offset:0 sc1
    v_pk_fma_f32 v[132:133], v[172:173], v[116:117], v[200:201] op_sel:[0,1,0] op_sel_hi:[1,1,1]
    v_pk_fma_f32 v[134:135], v[174:175], v[116:117], v[202:203] op_sel:[0,1,0] op_sel_hi:[1,1,1]
    v_pk_fma_f32 v[136:137], v[172:173], v[118:119], v[200:201] op_sel:[0,1,0] op_sel_hi:[1,1,1]
    v_pk_fma_f32 v[138:139], v[174:175], v[118:119], v[202:203] op_sel:[0,1,0] op_sel_hi:[1,1,1]
    v_pk_fma_f32 v[100:101], v[100:101], v[116:117], v[132:133] op_sel:[0,0,0] op_sel_hi:[1,0,1]
    v_pk_fma_f32 v[102:103], v[102:103], v[116:117], v[134:135] op_sel:[0,0,0] op_sel_hi:[1,0,1]
    v_pk_fma_f32 v[104:105], v[104:105], v[118:119], v[136:137] op_sel:[0,0,0] op_sel_hi:[1,0,1]
    v_pk_fma_f32 v[106:107], v[106:107], v[118:119], v[138:139] op_sel:[0,0,0] op_sel_hi:[1,0,1]
    v_pk_mul_f32 v[132:133], v[100:101], v[100:101]
    v_pk_mul_f32 v[134:135], v[102:103], v[102:103]
    v_pk_mul_f32 v[136:137], v[104:105], v[104:105]
    v_pk_mul_f32 v[138:139], v[106:107], v[106:107]
    v_pk_fma_f32 v[132:133], v[132:133], v[248:249], v[248:249] op_sel:[0,0,1] op_sel_hi:[1,0,1]
    v_pk_fma_f32 v[134:135], v[134:135], v[248:249], v[248:249] op_sel:[0,0,1] op_sel_hi:[1,0,1]
    v_pk_fma_f32 v[136:137], v[136:137], v[248:249], v[248:249] op_sel:[0,0,1] op_sel_hi:[1,0,1]
    v_pk_fma_f32 v[138:139], v[138:139], v[248:249], v[248:249] op_sel:[0,0,1] op_sel_hi:[1,0,1]
    v_pk_mul_f32 v[132:133], v[132:133], v[100:101]
    v_pk_mul_f32 v[134:135], v[134:135], v[102:103]
    v_pk_mul_f32 v[136:137], v[136:137], v[104:105]
    v_pk_mul_f32 v[138:139], v[138:139], v[106:107]
    v_exp_f32 v132, v132
    v_exp_f32 v133, v133
    v_exp_f32 v134, v134
    v_exp_f32 v135, v135
    v_exp_f32 v136, v136
    v_exp_f32 v137, v137
    v_exp_f32 v138, v138
    v_exp_f32 v139, v139
    v_pk_add_f32 v[132:133], v[132:133], 1.0 op_sel_hi:[1,0]
    v_pk_add_f32 v[134:135], v[134:135], 1.0 op_sel_hi:[1,0]
    v_pk_add_f32 v[136:137], v[136:137], 1.0 op_sel_hi:[1,0]
    v_pk_add_f32 v[138:139], v[138:139], 1.0 op_sel_hi:[1,0]
    v_rcp_f32 v132, v132
    v_rcp_f32 v133, v133
    v_rcp_f32 v134, v134
    v_rcp_f32 v135, v135
    v_rcp_f32 v136, v136
    v_rcp_f32 v137, v137
    v_rcp_f32 v138, v138
    v_rcp_f32 v139, v139
    v_pk_mul_f32 v[100:101], v[100:101], v[132:133]
    v_pk_mul_f32 v[102:103], v[102:103], v[134:135]
    v_pk_mul_f32 v[104:105], v[104:105], v[136:137]
    v_pk_mul_f32 v[106:107], v[106:107], v[138:139]
    v_cvt_pk_bf16_f32 v128, v100, v101
    v_cvt_pk_bf16_f32 v129, v102, v103
    v_cvt_pk_bf16_f32 v130, v104, v105
    v_cvt_pk_bf16_f32 v131, v106, v107
    ds_write_b64 v247, v[128:129] offset:0
    ds_write_b64 v247, v[130:131] offset:1024
    v_pk_fma_f32 v[132:133], v[172:173], v[120:121], v[200:201] op_sel:[0,1,0] op_sel_hi:[1,1,1]
    v_pk_fma_f32 v[134:135], v[174:175], v[120:121], v[202:203] op_sel:[0,1,0] op_sel_hi:[1,1,1]
    v_pk_fma_f32 v[136:137], v[172:173], v[122:123], v[200:201] op_sel:[0,1,0] op_sel_hi:[1,1,1]
    v_pk_fma_f32 v[138:139], v[174:175], v[122:123], v[202:203] op_sel:[0,1,0] op_sel_hi:[1,1,1]
    v_pk_fma_f32 v[108:109], v[108:109], v[120:121], v[132:133] op_sel:[0,0,0] op_sel_hi:[1,0,1]
    v_pk_fma_f32 v[110:111], v[110:111], v[120:121], v[134:135] op_sel:[0,0,0] op_sel_hi:[1,0,1]
    v_pk_fma_f32 v[112:113], v[112:113], v[122:123], v[136:137] op_sel:[0,0,0] op_sel_hi:[1,0,1]
    v_pk_fma_f32 v[114:115], v[114:115], v[122:123], v[138:139] op_sel:[0,0,0] op_sel_hi:[1,0,1]
    v_pk_mul_f32 v[132:133], v[108:109], v[108:109]
    v_pk_mul_f32 v[134:135], v[110:111], v[110:111]
    v_pk_mul_f32 v[136:137], v[112:113], v[112:113]
    v_pk_mul_f32 v[138:139], v[114:115], v[114:115]
    v_pk_fma_f32 v[132:133], v[132:133], v[248:249], v[248:249] op_sel:[0,0,1] op_sel_hi:[1,0,1]
    v_pk_fma_f32 v[134:135], v[134:135], v[248:249], v[248:249] op_sel:[0,0,1] op_sel_hi:[1,0,1]
    v_pk_fma_f32 v[136:137], v[136:137], v[248:249], v[248:249] op_sel:[0,0,1] op_sel_hi:[1,0,1]
    v_pk_fma_f32 v[138:139], v[138:139], v[248:249], v[248:249] op_sel:[0,0,1] op_sel_hi:[1,0,1]
    v_pk_mul_f32 v[132:133], v[132:133], v[108:109]
    v_pk_mul_f32 v[134:135], v[134:135], v[110:111]
    v_pk_mul_f32 v[136:137], v[136:137], v[112:113]
    v_pk_mul_f32 v[138:139], v[138:139], v[114:115]
    v_exp_f32 v132, v132
    v_exp_f32 v133, v133
    v_exp_f32 v134, v134
    v_exp_f32 v135, v135
    v_exp_f32 v136, v136
    v_exp_f32 v137, v137
    v_exp_f32 v138, v138
    v_exp_f32 v139, v139
    v_pk_add_f32 v[132:133], v[132:133], 1.0 op_sel_hi:[1,0]
    v_pk_add_f32 v[134:135], v[134:135], 1.0 op_sel_hi:[1,0]
    v_pk_add_f32 v[136:137], v[136:137], 1.0 op_sel_hi:[1,0]
    v_pk_add_f32 v[138:139], v[138:139], 1.0 op_sel_hi:[1,0]
    v_rcp_f32 v132, v132
    v_rcp_f32 v133, v133
    v_rcp_f32 v134, v134
    v_rcp_f32 v135, v135
    v_rcp_f32 v136, v136
    v_rcp_f32 v137, v137
    v_rcp_f32 v138, v138
    v_rcp_f32 v139, v139
    v_pk_mul_f32 v[108:109], v[108:109], v[132:133]
    v_pk_mul_f32 v[110:111], v[110:111], v[134:135]
    v_pk_mul_f32 v[112:113], v[112:113], v[136:137]
    v_pk_mul_f32 v[114:115], v[114:115], v[138:139]
    v_cvt_pk_bf16_f32 v144, v108, v109
    v_cvt_pk_bf16_f32 v145, v110, v111
    v_cvt_pk_bf16_f32 v146, v112, v113
    v_cvt_pk_bf16_f32 v147, v114, v115
    ds_write_b64 v247, v[144:145] offset:2048
    ds_write_b64 v247, v[146:147] offset:3072
    s_lshl_b32 s3, s6, 2
    s_add_u32 s3, s3, 147456
    v_mov_b32 v124, s3
    v_mov_b32 v125, 3
    s_waitcnt lgkmcnt(0)
    ds_write_b32 v124, v125
    v_pk_fma_f32 v[132:133], v[156:157], v[116:117], v[184:185] op_sel:[0,1,0] op_sel_hi:[1,1,1]
    v_pk_fma_f32 v[134:135], v[158:159], v[116:117], v[186:187] op_sel:[0,1,0] op_sel_hi:[1,1,1]
    v_pk_fma_f32 v[136:137], v[160:161], v[116:117], v[188:189] op_sel:[0,1,0] op_sel_hi:[1,1,1]
    v_pk_fma_f32 v[138:139], v[162:163], v[116:117], v[190:191] op_sel:[0,1,0] op_sel_hi:[1,1,1]
    v_pk_fma_f32 v[36:37], v[36:37], v[116:117], v[132:133] op_sel:[0,0,0] op_sel_hi:[1,0,1]
    v_pk_fma_f32 v[38:39], v[38:39], v[116:117], v[134:135] op_sel:[0,0,0] op_sel_hi:[1,0,1]
    v_pk_fma_f32 v[52:53], v[52:53], v[116:117], v[136:137] op_sel:[0,0,0] op_sel_hi:[1,0,1]
    v_pk_fma_f32 v[54:55], v[54:55], v[116:117], v[138:139] op_sel:[0,0,0] op_sel_hi:[1,0,1]
    v_pk_mul_f32 v[132:133], v[36:37], v[36:37]
    v_pk_mul_f32 v[134:135], v[38:39], v[38:39]
    v_pk_mul_f32 v[136:137], v[52:53], v[52:53]
    v_pk_mul_f32 v[138:139], v[54:55], v[54:55]
    v_pk_fma_f32 v[132:133], v[132:133], v[248:249], v[248:249] op_sel:[0,0,1] op_sel_hi:[1,0,1]
    v_pk_fma_f32 v[134:135], v[134:135], v[248:249], v[248:249] op_sel:[0,0,1] op_sel_hi:[1,0,1]
    v_pk_fma_f32 v[136:137], v[136:137], v[248:249], v[248:249] op_sel:[0,0,1] op_sel_hi:[1,0,1]
    v_pk_fma_f32 v[138:139], v[138:139], v[248:249], v[248:249] op_sel:[0,0,1] op_sel_hi:[1,0,1]
    v_pk_mul_f32 v[132:133], v[132:133], v[36:37]
    v_pk_mul_f32 v[134:135], v[134:135], v[38:39]
    v_pk_mul_f32 v[136:137], v[136:137], v[52:53]
    v_pk_mul_f32 v[138:139], v[138:139], v[54:55]
    v_exp_f32 v132, v132
    v_exp_f32 v133, v133
    v_exp_f32 v134, v134
    v_exp_f32 v135, v135
    v_exp_f32 v136, v136
    v_exp_f32 v137, v137
    v_exp_f32 v138, v138
    v_exp_f32 v139, v139
    v_pk_add_f32 v[132:133], v[132:133], 1.0 op_sel_hi:[1,0]
    v_pk_add_f32 v[134:135], v[134:135], 1.0 op_sel_hi:[1,0]
    v_pk_add_f32 v[136:137], v[136:137], 1.0 op_sel_hi:[1,0]
    v_pk_add_f32 v[138:139], v[138:139], 1.0 op_sel_hi:[1,0]
    v_rcp_f32 v132, v132
    v_rcp_f32 v133, v133
    v_rcp_f32 v134, v134
    v_rcp_f32 v135, v135
    v_rcp_f32 v136, v136
    v_rcp_f32 v137, v137
    v_rcp_f32 v138, v138
    v_rcp_f32 v139, v139
    v_pk_mul_f32 v[36:37], v[36:37], v[132:133]
    v_pk_mul_f32 v[38:39], v[38:39], v[134:135]
    v_pk_mul_f32 v[52:53], v[52:53], v[136:137]
    v_pk_mul_f32 v[54:55], v[54:55], v[138:139]
    v_cvt_pk_bf16_f32 v128, v36, v37
    v_cvt_pk_bf16_f32 v129, v38, v39
    v_cvt_pk_bf16_f32 v130, v52, v53
    v_cvt_pk_bf16_f32 v131, v54, v55
    s_nop 0
    v_permlane16_swap_b32 v128, v130
    v_permlane16_swap_b32 v129, v131
    buffer_store_dwordx4 v[128:131], v244, s[16:19], s76 offen offset:1024 sc1
    v_pk_fma_f32 v[132:133], v[156:157], v[118:119], v[184:185] op_sel:[0,1,0] op_sel_hi:[1,1,1]
    v_pk_fma_f32 v[134:135], v[158:159], v[118:119], v[186:187] op_sel:[0,1,0] op_sel_hi:[1,1,1]
    v_pk_fma_f32 v[136:137], v[160:161], v[118:119], v[188:189] op_sel:[0,1,0] op_sel_hi:[1,1,1]
    v_pk_fma_f32 v[138:139], v[162:163], v[118:119], v[190:191] op_sel:[0,1,0] op_sel_hi:[1,1,1]
    v_pk_fma_f32 v[40:41], v[40:41], v[118:119], v[132:133] op_sel:[0,0,0] op_sel_hi:[1,0,1]
    v_pk_fma_f32 v[42:43], v[42:43], v[118:119], v[134:135] op_sel:[0,0,0] op_sel_hi:[1,0,1]
    v_pk_fma_f32 v[56:57], v[56:57], v[118:119], v[136:137] op_sel:[0,0,0] op_sel_hi:[1,0,1]
    v_pk_fma_f32 v[58:59], v[58:59], v[118:119], v[138:139] op_sel:[0,0,0] op_sel_hi:[1,0,1]
    v_pk_mul_f32 v[132:133], v[40:41], v[40:41]
    v_pk_mul_f32 v[134:135], v[42:43], v[42:43]
    v_pk_mul_f32 v[136:137], v[56:57], v[56:57]
    v_pk_mul_f32 v[138:139], v[58:59], v[58:59]
    v_pk_fma_f32 v[132:133], v[132:133], v[248:249], v[248:249] op_sel:[0,0,1] op_sel_hi:[1,0,1]
    v_pk_fma_f32 v[134:135], v[134:135], v[248:249], v[248:249] op_sel:[0,0,1] op_sel_hi:[1,0,1]
    v_pk_fma_f32 v[136:137], v[136:137], v[248:249], v[248:249] op_sel:[0,0,1] op_sel_hi:[1,0,1]
    v_pk_fma_f32 v[138:139], v[138:139], v[248:249], v[248:249] op_sel:[0,0,1] op_sel_hi:[1,0,1]
    v_pk_mul_f32 v[132:133], v[132:133], v[40:41]
    v_pk_mul_f32 v[134:135], v[134:135], v[42:43]
    v_pk_mul_f32 v[136:137], v[136:137], v[56:57]
    v_pk_mul_f32 v[138:139], v[138:139], v[58:59]
    v_exp_f32 v132, v132
    v_exp_f32 v133, v133
    v_exp_f32 v134, v134
    v_exp_f32 v135, v135
    v_exp_f32 v136, v136
    v_exp_f32 v137, v137
    v_exp_f32 v138, v138
    v_exp_f32 v139, v139
    v_pk_add_f32 v[132:133], v[132:133], 1.0 op_sel_hi:[1,0]
    v_pk_add_f32 v[134:135], v[134:135], 1.0 op_sel_hi:[1,0]
    v_pk_add_f32 v[136:137], v[136:137], 1.0 op_sel_hi:[1,0]
    v_pk_add_f32 v[138:139], v[138:139], 1.0 op_sel_hi:[1,0]
    v_rcp_f32 v132, v132
    v_rcp_f32 v133, v133
    v_rcp_f32 v134, v134
    v_rcp_f32 v135, v135
    v_rcp_f32 v136, v136
    v_rcp_f32 v137, v137
    v_rcp_f32 v138, v138
    v_rcp_f32 v139, v139
    v_pk_mul_f32 v[40:41], v[40:41], v[132:133]
    v_pk_mul_f32 v[42:43], v[42:43], v[134:135]
    v_pk_mul_f32 v[56:57], v[56:57], v[136:137]
    v_pk_mul_f32 v[58:59], v[58:59], v[138:139]
    v_cvt_pk_bf16_f32 v144, v40, v41
    v_cvt_pk_bf16_f32 v145, v42, v43
    v_cvt_pk_bf16_f32 v146, v56, v57
    v_cvt_pk_bf16_f32 v147, v58, v59
    s_nop 0
    v_permlane16_swap_b32 v144, v146
    v_permlane16_swap_b32 v145, v147
    buffer_store_dwordx4 v[144:147], v244, s[16:19], s77 offen offset:1024 sc1
    v_xor_b32 v124, 8, v124
P3_ps:
    ds_read_b32 v125, v124
    s_waitcnt lgkmcnt(0)
    v_readfirstlane_b32 s3, v125
    s_nop 0
    s_cmp_lg_u32 s3, 3
    s_cbranch_scc1 P3_ps
    ds_read_b128 v[100:103], v246 offset:0
    ds_read_b128 v[104:107], v246 offset:1024
    v_pk_fma_f32 v[132:133], v[156:157], v[120:121], v[184:185] op_sel:[0,1,0] op_sel_hi:[1,1,1]
    v_pk_fma_f32 v[134:135], v[158:159], v[120:121], v[186:187] op_sel:[0,1,0] op_sel_hi:[1,1,1]
    v_pk_fma_f32 v[136:137], v[160:161], v[120:121], v[188:189] op_sel:[0,1,0] op_sel_hi:[1,1,1]
    v_pk_fma_f32 v[138:139], v[162:163], v[120:121], v[190:191] op_sel:[0,1,0] op_sel_hi:[1,1,1]
    v_pk_fma_f32 v[44:45], v[44:45], v[120:121], v[132:133] op_sel:[0,0,0] op_sel_hi:[1,0,1]
    v_pk_fma_f32 v[46:47], v[46:47], v[120:121], v[134:135] op_sel:[0,0,0] op_sel_hi:[1,0,1]
    v_pk_fma_f32 v[60:61], v[60:61], v[120:121], v[136:137] op_sel:[0,0,0] op_sel_hi:[1,0,1]
    v_pk_fma_f32 v[62:63], v[62:63], v[120:121], v[138:139] op_sel:[0,0,0] op_sel_hi:[1,0,1]
    v_pk_mul_f32 v[132:133], v[44:45], v[44:45]
    v_pk_mul_f32 v[134:135], v[46:47], v[46:47]
    v_pk_mul_f32 v[136:137], v[60:61], v[60:61]
    v_pk_mul_f32 v[138:139], v[62:63], v[62:63]
    v_pk_fma_f32 v[132:133], v[132:133], v[248:249], v[248:249] op_sel:[0,0,1] op_sel_hi:[1,0,1]
    v_pk_fma_f32 v[134:135], v[134:135], v[248:249], v[248:249] op_sel:[0,0,1] op_sel_hi:[1,0,1]
    v_pk_fma_f32 v[136:137], v[136:137], v[248:249], v[248:249] op_sel:[0,0,1] op_sel_hi:[1,0,1]
    v_pk_fma_f32 v[138:139], v[138:139], v[248:249], v[248:249] op_sel:[0,0,1] op_sel_hi:[1,0,1]
    v_pk_mul_f32 v[132:133], v[132:133], v[44:45]
    v_pk_mul_f32 v[134:135], v[134:135], v[46:47]
    v_pk_mul_f32 v[136:137], v[136:137], v[60:61]
    v_pk_mul_f32 v[138:139], v[138:139], v[62:63]
    v_exp_f32 v132, v132
    v_exp_f32 v133, v133
    v_exp_f32 v134, v134
    v_exp_f32 v135, v135
    v_exp_f32 v136, v136
    v_exp_f32 v137, v137
    v_exp_f32 v138, v138
    v_exp_f32 v139, v139
    v_pk_add_f32 v[132:133], v[132:133], 1.0 op_sel_hi:[1,0]
    v_pk_add_f32 v[134:135], v[134:135], 1.0 op_sel_hi:[1,0]
    v_pk_add_f32 v[136:137], v[136:137], 1.0 op_sel_hi:[1,0]
    v_pk_add_f32 v[138:139], v[138:139], 1.0 op_sel_hi:[1,0]
    v_rcp_f32 v132, v132
    v_rcp_f32 v133, v133
    v_rcp_f32 v134, v134
    v_rcp_f32 v135, v135
    v_rcp_f32 v136, v136
    v_rcp_f32 v137, v137
    v_rcp_f32 v138, v138
    v_rcp_f32 v139, v139
    v_pk_mul_f32 v[44:45], v[44:45], v[132:133]
    v_pk_mul_f32 v[46:47], v[46:47], v[134:135]
    v_pk_mul_f32 v[60:61], v[60:61], v[136:137]
    v_pk_mul_f32 v[62:63], v[62:63], v[138:139]
    v_cvt_pk_bf16_f32 v128, v44, v45
    v_cvt_pk_bf16_f32 v129, v46, v47
    v_cvt_pk_bf16_f32 v130, v60, v61
    v_cvt_pk_bf16_f32 v131, v62, v63
    s_nop 0
    v_permlane16_swap_b32 v128, v130
    v_permlane16_swap_b32 v129, v131
    buffer_store_dwordx4 v[128:131], v244, s[16:19], s78 offen offset:1024 sc1
    v_pk_fma_f32 v[132:133], v[156:157], v[122:123], v[184:185] op_sel:[0,1,0] op_sel_hi:[1,1,1]
    v_pk_fma_f32 v[134:135], v[158:159], v[122:123], v[186:187] op_sel:[0,1,0] op_sel_hi:[1,1,1]
    v_pk_fma_f32 v[136:137], v[160:161], v[122:123], v[188:189] op_sel:[0,1,0] op_sel_hi:[1,1,1]
    v_pk_fma_f32 v[138:139], v[162:163], v[122:123], v[190:191] op_sel:[0,1,0] op_sel_hi:[1,1,1]
    v_pk_fma_f32 v[48:49], v[48:49], v[122:123], v[132:133] op_sel:[0,0,0] op_sel_hi:[1,0,1]
    v_pk_fma_f32 v[50:51], v[50:51], v[122:123], v[134:135] op_sel:[0,0,0] op_sel_hi:[1,0,1]
    v_pk_fma_f32 v[64:65], v[64:65], v[122:123], v[136:137] op_sel:[0,0,0] op_sel_hi:[1,0,1]
    v_pk_fma_f32 v[66:67], v[66:67], v[122:123], v[138:139] op_sel:[0,0,0] op_sel_hi:[1,0,1]
    v_pk_mul_f32 v[132:133], v[48:49], v[48:49]
    v_pk_mul_f32 v[134:135], v[50:51], v[50:51]
    v_pk_mul_f32 v[136:137], v[64:65], v[64:65]
    v_pk_mul_f32 v[138:139], v[66:67], v[66:67]
    v_pk_fma_f32 v[132:133], v[132:133], v[248:249], v[248:249] op_sel:[0,0,1] op_sel_hi:[1,0,1]
    v_pk_fma_f32 v[134:135], v[134:135], v[248:249], v[248:249] op_sel:[0,0,1] op_sel_hi:[1,0,1]
    v_pk_fma_f32 v[136:137], v[136:137], v[248:249], v[248:249] op_sel:[0,0,1] op_sel_hi:[1,0,1]
    v_pk_fma_f32 v[138:139], v[138:139], v[248:249], v[248:249] op_sel:[0,0,1] op_sel_hi:[1,0,1]
    v_pk_mul_f32 v[132:133], v[132:133], v[48:49]
    v_pk_mul_f32 v[134:135], v[134:135], v[50:51]
    v_pk_mul_f32 v[136:137], v[136:137], v[64:65]
    v_pk_mul_f32 v[138:139], v[138:139], v[66:67]
    v_exp_f32 v132, v132
    v_exp_f32 v133, v133
    v_exp_f32 v134, v134
    v_exp_f32 v135, v135
    v_exp_f32 v136, v136
    v_exp_f32 v137, v137
    v_exp_f32 v138, v138
    v_exp_f32 v139, v139
    v_pk_add_f32 v[132:133], v[132:133], 1.0 op_sel_hi:[1,0]
    v_pk_add_f32 v[134:135], v[134:135], 1.0 op_sel_hi:[1,0]
    v_pk_add_f32 v[136:137], v[136:137], 1.0 op_sel_hi:[1,0]
    v_pk_add_f32 v[138:139], v[138:139], 1.0 op_sel_hi:[1,0]
    v_rcp_f32 v132, v132
    v_rcp_f32 v133, v133
    v_rcp_f32 v134, v134
    v_rcp_f32 v135, v135
    v_rcp_f32 v136, v136
    v_rcp_f32 v137, v137
    v_rcp_f32 v138, v138
    v_rcp_f32 v139, v139
    v_pk_mul_f32 v[48:49], v[48:49], v[132:133]
    v_pk_mul_f32 v[50:51], v[50:51], v[134:135]
    v_pk_mul_f32 v[64:65], v[64:65], v[136:137]
    v_pk_mul_f32 v[66:67], v[66:67], v[138:139]
    v_cvt_pk_bf16_f32 v144, v48, v49
    v_cvt_pk_bf16_f32 v145, v50, v51
    v_cvt_pk_bf16_f32 v146, v64, v65
    v_cvt_pk_bf16_f32 v147, v66, v67
    s_nop 0
    v_permlane16_swap_b32 v144, v146
    v_permlane16_swap_b32 v145, v147
    buffer_store_dwordx4 v[144:147], v244, s[16:19], s79 offen offset:1024 sc1
    v_mov_b32 v126, 147480
    v_mov_b32 v127, 1
    s_mov_b64 exec, 1
    s_waitcnt vmcnt(4)
    ds_add_rtn_u32 v127, v126, v127
    s_mov_b64 exec, -1
    v_pk_fma_f32 v[132:133], v[164:165], v[116:117], v[192:193] op_sel:[0,1,0] op_sel_hi:[1,1,1]
    v_pk_fma_f32 v[134:135], v[166:167], v[116:117], v[194:195] op_sel:[0,1,0] op_sel_hi:[1,1,1]
    v_pk_fma_f32 v[136:137], v[168:169], v[116:117], v[196:197] op_sel:[0,1,0] op_sel_hi:[1,1,1]
    v_pk_fma_f32 v[138:139], v[170:171], v[116:117], v[198:199] op_sel:[0,1,0] op_sel_hi:[1,1,1]
    v_pk_fma_f32 v[68:69], v[68:69], v[116:117], v[132:133] op_sel:[0,0,0] op_sel_hi:[1,0,1]
    v_pk_fma_f32 v[70:71], v[70:71], v[116:117], v[134:135] op_sel:[0,0,0] op_sel_hi:[1,0,1]
    v_pk_fma_f32 v[84:85], v[84:85], v[116:117], v[136:137] op_sel:[0,0,0] op_sel_hi:[1,0,1]
    v_pk_fma_f32 v[86:87], v[86:87], v[116:117], v[138:139] op_sel:[0,0,0] op_sel_hi:[1,0,1]
    v_pk_mul_f32 v[132:133], v[68:69], v[68:69]
    v_pk_mul_f32 v[134:135], v[70:71], v[70:71]
    v_pk_mul_f32 v[136:137], v[84:85], v[84:85]
    v_pk_mul_f32 v[138:139], v[86:87], v[86:87]
    v_pk_fma_f32 v[132:133], v[132:133], v[248:249], v[248:249] op_sel:[0,0,1] op_sel_hi:[1,0,1]
    v_pk_fma_f32 v[134:135], v[134:135], v[248:249], v[248:249] op_sel:[0,0,1] op_sel_hi:[1,0,1]
    v_pk_fma_f32 v[136:137], v[136:137], v[248:249], v[248:249] op_sel:[0,0,1] op_sel_hi:[1,0,1]
    v_pk_fma_f32 v[138:139], v[138:139], v[248:249], v[248:249] op_sel:[0,0,1] op_sel_hi:[1,0,1]
    v_pk_mul_f32 v[132:133], v[132:133], v[68:69]
    v_pk_mul_f32 v[134:135], v[134:135], v[70:71]
    v_pk_mul_f32 v[136:137], v[136:137], v[84:85]
    v_pk_mul_f32 v[138:139], v[138:139], v[86:87]
    v_exp_f32 v132, v132
    v_exp_f32 v133, v133
    v_exp_f32 v134, v134
    v_exp_f32 v135, v135
    v_exp_f32 v136, v136
    v_exp_f32 v137, v137
    v_exp_f32 v138, v138
    v_exp_f32 v139, v139
    v_pk_add_f32 v[132:133], v[132:133], 1.0 op_sel_hi:[1,0]
    v_pk_add_f32 v[134:135], v[134:135], 1.0 op_sel_hi:[1,0]
    v_pk_add_f32 v[136:137], v[136:137], 1.0 op_sel_hi:[1,0]
    v_pk_add_f32 v[138:139], v[138:139], 1.0 op_sel_hi:[1,0]
    v_rcp_f32 v132, v132
    v_rcp_f32 v133, v133
    v_rcp_f32 v134, v134
    v_rcp_f32 v135, v135
    v_rcp_f32 v136, v136
    v_rcp_f32 v137, v137
    v_rcp_f32 v138, v138
    v_rcp_f32 v139, v139
    v_pk_mul_f32 v[68:69], v[68:69], v[132:133]
    v_pk_mul_f32 v[70:71], v[70:71], v[134:135]
    v_pk_mul_f32 v[84:85], v[84:85], v[136:137]
    v_pk_mul_f32 v[86:87], v[86:87], v[138:139]
    v_cvt_pk_bf16_f32 v128, v68, v69
    v_cvt_pk_bf16_f32 v129, v70, v71
    v_cvt_pk_bf16_f32 v130, v84, v85
    v_cvt_pk_bf16_f32 v131, v86, v87
    s_nop 0
    v_permlane16_swap_b32 v128, v130
    v_permlane16_swap_b32 v129, v131
    buffer_store_dwordx4 v[128:131], v244, s[16:19], s76 offen offset:2048 sc1
    s_waitcnt lgkmcnt(0)
    v_readfirstlane_b32 s3, v127
    s_nop 0
    s_cmp_lg_u32 s3, 3
    s_cbranch_scc1 P3_ne
    v_mov_b32 v126, s85
    v_mov_b32 v132, s74
    v_mov_b32 v133, s75
    s_mov_b64 exec, 1
    global_store_dwordx2 v126, v[132:133], s[68:69] sc1
    s_mov_b64 exec, -1
P3_ne:
    v_pk_fma_f32 v[132:133], v[164:165], v[118:119], v[192:193] op_sel:[0,1,0] op_sel_hi:[1,1,1]
    v_pk_fma_f32 v[134:135], v[166:167], v[118:119], v[194:195] op_sel:[0,1,0] op_sel_hi:[1,1,1]
    v_pk_fma_f32 v[136:137], v[168:169], v[118:119], v[196:197] op_sel:[0,1,0] op_sel_hi:[1,1,1]
    v_pk_fma_f32 v[138:139], v[170:171], v[118:119], v[198:199] op_sel:[0,1,0] op_sel_hi:[1,1,1]
    v_pk_fma_f32 v[72:73], v[72:73], v[118:119], v[132:133] op_sel:[0,0,0] op_sel_hi:[1,0,1]
    v_pk_fma_f32 v[74:75], v[74:75], v[118:119], v[134:135] op_sel:[0,0,0] op_sel_hi:[1,0,1]
    v_pk_fma_f32 v[88:89], v[88:89], v[118:119], v[136:137] op_sel:[0,0,0] op_sel_hi:[1,0,1]
    v_pk_fma_f32 v[90:91], v[90:91], v[118:119], v[138:139] op_sel:[0,0,0] op_sel_hi:[1,0,1]
    v_pk_mul_f32 v[132:133], v[72:73], v[72:73]
    v_pk_mul_f32 v[134:135], v[74:75], v[74:75]
    v_pk_mul_f32 v[136:137], v[88:89], v[88:89]
    v_pk_mul_f32 v[138:139], v[90:91], v[90:91]
    v_pk_fma_f32 v[132:133], v[132:133], v[248:249], v[248:249] op_sel:[0,0,1] op_sel_hi:[1,0,1]
    v_pk_fma_f32 v[134:135], v[134:135], v[248:249], v[248:249] op_sel:[0,0,1] op_sel_hi:[1,0,1]
    v_pk_fma_f32 v[136:137], v[136:137], v[248:249], v[248:249] op_sel:[0,0,1] op_sel_hi:[1,0,1]
    v_pk_fma_f32 v[138:139], v[138:139], v[248:249], v[248:249] op_sel:[0,0,1] op_sel_hi:[1,0,1]
    v_pk_mul_f32 v[132:133], v[132:133], v[72:73]
    v_pk_mul_f32 v[134:135], v[134:135], v[74:75]
    v_pk_mul_f32 v[136:137], v[136:137], v[88:89]
    v_pk_mul_f32 v[138:139], v[138:139], v[90:91]
    v_exp_f32 v132, v132
    v_exp_f32 v133, v133
    v_exp_f32 v134, v134
    v_exp_f32 v135, v135
    v_exp_f32 v136, v136
    v_exp_f32 v137, v137
    v_exp_f32 v138, v138
    v_exp_f32 v139, v139
    v_pk_add_f32 v[132:133], v[132:133], 1.0 op_sel_hi:[1,0]
    v_pk_add_f32 v[134:135], v[134:135], 1.0 op_sel_hi:[1,0]
    v_pk_add_f32 v[136:137], v[136:137], 1.0 op_sel_hi:[1,0]
    v_pk_add_f32 v[138:139], v[138:139], 1.0 op_sel_hi:[1,0]
    v_rcp_f32 v132, v132
    v_rcp_f32 v133, v133
    v_rcp_f32 v134, v134
    v_rcp_f32 v135, v135
    v_rcp_f32 v136, v136
    v_rcp_f32 v137, v137
    v_rcp_f32 v138, v138
    v_rcp_f32 v139, v139
    v_pk_mul_f32 v[72:73], v[72:73], v[132:133]
    v_pk_mul_f32 v[74:75], v[74:75], v[134:135]
    v_pk_mul_f32 v[88:89], v[88:89], v[136:137]
    v_pk_mul_f32 v[90:91], v[90:91], v[138:139]
    v_cvt_pk_bf16_f32 v144, v72, v73
    v_cvt_pk_bf16_f32 v145, v74, v75
    v_cvt_pk_bf16_f32 v146, v88, v89
    v_cvt_pk_bf16_f32 v147, v90, v91
    s_nop 0
    v_permlane16_swap_b32 v144, v146
    v_permlane16_swap_b32 v145, v147
    buffer_store_dwordx4 v[144:147], v244, s[16:19], s77 offen offset:2048 sc1
    s_waitcnt lgkmcnt(0)
    v_permlane16_swap_b32 v100, v102
    v_permlane16_swap_b32 v101, v103
    buffer_store_dwordx4 v[100:103], v244, s[16:19], s80 offen offset:0 sc1
    v_permlane16_swap_b32 v104, v106
    v_permlane16_swap_b32 v105, v107
    buffer_store_dwordx4 v[104:107], v244, s[16:19], s81 offen offset:0 sc1
    v_pk_fma_f32 v[132:133], v[164:165], v[120:121], v[192:193] op_sel:[0,1,0] op_sel_hi:[1,1,1]
    v_pk_fma_f32 v[134:135], v[166:167], v[120:121], v[194:195] op_sel:[0,1,0] op_sel_hi:[1,1,1]
    v_pk_fma_f32 v[136:137], v[168:169], v[120:121], v[196:197] op_sel:[0,1,0] op_sel_hi:[1,1,1]
    v_pk_fma_f32 v[138:139], v[170:171], v[120:121], v[198:199] op_sel:[0,1,0] op_sel_hi:[1,1,1]
    v_pk_fma_f32 v[76:77], v[76:77], v[120:121], v[132:133] op_sel:[0,0,0] op_sel_hi:[1,0,1]
    v_pk_fma_f32 v[78:79], v[78:79], v[120:121], v[134:135] op_sel:[0,0,0] op_sel_hi:[1,0,1]
    v_pk_fma_f32 v[92:93], v[92:93], v[120:121], v[136:137] op_sel:[0,0,0] op_sel_hi:[1,0,1]
    v_pk_fma_f32 v[94:95], v[94:95], v[120:121], v[138:139] op_sel:[0,0,0] op_sel_hi:[1,0,1]
    v_pk_mul_f32 v[132:133], v[76:77], v[76:77]
    v_pk_mul_f32 v[134:135], v[78:79], v[78:79]
    v_pk_mul_f32 v[136:137], v[92:93], v[92:93]
    v_pk_mul_f32 v[138:139], v[94:95], v[94:95]
    v_pk_fma_f32 v[132:133], v[132:133], v[248:249], v[248:249] op_sel:[0,0,1] op_sel_hi:[1,0,1]
    v_pk_fma_f32 v[134:135], v[134:135], v[248:249], v[248:249] op_sel:[0,0,1] op_sel_hi:[1,0,1]
    v_pk_fma_f32 v[136:137], v[136:137], v[248:249], v[248:249] op_sel:[0,0,1] op_sel_hi:[1,0,1]
    v_pk_fma_f32 v[138:139], v[138:139], v[248:249], v[248:249] op_sel:[0,0,1] op_sel_hi:[1,0,1]
    v_pk_mul_f32 v[132:133], v[132:133], v[76:77]
    v_pk_mul_f32 v[134:135], v[134:135], v[78:79]
    v_pk_mul_f32 v[136:137], v[136:137], v[92:93]
    v_pk_mul_f32 v[138:139], v[138:139], v[94:95]
    v_exp_f32 v132, v132
    v_exp_f32 v133, v133
    v_exp_f32 v134, v134
    v_exp_f32 v135, v135
    v_exp_f32 v136, v136
    v_exp_f32 v137, v137
    v_exp_f32 v138, v138
    v_exp_f32 v139, v139
    v_pk_add_f32 v[132:133], v[132:133], 1.0 op_sel_hi:[1,0]
    v_pk_add_f32 v[134:135], v[134:135], 1.0 op_sel_hi:[1,0]
    v_pk_add_f32 v[136:137], v[136:137], 1.0 op_sel_hi:[1,0]
    v_pk_add_f32 v[138:139], v[138:139], 1.0 op_sel_hi:[1,0]
    v_rcp_f32 v132, v132
    v_rcp_f32 v133, v133
    v_rcp_f32 v134, v134
    v_rcp_f32 v135, v135
    v_rcp_f32 v136, v136
    v_rcp_f32 v137, v137
    v_rcp_f32 v138, v138
    v_rcp_f32 v139, v139
    v_pk_mul_f32 v[76:77], v[76:77], v[132:133]
    v_pk_mul_f32 v[78:79], v[78:79], v[134:135]
    v_pk_mul_f32 v[92:93], v[92:93], v[136:137]
    v_pk_mul_f32 v[94:95], v[94:95], v[138:139]
    v_cvt_pk_bf16_f32 v128, v76, v77
    v_cvt_pk_bf16_f32 v129, v78, v79
    v_cvt_pk_bf16_f32 v130, v92, v93
    v_cvt_pk_bf16_f32 v131, v94, v95
    s_nop 0
    v_permlane16_swap_b32 v128, v130
    v_permlane16_swap_b32 v129, v131
    buffer_store_dwordx4 v[128:131], v244, s[16:19], s78 offen offset:2048 sc1
    v_pk_fma_f32 v[132:133], v[164:165], v[122:123], v[192:193] op_sel:[0,1,0] op_sel_hi:[1,1,1]
    v_pk_fma_f32 v[134:135], v[166:167], v[122:123], v[194:195] op_sel:[0,1,0] op_sel_hi:[1,1,1]
    v_pk_fma_f32 v[136:137], v[168:169], v[122:123], v[196:197] op_sel:[0,1,0] op_sel_hi:[1,1,1]
    v_pk_fma_f32 v[138:139], v[170:171], v[122:123], v[198:199] op_sel:[0,1,0] op_sel_hi:[1,1,1]
    v_pk_fma_f32 v[80:81], v[80:81], v[122:123], v[132:133] op_sel:[0,0,0] op_sel_hi:[1,0,1]
    v_pk_fma_f32 v[82:83], v[82:83], v[122:123], v[134:135] op_sel:[0,0,0] op_sel_hi:[1,0,1]
    v_pk_fma_f32 v[96:97], v[96:97], v[122:123], v[136:137] op_sel:[0,0,0] op_sel_hi:[1,0,1]
    v_pk_fma_f32 v[98:99], v[98:99], v[122:123], v[138:139] op_sel:[0,0,0] op_sel_hi:[1,0,1]
    v_pk_mul_f32 v[132:133], v[80:81], v[80:81]
    v_pk_mul_f32 v[134:135], v[82:83], v[82:83]
    v_pk_mul_f32 v[136:137], v[96:97], v[96:97]
    v_pk_mul_f32 v[138:139], v[98:99], v[98:99]
    v_pk_fma_f32 v[132:133], v[132:133], v[248:249], v[248:249] op_sel:[0,0,1] op_sel_hi:[1,0,1]
    v_pk_fma_f32 v[134:135], v[134:135], v[248:249], v[248:249] op_sel:[0,0,1] op_sel_hi:[1,0,1]
    v_pk_fma_f32 v[136:137], v[136:137], v[248:249], v[248:249] op_sel:[0,0,1] op_sel_hi:[1,0,1]
    v_pk_fma_f32 v[138:139], v[138:139], v[248:249], v[248:249] op_sel:[0,0,1] op_sel_hi:[1,0,1]
    v_pk_mul_f32 v[132:133], v[132:133], v[80:81]
    v_pk_mul_f32 v[134:135], v[134:135], v[82:83]
    v_pk_mul_f32 v[136:137], v[136:137], v[96:97]
    v_pk_mul_f32 v[138:139], v[138:139], v[98:99]
    v_exp_f32 v132, v132
    v_exp_f32 v133, v133
    v_exp_f32 v134, v134
    v_exp_f32 v135, v135
    v_exp_f32 v136, v136
    v_exp_f32 v137, v137
    v_exp_f32 v138, v138
    v_exp_f32 v139, v139
    v_pk_add_f32 v[132:133], v[132:133], 1.0 op_sel_hi:[1,0]
    v_pk_add_f32 v[134:135], v[134:135], 1.0 op_sel_hi:[1,0]
    v_pk_add_f32 v[136:137], v[136:137], 1.0 op_sel_hi:[1,0]
    v_pk_add_f32 v[138:139], v[138:139], 1.0 op_sel_hi:[1,0]
    v_rcp_f32 v132, v132
    v_rcp_f32 v133, v133
    v_rcp_f32 v134, v134
    v_rcp_f32 v135, v135
    v_rcp_f32 v136, v136
    v_rcp_f32 v137, v137
    v_rcp_f32 v138, v138
    v_rcp_f32 v139, v139
    v_pk_mul_f32 v[80:81], v[80:81], v[132:133]
    v_pk_mul_f32 v[82:83], v[82:83], v[134:135]
    v_pk_mul_f32 v[96:97], v[96:97], v[136:137]
    v_pk_mul_f32 v[98:99], v[98:99], v[138:139]
    v_cvt_pk_bf16_f32 v144, v80, v81
    v_cvt_pk_bf16_f32 v145, v82, v83
    v_cvt_pk_bf16_f32 v146, v96, v97
    v_cvt_pk_bf16_f32 v147, v98, v99
    s_nop 0
    v_permlane16_swap_b32 v144, v146
    v_permlane16_swap_b32 v145, v147
    buffer_store_dwordx4 v[144:147], v244, s[16:19], s79 offen offset:2048 sc1
    s_mov_b32 s16, s64
    s_mov_b32 s17, s65
    s_mov_b32 s18, 4194304
    s_mov_b32 s19, 0x20000
    s_add_u32 s20, s68, 50331648
    s_addc_u32 s21, s69, 0
    s_mov_b32 s22, 8388608
    s_mov_b32 s23, 0x20000
    s_and_b32 s34, s6, 1
    s_lshr_b32 s35, s6, 1
    s_lshl_b32 s36, s34, 13
    s_add_u32 s36, s36, 49152
    v_lshlrev_b32 v4, 4, v1
    v_add_u32 v4, s36, v4
    s_lshl_b32 s37, s5, 12
    s_sub_u32 s38, 4096, s37
    v_add_u32 v5, s38, v4
    v_add_u32 v4, s37, v4
    s_lshl_b32 s36, s35, 13
    s_add_u32 s36, s36, 65536
    v_bfe_u32 v7, v2, 3, 1
    v_and_b32 v6, 1, v3
    v_lshl_or_b32 v7, v6, 1, v7
    v_lshrrev_b32 v6, 2, v2
    v_lshl_add_u32 v6, v3, 3, v6
    v_lshlrev_b32 v8, 7, v6
    v_and_b32 v6, 3, v2
    v_lshl_add_u32 v8, v6, 3, v8
    v_add_u32 v8, s36, v8
    v_xor_b32 v6, 0, v7
    v_lshl_add_u32 v9, v6, 5, v8
    v_xor_b32 v6, 1, v7
    v_lshl_add_u32 v10, v6, 5, v8
    v_xor_b32 v6, 2, v7
    v_lshl_add_u32 v11, v6, 5, v8
    v_xor_b32 v6, 3, v7
    v_lshl_add_u32 v12, v6, 5, v8
    s_lshl_b32 s36, s70, 7
    s_lshl_b32 s37, s34, 6
    s_add_u32 s36, s36, s37
    s_lshl_b32 s37, s5, 5
    s_add_u32 s36, s36, s37
    v_add_u32 v144, s36, v2
    v_lshlrev_b32 v144, 11, v144
    v_and_b32 v145, 1, v3
    v_lshl_add_u32 v144, v145, 5, v144
    v_lshrrev_b32 v145, 1, v3
    v_lshl_add_u32 v144, v145, 4, v144
    s_lshl_b32 s36, s4, 8
    s_lshl_b32 s37, s35, 7
    s_add_u32 s36, s36, s37
    v_add_u32 v144, s36, v144
    s_mov_b32 s45, 32768
    v_lshlrev_b32 v146, 4, v1
    s_lshl_b32 s36, s2, 2
    s_add_u32 s36, s36, s6
    s_xor_b32 s37, s36, 8
    s_lshl_b32 s76, s36, 13
    s_add_u32 s77, s76, 4096
    s_lshl_b32 s78, s37, 13
    s_add_u32 s79, s78, 4096
    s_lshl_b32 s36, s36, 7
    s_lshl_b32 s37, s37, 7
    s_add_u32 s36, s36, 32505856
    s_add_u32 s37, s37, 32505856
    v_mov_b32 v148, s36
    v_mov_b32 v149, s37
    v_mov_b32 v150, s74
    v_mov_b32 v151, s75
    v_lshlrev_b32 v24, 16, v232
    v_and_b32 v25, 0xffff0000, v232
    v_lshlrev_b32 v26, 16, v233
    v_and_b32 v27, 0xffff0000, v233
    v_lshlrev_b32 v16, 16, v216
    v_and_b32 v17, 0xffff0000, v216
    v_lshlrev_b32 v18, 16, v217
    v_and_b32 v19, 0xffff0000, v217
    v_lshlrev_b32 v20, 16, v224
    v_and_b32 v21, 0xffff0000, v224
    v_lshlrev_b32 v22, 16, v225
    v_and_b32 v23, 0xffff0000, v225
    v_pk_add_f32 v[16:17], v[16:17], v[24:25]
    v_pk_add_f32 v[18:19], v[18:19], v[26:27]
    v_pk_add_f32 v[20:21], v[20:21], v[24:25]
    v_pk_add_f32 v[22:23], v[22:23], v[26:27]
    v_mov_b32 v24, 0
    v_mov_b32 v25, 0
    v_mov_b32 v26, 0
    v_mov_b32 v27, 0
    v_mov_b32 v28, 0
    v_mov_b32 v29, 0
    v_mov_b32 v30, 0
    v_mov_b32 v31, 0
    v_lshlrev_b32 v40, 16, v234
    v_and_b32 v41, 0xffff0000, v234
    v_lshlrev_b32 v42, 16, v235
    v_and_b32 v43, 0xffff0000, v235
    v_lshlrev_b32 v32, 16, v218
    v_and_b32 v33, 0xffff0000, v218
    v_lshlrev_b32 v34, 16, v219
    v_and_b32 v35, 0xffff0000, v219
    v_lshlrev_b32 v36, 16, v226
    v_and_b32 v37, 0xffff0000, v226
    v_lshlrev_b32 v38, 16, v227
    v_and_b32 v39, 0xffff0000, v227
    v_pk_add_f32 v[32:33], v[32:33], v[40:41]
    v_pk_add_f32 v[34:35], v[34:35], v[42:43]
    v_pk_add_f32 v[36:37], v[36:37], v[40:41]
    v_pk_add_f32 v[38:39], v[38:39], v[42:43]
    v_mov_b32 v40, 0
    v_mov_b32 v41, 0
    v_mov_b32 v42, 0
    v_mov_b32 v43, 0
    v_mov_b32 v44, 0
    v_mov_b32 v45, 0
    v_mov_b32 v46, 0
    v_mov_b32 v47, 0
    v_lshlrev_b32 v56, 16, v236
    v_and_b32 v57, 0xffff0000, v236
    v_lshlrev_b32 v58, 16, v237
    v_and_b32 v59, 0xffff0000, v237
    v_lshlrev_b32 v48, 16, v220
    v_and_b32 v49, 0xffff0000, v220
    v_lshlrev_b32 v50, 16, v221
    v_and_b32 v51, 0xffff0000, v221
    v_lshlrev_b32 v52, 16, v228
    v_and_b32 v53, 0xffff0000, v228
    v_lshlrev_b32 v54, 16, v229
    v_and_b32 v55, 0xffff0000, v229
    v_pk_add_f32 v[48:49], v[48:49], v[56:57]
    v_pk_add_f32 v[50:51], v[50:51], v[58:59]
    v_pk_add_f32 v[52:53], v[52:53], v[56:57]
    v_pk_add_f32 v[54:55], v[54:55], v[58:59]
    v_mov_b32 v56, 0
    v_mov_b32 v57, 0
    v_mov_b32 v58, 0
    v_mov_b32 v59, 0
    v_mov_b32 v60, 0
    v_mov_b32 v61, 0
    v_mov_b32 v62, 0
    v_mov_b32 v63, 0
    v_lshlrev_b32 v72, 16, v238
    v_and_b32 v73, 0xffff0000, v238
    v_lshlrev_b32 v74, 16, v239
    v_and_b32 v75, 0xffff0000, v239
    v_lshlrev_b32 v64, 16, v222
    v_and_b32 v65, 0xffff0000, v222
    v_lshlrev_b32 v66, 16, v223
    v_and_b32 v67, 0xffff0000, v223
    v_lshlrev_b32 v68, 16, v230
    v_and_b32 v69, 0xffff0000, v230
    v_lshlrev_b32 v70, 16, v231
    v_and_b32 v71, 0xffff0000, v231
    v_pk_add_f32 v[64:65], v[64:65], v[72:73]
    v_pk_add_f32 v[66:67], v[66:67], v[74:75]
    v_pk_add_f32 v[68:69], v[68:69], v[72:73]
    v_pk_add_f32 v[70:71], v[70:71], v[74:75]
    v_mov_b32 v72, 0
    v_mov_b32 v73, 0
    v_mov_b32 v74, 0
    v_mov_b32 v75, 0
    v_mov_b32 v76, 0
    v_mov_b32 v77, 0
    v_mov_b32 v78, 0
    v_mov_b32 v79, 0
    s_lshl_b32 s7, s70, 11
    s_lshl_b32 s3, s71, 7
    s_add_u32 s7, s7, s3
    s_add_u32 s7, s7, 31621120
    v_mov_b32 v244, 147472
    v_mov_b32 v245, 1
    v_mov_b32 v246, s74
    v_mov_b32 v247, s75
    s_mov_b64 exec, 1
    s_waitcnt vmcnt(0)
    ds_add_rtn_u32 v245, v244, v245
    v_mov_b32 v244, s7
    s_waitcnt lgkmcnt(0)
    v_readfirstlane_b32 s3, v245
    s_nop 0
    s_cmp_lg_u32 s3, 11
    s_cbranch_scc1 FIN3
    global_store_dwordx2 v244, v[246:247], s[68:69] sc1
FIN3:
    s_mov_b64 exec, -1
    s_mov_b32 s42, 1
    s_mov_b32 s46, 4294868992
    s_mov_b32 s47, 49152
    s_mov_b32 s43, 28
    s_waitcnt lgkmcnt(0)
    s_barrier
    ds_read_b128 v[80:83], v4 offset:0
    ds_read_b128 v[84:87], v4 offset:2048
    ds_read_b128 v[88:91], v5 offset:0
    ds_read_b128 v[92:95], v5 offset:2048
    ds_read_b64_tr_b16 v[112:113], v9 offset:0
    ds_read_b64_tr_b16 v[114:115], v9 offset:512
    ds_read_b64_tr_b16 v[116:117], v10 offset:0
    ds_read_b64_tr_b16 v[118:119], v10 offset:512
    ds_read_b64_tr_b16 v[120:121], v11 offset:0
    ds_read_b64_tr_b16 v[122:123], v11 offset:512
    s_waitcnt lgkmcnt(4)
    v_mfma_f32_16x16x32_bf16 v[24:27], v[112:115], v[88:91], v[24:27]
    ds_read_b64_tr_b16 v[124:125], v12 offset:0
    ds_read_b64_tr_b16 v[126:127], v12 offset:512
    v_mfma_f32_16x16x32_bf16 v[28:31], v[112:115], v[92:95], v[28:31]
    ds_read_b128 v[96:99], v4 offset:1024
    ds_read_b128 v[100:103], v4 offset:3072
    v_mfma_f32_16x16x32_bf16 v[16:19], v[112:115], v[80:83], v[16:19]
    ds_read_b128 v[104:107], v5 offset:1024
    ds_read_b128 v[108:111], v5 offset:3072
    v_mfma_f32_16x16x32_bf16 v[20:23], v[112:115], v[84:87], v[20:23]
    ds_read_b64_tr_b16 v[128:129], v9 offset:4096
    ds_read_b64_tr_b16 v[130:131], v9 offset:4608
    s_waitcnt lgkmcnt(10)
    v_mfma_f32_16x16x32_bf16 v[36:39], v[116:119], v[84:87], v[36:39]
    ds_read_b64_tr_b16 v[132:133], v10 offset:4096
    ds_read_b64_tr_b16 v[134:135], v10 offset:4608
    v_mfma_f32_16x16x32_bf16 v[32:35], v[116:119], v[80:83], v[32:35]
    ds_read_b64_tr_b16 v[136:137], v11 offset:4096
    ds_read_b64_tr_b16 v[138:139], v11 offset:4608
    v_mfma_f32_16x16x32_bf16 v[44:47], v[116:119], v[92:95], v[44:47]
    s_waitcnt lgkmcnt(8)
    ds_read_b64_tr_b16 v[140:141], v12 offset:4096
    ds_read_b64_tr_b16 v[142:143], v12 offset:4608
    v_mfma_f32_16x16x32_bf16 v[40:43], v[116:119], v[88:91], v[40:43]
    s_cmp_eq_u32 s42, 2
    s_cselect_b32 s44, s46, s47
    s_waitcnt lgkmcnt(14)
    v_mfma_f32_16x16x32_bf16 v[56:59], v[120:123], v[88:91], v[56:59]
    v_add_u32 v4, s44, v4
    v_add_u32 v5, s44, v5
    v_mfma_f32_16x16x32_bf16 v[60:63], v[120:123], v[92:95], v[60:63]
    v_add_u32 v9, s44, v9
    v_add_u32 v10, s44, v10
    v_mfma_f32_16x16x32_bf16 v[48:51], v[120:123], v[80:83], v[48:51]
    v_add_u32 v11, s44, v11
    v_add_u32 v12, s44, v12
    v_mfma_f32_16x16x32_bf16 v[52:55], v[120:123], v[84:87], v[52:55]
    s_waitcnt lgkmcnt(12)
    v_mfma_f32_16x16x32_bf16 v[68:71], v[124:127], v[84:87], v[68:71]
    v_mfma_f32_16x16x32_bf16 v[64:67], v[124:127], v[80:83], v[64:67]
    v_mfma_f32_16x16x32_bf16 v[76:79], v[124:127], v[92:95], v[76:79]
    v_mfma_f32_16x16x32_bf16 v[72:75], v[124:127], v[88:91], v[72:75]
    s_branch P4_h1
P4_loop:
    s_waitcnt lgkmcnt(0)
    v_mfma_f32_16x16x32_bf16 v[24:27], v[112:115], v[88:91], v[24:27]
    ds_read_b128 v[96:99], v4 offset:1024
    ds_read_b128 v[100:103], v4 offset:3072
    v_mfma_f32_16x16x32_bf16 v[28:31], v[112:115], v[92:95], v[28:31]
    ds_read_b128 v[104:107], v5 offset:1024
    ds_read_b128 v[108:111], v5 offset:3072
    v_mfma_f32_16x16x32_bf16 v[16:19], v[112:115], v[80:83], v[16:19]
    ds_read_b64_tr_b16 v[128:129], v9 offset:4096
    ds_read_b64_tr_b16 v[130:131], v9 offset:4608
    v_mfma_f32_16x16x32_bf16 v[20:23], v[112:115], v[84:87], v[20:23]
    ds_read_b64_tr_b16 v[132:133], v10 offset:4096
    ds_read_b64_tr_b16 v[134:135], v10 offset:4608
    v_mfma_f32_16x16x32_bf16 v[36:39], v[116:119], v[84:87], v[36:39]
    ds_read_b64_tr_b16 v[136:137], v11 offset:4096
    v_mfma_f32_16x16x32_bf16 v[32:35], v[116:119], v[80:83], v[32:35]
    ds_read_b64_tr_b16 v[138:139], v11 offset:4608
    v_mfma_f32_16x16x32_bf16 v[44:47], v[116:119], v[92:95], v[44:47]
    ds_read_b64_tr_b16 v[140:141], v12 offset:4096
    v_mfma_f32_16x16x32_bf16 v[40:43], v[116:119], v[88:91], v[40:43]
    ds_read_b64_tr_b16 v[142:143], v12 offset:4608
    v_mfma_f32_16x16x32_bf16 v[56:59], v[120:123], v[88:91], v[56:59]
    s_cmp_eq_u32 s42, 2
    v_mfma_f32_16x16x32_bf16 v[60:63], v[120:123], v[92:95], v[60:63]
    s_cselect_b32 s44, s46, s47
    v_mfma_f32_16x16x32_bf16 v[48:51], v[120:123], v[80:83], v[48:51]
    v_add_u32 v4, s44, v4
    v_mfma_f32_16x16x32_bf16 v[52:55], v[120:123], v[84:87], v[52:55]
    v_add_u32 v5, s44, v5
    v_mfma_f32_16x16x32_bf16 v[68:71], v[124:127], v[84:87], v[68:71]
    v_add_u32 v9, s44, v9
    v_mfma_f32_16x16x32_bf16 v[64:67], v[124:127], v[80:83], v[64:67]
    v_add_u32 v10, s44, v10
    v_mfma_f32_16x16x32_bf16 v[76:79], v[124:127], v[92:95], v[76:79]
    v_add_u32 v11, s44, v11
    v_mfma_f32_16x16x32_bf16 v[72:75], v[124:127], v[88:91], v[72:75]
    v_add_u32 v12, s44, v12
P4_h1:
    s_waitcnt lgkmcnt(0)
    v_mfma_f32_16x16x32_bf16 v[24:27], v[128:131], v[104:107], v[24:27]
    s_barrier
    v_mfma_f32_16x16x32_bf16 v[28:31], v[128:131], v[108:111], v[28:31]
    ds_read_b128 v[80:83], v4 offset:0
    ds_read_b128 v[84:87], v4 offset:2048
    v_mfma_f32_16x16x32_bf16 v[44:47], v[132:135], v[108:111], v[44:47]
    ds_read_b128 v[88:91], v5 offset:0
    v_mfma_f32_16x16x32_bf16 v[40:43], v[132:135], v[104:107], v[40:43]
    ds_read_b128 v[92:95], v5 offset:2048
    v_mfma_f32_16x16x32_bf16 v[56:59], v[136:139], v[104:107], v[56:59]
    ds_read_b64_tr_b16 v[112:113], v9 offset:0
    v_mfma_f32_16x16x32_bf16 v[60:63], v[136:139], v[108:111], v[60:63]
    ds_read_b64_tr_b16 v[114:115], v9 offset:512
    v_mfma_f32_16x16x32_bf16 v[76:79], v[140:143], v[108:111], v[76:79]
    ds_read_b64_tr_b16 v[116:117], v10 offset:0
    v_mfma_f32_16x16x32_bf16 v[72:75], v[140:143], v[104:107], v[72:75]
    ds_read_b64_tr_b16 v[118:119], v10 offset:512
    v_mfma_f32_16x16x32_bf16 v[64:67], v[140:143], v[96:99], v[64:67]
    ds_read_b64_tr_b16 v[120:121], v11 offset:0
    v_mfma_f32_16x16x32_bf16 v[68:71], v[140:143], v[100:103], v[68:71]
    ds_read_b64_tr_b16 v[122:123], v11 offset:512
    v_mfma_f32_16x16x32_bf16 v[52:55], v[136:139], v[100:103], v[52:55]
    ds_read_b64_tr_b16 v[124:125], v12 offset:0
    v_mfma_f32_16x16x32_bf16 v[48:51], v[136:139], v[96:99], v[48:51]
    ds_read_b64_tr_b16 v[126:127], v12 offset:512
    v_mfma_f32_16x16x32_bf16 v[32:35], v[132:135], v[96:99], v[32:35]
    s_add_u32 s42, s42, 1
    v_mfma_f32_16x16x32_bf16 v[36:39], v[132:135], v[100:103], v[36:39]
    s_cmp_eq_u32 s42, 3
    v_mfma_f32_16x16x32_bf16 v[20:23], v[128:131], v[100:103], v[20:23]
    s_cselect_b32 s42, 0, s42
    v_mfma_f32_16x16x32_bf16 v[16:19], v[128:131], v[96:99], v[16:19]
    s_sub_u32 s43, s43, 1
    s_waitcnt lgkmcnt(0)
    v_mfma_f32_16x16x32_bf16 v[24:27], v[112:115], v[88:91], v[24:27]
    ds_read_b128 v[96:99], v4 offset:1024
    ds_read_b128 v[100:103], v4 offset:3072
    v_mfma_f32_16x16x32_bf16 v[28:31], v[112:115], v[92:95], v[28:31]
    ds_read_b128 v[104:107], v5 offset:1024
    ds_read_b128 v[108:111], v5 offset:3072
    v_mfma_f32_16x16x32_bf16 v[16:19], v[112:115], v[80:83], v[16:19]
    ds_read_b64_tr_b16 v[128:129], v9 offset:4096
    ds_read_b64_tr_b16 v[130:131], v9 offset:4608
    v_mfma_f32_16x16x32_bf16 v[20:23], v[112:115], v[84:87], v[20:23]
    ds_read_b64_tr_b16 v[132:133], v10 offset:4096
    ds_read_b64_tr_b16 v[134:135], v10 offset:4608
    v_mfma_f32_16x16x32_bf16 v[36:39], v[116:119], v[84:87], v[36:39]
    ds_read_b64_tr_b16 v[136:137], v11 offset:4096
    v_mfma_f32_16x16x32_bf16 v[32:35], v[116:119], v[80:83], v[32:35]
    ds_read_b64_tr_b16 v[138:139], v11 offset:4608
    v_mfma_f32_16x16x32_bf16 v[44:47], v[116:119], v[92:95], v[44:47]
    ds_read_b64_tr_b16 v[140:141], v12 offset:4096
    v_mfma_f32_16x16x32_bf16 v[40:43], v[116:119], v[88:91], v[40:43]
    ds_read_b64_tr_b16 v[142:143], v12 offset:4608
    v_mfma_f32_16x16x32_bf16 v[56:59], v[120:123], v[88:91], v[56:59]
    s_cmp_eq_u32 s42, 2
    v_mfma_f32_16x16x32_bf16 v[60:63], v[120:123], v[92:95], v[60:63]
    s_cselect_b32 s44, s46, s47
    v_mfma_f32_16x16x32_bf16 v[48:51], v[120:123], v[80:83], v[48:51]
    v_add_u32 v4, s44, v4
    v_mfma_f32_16x16x32_bf16 v[52:55], v[120:123], v[84:87], v[52:55]
    v_add_u32 v5, s44, v5
    v_mfma_f32_16x16x32_bf16 v[68:71], v[124:127], v[84:87], v[68:71]
    v_add_u32 v9, s44, v9
    v_mfma_f32_16x16x32_bf16 v[64:67], v[124:127], v[80:83], v[64:67]
    v_add_u32 v10, s44, v10
    v_mfma_f32_16x16x32_bf16 v[76:79], v[124:127], v[92:95], v[76:79]
    v_add_u32 v11, s44, v11
    v_mfma_f32_16x16x32_bf16 v[72:75], v[124:127], v[88:91], v[72:75]
    v_add_u32 v12, s44, v12
    s_waitcnt lgkmcnt(0)
    v_mfma_f32_16x16x32_bf16 v[24:27], v[128:131], v[104:107], v[24:27]
    s_barrier
    v_mfma_f32_16x16x32_bf16 v[28:31], v[128:131], v[108:111], v[28:31]
    ds_read_b128 v[80:83], v4 offset:0
    ds_read_b128 v[84:87], v4 offset:2048
    v_mfma_f32_16x16x32_bf16 v[44:47], v[132:135], v[108:111], v[44:47]
    ds_read_b128 v[88:91], v5 offset:0
    ds_read_b128 v[92:95], v5 offset:2048
    v_mfma_f32_16x16x32_bf16 v[40:43], v[132:135], v[104:107], v[40:43]
    ds_read_b64_tr_b16 v[112:113], v9 offset:0
    v_mfma_f32_16x16x32_bf16 v[56:59], v[136:139], v[104:107], v[56:59]
    ds_read_b64_tr_b16 v[114:115], v9 offset:512
    v_mfma_f32_16x16x32_bf16 v[60:63], v[136:139], v[108:111], v[60:63]
    ds_read_b64_tr_b16 v[116:117], v10 offset:0
    v_mfma_f32_16x16x32_bf16 v[76:79], v[140:143], v[108:111], v[76:79]
    ds_read_b64_tr_b16 v[118:119], v10 offset:512
    v_mfma_f32_16x16x32_bf16 v[72:75], v[140:143], v[104:107], v[72:75]
    ds_read_b64_tr_b16 v[120:121], v11 offset:0
    v_mfma_f32_16x16x32_bf16 v[64:67], v[140:143], v[96:99], v[64:67]
    ds_read_b64_tr_b16 v[122:123], v11 offset:512
    v_mfma_f32_16x16x32_bf16 v[68:71], v[140:143], v[100:103], v[68:71]
    ds_read_b64_tr_b16 v[124:125], v12 offset:0
    v_mfma_f32_16x16x32_bf16 v[52:55], v[136:139], v[100:103], v[52:55]
    ds_read_b64_tr_b16 v[126:127], v12 offset:512
    v_mfma_f32_16x16x32_bf16 v[48:51], v[136:139], v[96:99], v[48:51]
    s_add_u32 s42, s42, 1
    v_mfma_f32_16x16x32_bf16 v[32:35], v[132:135], v[96:99], v[32:35]
    s_cmp_eq_u32 s42, 3
    v_mfma_f32_16x16x32_bf16 v[36:39], v[132:135], v[100:103], v[36:39]
    s_cselect_b32 s42, 0, s42
    v_mfma_f32_16x16x32_bf16 v[20:23], v[128:131], v[100:103], v[20:23]
    s_sub_u32 s43, s43, 1
    v_mfma_f32_16x16x32_bf16 v[16:19], v[128:131], v[96:99], v[16:19]
    s_cmp_lg_u32 s43, 0
    s_cbranch_scc1 P4_loop
CT_e4:
    s_waitcnt lgkmcnt(0)
    v_mov_b32 v83, s74
    v_mov_b32 v87, s74
    v_mov_b32 v91, s74
    v_mov_b32 v95, s74
    v_mov_b32 v99, s74
    v_mov_b32 v103, s74
    v_cvt_pk_bf16_f32 v80, v24, v25
    v_cvt_pk_bf16_f32 v81, v26, v27
    v_cvt_pk_bf16_f32 v82, v40, v41
    v_cvt_pk_bf16_f32 v84, v42, v43
    buffer_store_dwordx4 v[80:83], v146, s[20:23], s76 offen offset:0 sc1
    v_cvt_pk_bf16_f32 v85, v56, v57
    v_cvt_pk_bf16_f32 v86, v58, v59
    buffer_store_dwordx4 v[84:87], v146, s[20:23], s76 offen offset:1024 sc1
    v_cvt_pk_bf16_f32 v88, v72, v73
    v_cvt_pk_bf16_f32 v89, v74, v75
    v_cvt_pk_bf16_f32 v90, v28, v29
    v_cvt_pk_bf16_f32 v92, v30, v31
    buffer_store_dwordx4 v[88:91], v146, s[20:23], s76 offen offset:2048 sc1
    v_cvt_pk_bf16_f32 v93, v44, v45
    v_cvt_pk_bf16_f32 v94, v46, v47
    buffer_store_dwordx4 v[92:95], v146, s[20:23], s76 offen offset:3072 sc1
    v_cvt_pk_bf16_f32 v96, v60, v61
    v_cvt_pk_bf16_f32 v97, v62, v63
    v_cvt_pk_bf16_f32 v98, v76, v77
    v_cvt_pk_bf16_f32 v100, v78, v79
    buffer_store_dwordx4 v[96:99], v146, s[20:23], s77 offen offset:0 sc1
    buffer_store_dwordx4 v[100:103], v146, s[20:23], s77 offen offset:1024 sc1
    s_mov_b32 s3, 0x40000
    s_mov_b32 exec_lo, 0
    s_mov_b32 exec_hi, 0x80000000
P4_hl:
    buffer_load_dword v112, v146, s[20:23], s79 offen offset:1036 sc1
    s_sub_u32 s3, s3, 1
    s_waitcnt vmcnt(0)
    v_cmp_eq_u32 vcc, s74, v112
    s_cmp_eq_u32 s3, 0
    s_cselect_b32 s3, 1, s3
    s_cbranch_scc1 P4_hd
    s_cmp_eq_u32 vcc_hi, 0
    s_cbranch_scc1 P4_hl
P4_hd:
    s_mov_b64 exec, -1
P4_pl:
    buffer_load_dwordx4 v[112:115], v146, s[20:23], s78 offen offset:0 sc1
    buffer_load_dwordx4 v[116:119], v146, s[20:23], s78 offen offset:1024 sc1
    buffer_load_dwordx4 v[120:123], v146, s[20:23], s78 offen offset:2048 sc1
    buffer_load_dwordx4 v[124:127], v146, s[20:23], s78 offen offset:3072 sc1
    buffer_load_dwordx4 v[128:131], v146, s[20:23], s79 offen offset:0 sc1
    buffer_load_dwordx4 v[132:135], v146, s[20:23], s79 offen offset:1024 sc1
    s_sub_u32 s3, s3, 1
    s_mov_b64 s[36:37], -1
    s_waitcnt vmcnt(5)
    v_cmp_eq_u32 vcc, s74, v115
    s_nop 0
    s_and_b64 s[36:37], s[36:37], vcc
    s_waitcnt vmcnt(4)
    v_cmp_eq_u32 vcc, s74, v119
    s_nop 0
    s_and_b64 s[36:37], s[36:37], vcc
    s_waitcnt vmcnt(3)
    v_cmp_eq_u32 vcc, s74, v123
    s_nop 0
    s_and_b64 s[36:37], s[36:37], vcc
    s_waitcnt vmcnt(2)
    v_cmp_eq_u32 vcc, s74, v127
    s_nop 0
    s_and_b64 s[36:37], s[36:37], vcc
    s_waitcnt vmcnt(1)
    v_cmp_eq_u32 vcc, s74, v131
    s_nop 0
    s_and_b64 s[36:37], s[36:37], vcc
    s_waitcnt vmcnt(0)
    v_cmp_eq_u32 vcc, s74, v135
    s_nop 0
    s_and_b64 s[36:37], s[36:37], vcc
    s_cmp_eq_u32 s3, 0
    s_cbranch_scc1 P4_pd
    s_cmp_eq_u64 s[36:37], -1
    s_cbranch_scc0 P4_pl
P4_pd:
    v_lshlrev_b32 v104, 16, v112
    v_and_b32 v105, 0xffff0000, v112
    v_lshlrev_b32 v106, 16, v113
    v_and_b32 v107, 0xffff0000, v113
    v_pk_add_f32 v[16:17], v[16:17], v[104:105]
    v_pk_add_f32 v[18:19], v[18:19], v[106:107]
    v_cvt_pk_bf16_f32 v80, v16, v17
    v_cvt_pk_bf16_f32 v81, v18, v19
    v_lshlrev_b32 v108, 16, v114
    v_and_b32 v109, 0xffff0000, v114
    v_lshlrev_b32 v110, 16, v116
    v_and_b32 v111, 0xffff0000, v116
    v_pk_add_f32 v[32:33], v[32:33], v[108:109]
    v_pk_add_f32 v[34:35], v[34:35], v[110:111]
    v_cvt_pk_bf16_f32 v82, v32, v33
    v_cvt_pk_bf16_f32 v83, v34, v35
    s_nop 0
    v_permlane16_swap_b32 v80, v82
    v_permlane16_swap_b32 v81, v83
    buffer_store_dwordx4 v[80:83], v144, s[16:19], 0 offen offset:0 sc1
    v_lshlrev_b32 v104, 16, v117
    v_and_b32 v105, 0xffff0000, v117
    v_lshlrev_b32 v106, 16, v118
    v_and_b32 v107, 0xffff0000, v118
    v_pk_add_f32 v[48:49], v[48:49], v[104:105]
    v_pk_add_f32 v[50:51], v[50:51], v[106:107]
    v_cvt_pk_bf16_f32 v84, v48, v49
    v_cvt_pk_bf16_f32 v85, v50, v51
    v_lshlrev_b32 v108, 16, v120
    v_and_b32 v109, 0xffff0000, v120
    v_lshlrev_b32 v110, 16, v121
    v_and_b32 v111, 0xffff0000, v121
    v_pk_add_f32 v[64:65], v[64:65], v[108:109]
    v_pk_add_f32 v[66:67], v[66:67], v[110:111]
    v_cvt_pk_bf16_f32 v86, v64, v65
    v_cvt_pk_bf16_f32 v87, v66, v67
    s_nop 0
    v_permlane16_swap_b32 v84, v86
    v_permlane16_swap_b32 v85, v87
    buffer_store_dwordx4 v[84:87], v144, s[16:19], 0 offen offset:64 sc1
    v_lshlrev_b32 v104, 16, v122
    v_and_b32 v105, 0xffff0000, v122
    v_lshlrev_b32 v106, 16, v124
    v_and_b32 v107, 0xffff0000, v124
    v_pk_add_f32 v[20:21], v[20:21], v[104:105]
    v_pk_add_f32 v[22:23], v[22:23], v[106:107]
    v_cvt_pk_bf16_f32 v88, v20, v21
    v_cvt_pk_bf16_f32 v89, v22, v23
    v_lshlrev_b32 v108, 16, v125
    v_and_b32 v109, 0xffff0000, v125
    v_lshlrev_b32 v110, 16, v126
    v_and_b32 v111, 0xffff0000, v126
    v_pk_add_f32 v[36:37], v[36:37], v[108:109]
    v_pk_add_f32 v[38:39], v[38:39], v[110:111]
    v_cvt_pk_bf16_f32 v90, v36, v37
    v_cvt_pk_bf16_f32 v91, v38, v39
    s_nop 0
    v_permlane16_swap_b32 v88, v90
    v_permlane16_swap_b32 v89, v91
    buffer_store_dwordx4 v[88:91], v144, s[16:19], s45 offen offset:0 sc1
    v_lshlrev_b32 v104, 16, v128
    v_and_b32 v105, 0xffff0000, v128
    v_lshlrev_b32 v106, 16, v129
    v_and_b32 v107, 0xffff0000, v129
    v_pk_add_f32 v[52:53], v[52:53], v[104:105]
    v_pk_add_f32 v[54:55], v[54:55], v[106:107]
    v_cvt_pk_bf16_f32 v92, v52, v53
    v_cvt_pk_bf16_f32 v93, v54, v55
    v_lshlrev_b32 v108, 16, v130
    v_and_b32 v109, 0xffff0000, v130
    v_lshlrev_b32 v110, 16, v132
    v_and_b32 v111, 0xffff0000, v132
    v_pk_add_f32 v[68:69], v[68:69], v[108:109]
    v_pk_add_f32 v[70:71], v[70:71], v[110:111]
    v_cvt_pk_bf16_f32 v94, v68, v69
    v_cvt_pk_bf16_f32 v95, v70, v71
    s_nop 0
    v_permlane16_swap_b32 v92, v94
    v_permlane16_swap_b32 v93, v95
    buffer_store_dwordx4 v[92:95], v144, s[16:19], s45 offen offset:64 sc1
KEND:
    s_endpgm
LOADER:
    s_sub_u32 s6, s6, 4
    v_lshrrev_b32 v2, 3, v1
    v_and_b32 v3, 7, v1
    v_bfe_u32 v5, v1, 4, 1
    s_and_b32 s7, s6, 1
    s_lshl_b32 s7, s7, 1
    v_or_b32 v5, s7, v5
    v_lshlrev_b32 v5, 1, v5
    v_xor_b32 v5, v3, v5
    v_lshlrev_b32 v5, 4, v5
    s_lshl_b32 s7, s71, 7
    v_add_u32 v5, s7, v5
    s_lshl_b32 s7, s6, 3
    v_add_u32 v6, s7, v2
    v_mul_u32_u24 v6, 6144, v6
    v_add_u32 v5, v5, v6
    v_add_u32 v24, 0, v5
    v_add_u32 v25, 196608, v5
    v_add_u32 v26, 2048, v5
    v_add_u32 v27, 198656, v5
    v_add_u32 v28, 4096, v5
    v_add_u32 v29, 200704, v5
    s_and_b32 s41, s70, 7
    s_lshl_b32 s41, s41, 1
    s_mul_i32 s40, s41, 393216
    s_mul_i32 s42, s6, 1024
    s_add_u32 s42, s42, 24576
    s_mov_b32 s43, 0
    s_and_b32 s3, s6, 1
    s_lshl_b32 s7, s3, 2
    v_lshrrev_b32 v4, 4, v1
    v_or_b32 v4, s7, v4
    v_xor_b32 v4, v3, v4
    v_lshlrev_b32 v4, 4, v4
    s_lshl_b32 s7, s70, 7
    s_lshl_b32 s34, s6, 3
    s_add_u32 s7, s7, s34
    s_sub_u32 s7, s7, 16
    v_add_u32 v5, s7, v2
    v_max_i32 v5, 0, v5
    v_lshl_add_u32 v8, v5, 11, v4
    v_add_u32 v5, s7, v2
    v_add_u32 v5, 32, v5
    v_lshl_add_u32 v9, v5, 11, v4
    v_add_u32 v5, s7, v2
    v_add_u32 v5, 64, v5
    v_lshl_add_u32 v10, v5, 11, v4
    v_add_u32 v5, s7, v2
    v_add_u32 v5, 96, v5
    v_lshl_add_u32 v11, v5, 11, v4
    v_add_u32 v5, s7, v2
    v_add_u32 v5, 128, v5
    v_lshl_add_u32 v12, v5, 11, v4
    s_and_b32 s21, s70, 7
    s_lshl_b32 s21, s21, 1
    s_mul_i32 s20, s21, 128
    s_mul_i32 s22, s6, 1024
    s_mov_b32 s23, 0
    s_waitcnt lgkmcnt(0)
    s_mov_b32 s16, s50
    s_mov_b32 s17, s51
    s_mov_b32 s18, 6291456
    s_mov_b32 s19, 0x20000
    s_or_b32 s3, s2, s6
    s_cmp_lg_u32 s3, 0
    s_cbranch_scc1 LD_nopub
    s_memrealtime s[34:35]
    v_mov_b32 v6, 0
    s_waitcnt lgkmcnt(0)
    s_or_b32 s34, s34, 1
    v_mov_b32 v4, s34
    v_mov_b32 v5, s35
    s_mov_b64 exec, 1
    global_store_dwordx2 v6, v[4:5], s[66:67] sc1
    s_mov_b64 exec, -1
LD_nopub:
    s_lshl_b32 s3, s2, 2
    s_add_u32 s3, s3, s6
    s_mul_i32 s3, s3, 7168
    s_add_u32 s88, s60, s3
    s_addc_u32 s89, s61, 0
    s_add_u32 s32, s56, s3
    s_addc_u32 s33, s57, 0
    s_mov_b32 s8, s48
    s_mov_b32 s9, s49
    s_mov_b32 s10, 4194304
    s_mov_b32 s11, 0x20000
    s_cmp_ge_u32 s6, 2
    s_cbranch_scc1 LD1_y
    s_add_u32 m0, s42, 0
    s_nop 0
    buffer_load_dwordx4 v24, s[16:19], s40 offen lds
    s_add_u32 s21, s21, 1
    s_add_u32 m0, s22, 0
    s_nop 0
    buffer_load_dwordx4 v8, s[8:11], s20 offen lds
    s_cmp_eq_u32 s21, 16
    s_cselect_b32 s21, 0, s21
    s_add_u32 m0, s42, 4096
    s_nop 0
    buffer_load_dwordx4 v25, s[16:19], s40 offen lds
    s_mul_i32 s90, s21, 128
    s_add_u32 m0, s22, 4096
    s_nop 0
    buffer_load_dwordx4 v9, s[8:11], s20 offen lds
    s_mul_i32 s91, s21, 393216
    s_add_u32 m0, s42, 8192
    s_nop 0
    buffer_load_dwordx4 v26, s[16:19], s40 offen lds
    s_add_u32 s23, s23, 1
    s_add_u32 m0, s22, 8192
    s_nop 0
    buffer_load_dwordx4 v10, s[8:11], s20 offen lds
    s_cmp_eq_u32 s23, 3
    s_cselect_b32 s93, 147456, 0
    s_cselect_b32 s23, 0, s23
    s_add_u32 m0, s42, 12288
    s_nop 0
    buffer_load_dwordx4 v27, s[16:19], s40 offen lds
    s_sub_u32 s93, 49152, s93
    s_add_u32 m0, s22, 12288
    s_nop 0
    buffer_load_dwordx4 v11, s[8:11], s20 offen lds
    s_add_u32 m0, s42, 16384
    s_nop 0
    buffer_load_dwordx4 v28, s[16:19], s40 offen lds
    s_add_u32 m0, s22, 16384
    s_nop 0
    buffer_load_dwordx4 v12, s[8:11], s20 offen lds
    s_add_u32 m0, s42, 20480
    s_nop 0
    buffer_load_dwordx4 v29, s[16:19], s40 offen lds
    s_mov_b32 s20, s90
    s_mov_b32 s40, s91
    s_add_u32 s22, s22, s93
    s_add_u32 s42, s42, s93
    s_mov_b32 s12, s52
    s_mov_b32 s13, s53
    s_mov_b32 s14, 2097152
    s_mov_b32 s15, 0x20000
    v_bfe_u32 v5, v1, 4, 1
    s_and_b32 s7, s6, 1
    s_lshl_b32 s7, s7, 1
    v_or_b32 v5, s7, v5
    v_lshlrev_b32 v5, 1, v5
    v_xor_b32 v5, v3, v5
    v_lshlrev_b32 v5, 4, v5
    s_lshl_b32 s7, s71, 7
    v_add_u32 v5, s7, v5
    s_lshl_b32 s7, s6, 3
    v_add_u32 v6, s7, v2
    v_mul_u32_u24 v6, 2048, v6
    v_add_u32 v5, v5, v6
    v_add_u32 v16, 0, v5
    v_add_u32 v17, 65536, v5
    v_add_u32 v18, 131072, v5
    v_add_u32 v19, 196608, v5
    s_and_b32 s37, s70, 7
    s_mul_i32 s37, s37, 2
    s_lshr_b32 s37, s37, 3
    s_lshl_b32 s37, s37, 2
    s_add_u32 s46, s70, s71
    s_add_u32 s7, s37, s46
    s_and_b32 s7, s7, 3
    s_andn2_b32 s36, s37, 3
    s_add_u32 s36, s36, s7
    s_mul_i32 s36, s36, 262144
    s_mul_i32 s38, s6, 1024
    s_add_u32 s38, s38, 81920
    s_mov_b32 s39, 1
    v_and_b32 v134, 15, v1
    v_lshrrev_b32 v132, 2, v134
    v_lshrrev_b32 v133, 4, v1
    v_lshl_add_u32 v132, v133, 3, v132
    v_mul_u32_u24 v132, 128, v132
    v_and_b32 v134, 3, v1
    v_lshl_add_u32 v132, v134, 3, v132
    v_and_b32 v133, 1, v133
    v_bfe_u32 v134, v1, 3, 1
    v_lshl_or_b32 v133, v133, 1, v134
    v_xor_b32 v133, s6, v133
    v_lshl_add_u32 v132, v133, 5, v132
    v_add_u32 v132, 24576, v132
    v_add_u32 v135, 49152, v132
    v_mov_b32 v128, 0x3f803f80
    v_mov_b32 v129, 0x3f803f80
    v_mov_b32 v130, 0x3f803f80
    v_mov_b32 v131, 0x3f803f80
    v_mov_b32 v64, 0
    v_mov_b32 v65, 0
    v_mov_b32 v66, 0
    v_mov_b32 v67, 0
    v_mov_b32 v68, 0
    v_mov_b32 v69, 0
    v_mov_b32 v70, 0
    v_mov_b32 v71, 0
    v_mov_b32 v72, 0
    v_mov_b32 v73, 0
    v_mov_b32 v74, 0
    v_mov_b32 v75, 0
    v_mov_b32 v76, 0
    v_mov_b32 v77, 0
    v_mov_b32 v78, 0
    v_mov_b32 v79, 0
    s_add_u32 s24, s68, 1048576
    s_addc_u32 s25, s69, 0
    s_mov_b32 s26, 196608
    s_mov_b32 s27, 0x20000
    s_mov_b32 s28, s68
    s_mov_b32 s29, s69
    s_mov_b32 s30, 16384
    s_mov_b32 s31, 0x20000
    v_lshrrev_b32 v134, 4, v1
    v_lshlrev_b32 v134, 4, v134
    s_mul_i32 s3, s70, 12288
    s_mul_i32 s7, s71, 256
    s_add_u32 s3, s3, s7
    s_lshl_b32 s7, s6, 6
    s_add_u32 s3, s3, s7
    v_add_u32 v134, s3, v134
    v_and_b32 v133, 15, v1
    v_cmp_eq_u32 vcc, 0, v133
    v_mov_b32 v133, 0x7ffffff0
    s_nop 0
    v_cndmask_b32 v136, v133, v134, vcc
    s_lshl_b32 s3, s6, 6
    v_add_u32 v157, s3, v1
    s_mov_b32 s80, 4096
    s_mov_b32 s81, 8192
    s_lshl_b32 s3, s70, 10
    s_lshl_b32 s7, s71, 6
    s_add_u32 s3, s3, s7
    s_lshl_b32 s7, s6, 4
    s_add_u32 s3, s3, s7
    v_mov_b32 v134, s3
    v_cmp_eq_u32 vcc, 0, v1
    s_nop 1
    v_cndmask_b32 v138, v133, v134, vcc
    v_cmp_gt_u32 vcc, 48, v1
    v_lshrrev_b32 v134, 4, v1
    v_lshlrev_b32 v134, 12, v134
    v_and_b32 v139, 15, v1
    v_lshl_add_u32 v134, v139, 4, v134
    s_lshl_b32 s3, s71, 8
    v_add_u32 v134, s3, v134
    v_cndmask_b32 v139, v133, v134, vcc
    s_lshl_b32 s3, s70, 7
    s_sub_u32 s3, s3, 16
    v_add_u32 v134, s3, v157
    v_max_i32 v134, 0, v134
    v_lshlrev_b32 v134, 3, v134
    v_cmp_gt_u32 vcc, 144, v157
    s_nop 1
    v_cndmask_b32 v156, v133, v134, vcc
    s_and_b32 s82, s70, 8
    s_mul_i32 s82, s82, 12288
    s_mul_i32 s3, s6, 24576
    s_add_u32 s82, s82, s3
    v_lshlrev_b32 v166, 4, v1
    s_lshl_b32 s3, s6, 10
    s_add_u32 s3, s3, 153856
    v_add_u32 v166, s3, v166
    s_add_u32 s84, s68, 31457280
    s_addc_u32 s85, s69, 0
    s_mov_b32 s86, 65536
    s_mov_b32 s87, 0x20000
    v_cmp_eq_u32 vcc, 0, v1
    s_lshl_b32 s7, s70, 2
    s_add_u32 s7, s7, s6
    s_lshl_b32 s7, s7, 3
    s_lshl_b32 s3, s71, 9
    s_add_u32 s7, s7, s3
    s_add_u32 s7, s7, 40960
    v_mov_b32 v134, s7
    v_cndmask_b32 v160, v133, v134, vcc
    s_lshl_b32 s7, s71, 2
    s_add_u32 s7, s7, s6
    s_lshl_b32 s7, s7, 3
    s_lshl_b32 s3, s70, 9
    s_add_u32 s7, s7, s3
    s_add_u32 s7, s7, 0
    v_mov_b32 v134, s7
    v_cndmask_b32 v164, v133, v134, vcc
    v_lshlrev_b32 v168, 3, v1
    s_lshl_b32 s3, s71, 9
    s_add_u32 s3, s3, 31498240
    s_lshl_b32 s7, s70, 9
    s_add_u32 s7, s7, 31457280
    v_add_u32 v169, s7, v168
    v_or_b32 v170, 56, v1
    v_lshlrev_b32 v170, 3, v170
    s_cmp_eq_u32 s70, 0
    s_cselect_b32 s34, 0, 512
    s_sub_u32 s7, s7, s34
    v_add_u32 v170, s7, v170
    v_and_b32 v168, 0xff, v168
    s_and_b32 s7, s70, 8
    s_lshl_b32 s7, s7, 5
    s_add_u32 s3, s3, s7
    v_add_u32 v168, s3, v168
    s_lshl_b32 s3, s6, 4
    s_add_u32 s3, s3, 147520
    v_mov_b32 v133, s3
    v_mov_b32 v32, 0
    v_mov_b32 v33, 147488
    s_lshl_b32 s3, s2, 2
    s_add_u32 s3, s3, s6
    s_lshl_b32 s3, s3, 13
    s_add_u32 s3, s3, 50331648
    v_lshlrev_b32 v180, 4, v1
    v_add_u32 v180, s3, v180
    v_add_u32 v181, 4096, v180
    v_mov_b32 v184, 0
    v_mov_b32 v185, 0
    v_mov_b32 v186, 0
    v_mov_b32 v187, 0
    s_add_u32 m0, s42, 0
    s_nop 0
    buffer_load_dwordx4 v24, s[16:19], s40 offen lds
    s_add_u32 s21, s21, 1
    s_add_u32 m0, s22, 0
    s_nop 0
    buffer_load_dwordx4 v8, s[8:11], s20 offen lds
    s_cmp_eq_u32 s21, 16
    s_cselect_b32 s21, 0, s21
    s_add_u32 m0, s42, 4096
    s_nop 0
    buffer_load_dwordx4 v25, s[16:19], s40 offen lds
    s_mul_i32 s90, s21, 128
    s_add_u32 m0, s22, 4096
    s_nop 0
    buffer_load_dwordx4 v9, s[8:11], s20 offen lds
    s_mul_i32 s91, s21, 393216
    s_add_u32 m0, s42, 8192
    s_nop 0
    buffer_load_dwordx4 v26, s[16:19], s40 offen lds
    s_waitcnt vmcnt(5)
    s_barrier
    s_add_u32 s23, s23, 1
    s_add_u32 m0, s22, 8192
    s_nop 0
    buffer_load_dwordx4 v10, s[8:11], s20 offen lds
    s_cmp_eq_u32 s23, 3
    s_cselect_b32 s93, 147456, 0
    s_cselect_b32 s23, 0, s23
    s_add_u32 m0, s42, 12288
    s_nop 0
    buffer_load_dwordx4 v27, s[16:19], s40 offen lds
    s_sub_u32 s93, 49152, s93
    s_add_u32 m0, s22, 12288
    s_nop 0
    buffer_load_dwordx4 v11, s[8:11], s20 offen lds
    s_add_u32 m0, s42, 16384
    s_nop 0
    buffer_load_dwordx4 v28, s[16:19], s40 offen lds
    s_add_u32 m0, s22, 16384
    s_nop 0
    buffer_load_dwordx4 v12, s[8:11], s20 offen lds
    s_add_u32 m0, s42, 20480
    s_nop 0
    buffer_load_dwordx4 v29, s[16:19], s40 offen lds
    s_mov_b32 s20, s90
    s_mov_b32 s40, s91
    s_add_u32 s22, s22, s93
    s_add_u32 s42, s42, s93
    s_add_u32 m0, s42, 0
    s_nop 0
    buffer_load_dwordx4 v24, s[16:19], s40 offen lds
    s_add_u32 s21, s21, 1
    s_cmp_eq_u32 s21, 16
    s_cselect_b32 s21, 0, s21
    s_add_u32 m0, s22, 0
    s_nop 0
    buffer_load_dwordx4 v8, s[8:11], s20 offen lds
    s_mul_i32 s90, s21, 128
    s_mul_i32 s91, s21, 393216
    s_add_u32 m0, s42, 4096
    s_nop 0
    buffer_load_dwordx4 v25, s[16:19], s40 offen lds
    s_add_u32 s23, s23, 1
    s_cmp_eq_u32 s23, 3
    s_cselect_b32 s93, 147456, 0
    s_cselect_b32 s23, 0, s23
    s_add_u32 m0, s22, 4096
    s_nop 0
    buffer_load_dwordx4 v9, s[8:11], s20 offen lds
    s_sub_u32 s93, 49152, s93
    ds_read_b128 v[140:143], v133
    s_add_u32 m0, s42, 8192
    s_nop 0
    buffer_load_dwordx4 v26, s[16:19], s40 offen lds
    ds_read_b64_tr_b16 v[96:97], v132 offset:0
    ds_read_b64_tr_b16 v[98:99], v132 offset:512
    s_add_u32 m0, s22, 8192
    s_nop 0
    buffer_load_dwordx4 v10, s[8:11], s20 offen lds
    ds_read_b64_tr_b16 v[100:101], v132 offset:8192
    ds_read_b64_tr_b16 v[102:103], v132 offset:8704
    s_add_u32 m0, s42, 12288
    s_nop 0
    buffer_load_dwordx4 v27, s[16:19], s40 offen lds
    ds_read_b64_tr_b16 v[104:105], v132 offset:16384
    ds_read_b64_tr_b16 v[106:107], v132 offset:16896
    s_add_u32 m0, s22, 12288
    s_nop 0
    buffer_load_dwordx4 v11, s[8:11], s20 offen lds
    ds_read_b64_tr_b16 v[112:113], v132 offset:4096
    ds_read_b64_tr_b16 v[114:115], v132 offset:4608
    s_add_u32 m0, s42, 16384
    s_nop 0
    buffer_load_dwordx4 v28, s[16:19], s40 offen lds
    ds_read_b64_tr_b16 v[116:117], v132 offset:12288
    ds_read_b64_tr_b16 v[118:119], v132 offset:12800
    s_add_u32 m0, s22, 16384
    s_nop 0
    buffer_load_dwordx4 v12, s[8:11], s20 offen lds
    ds_read_b64_tr_b16 v[120:121], v132 offset:20480
    ds_read_b64_tr_b16 v[122:123], v132 offset:20992
    s_add_u32 m0, s42, 20480
    s_nop 0
    buffer_load_dwordx4 v29, s[16:19], s40 offen lds
    s_mov_b32 s20, s90
    s_mov_b32 s40, s91
    s_add_u32 s22, s22, s93
    s_add_u32 s42, s42, s93
    s_waitcnt vmcnt(11) lgkmcnt(0)
    s_barrier
    s_setprio 3
    s_add_u32 m0, s42, 0
    s_nop 0
    buffer_load_dwordx4 v24, s[16:19], s40 offen lds
    s_add_u32 s21, s21, 1
    s_cmp_eq_u32 s21, 16
    s_cselect_b32 s21, 0, s21
    s_mul_i32 s90, s21, 128
    s_add_u32 m0, s22, 0
    s_nop 0
    buffer_load_dwordx4 v8, s[8:11], s20 offen lds
    s_mul_i32 s91, s21, 393216
    s_add_u32 s23, s23, 1
    s_cmp_eq_u32 s23, 3
    s_cselect_b32 s93, 147456, 0
    s_cselect_b32 s23, 0, s23
    s_add_u32 m0, s42, 4096
    s_nop 0
    buffer_load_dwordx4 v25, s[16:19], s40 offen lds
    s_sub_u32 s93, 49152, s93
    s_mov_b64 exec, 1
    buffer_store_dwordx4 v[140:143], v138, s[28:31], 0 offen sc1
    global_load_dwordx2 v[34:35], v32, s[66:67] sc1
    s_mov_b64 exec, -1
    v_mfma_f32_16x16x32_bf16 v[64:67], v[96:99], v[128:131], v[64:67]
    s_add_u32 m0, s22, 4096
    s_nop 0
    buffer_load_dwordx4 v9, s[8:11], s20 offen lds
    v_mfma_f32_16x16x32_bf16 v[68:71], v[100:103], v[128:131], v[68:71]
    v_mfma_f32_16x16x32_bf16 v[72:75], v[104:107], v[128:131], v[72:75]
    v_mfma_f32_16x16x32_bf16 v[64:67], v[112:115], v[128:131], v[64:67]
    s_add_u32 m0, s42, 8192
    s_nop 0
    buffer_load_dwordx4 v26, s[16:19], s40 offen lds
    v_mfma_f32_16x16x32_bf16 v[68:71], v[116:119], v[128:131], v[68:71]
    v_mfma_f32_16x16x32_bf16 v[72:75], v[120:123], v[128:131], v[72:75]
    ds_read_b64_tr_b16 v[96:97], v135 offset:0
    s_add_u32 m0, s22, 8192
    s_nop 0
    buffer_load_dwordx4 v10, s[8:11], s20 offen lds
    ds_read_b64_tr_b16 v[98:99], v135 offset:512
    ds_read_b64_tr_b16 v[100:101], v135 offset:8192
    ds_read_b64_tr_b16 v[102:103], v135 offset:8704
    s_add_u32 m0, s42, 12288
    s_nop 0
    buffer_load_dwordx4 v27, s[16:19], s40 offen lds
    ds_read_b64_tr_b16 v[104:105], v135 offset:16384
    ds_read_b64_tr_b16 v[106:107], v135 offset:16896
    ds_read_b64_tr_b16 v[112:113], v135 offset:4096
    s_add_u32 m0, s22, 12288
    s_nop 0
    buffer_load_dwordx4 v11, s[8:11], s20 offen lds
    ds_read_b64_tr_b16 v[114:115], v135 offset:4608
    ds_read_b64_tr_b16 v[116:117], v135 offset:12288
    ds_read_b64_tr_b16 v[118:119], v135 offset:12800
    s_add_u32 m0, s42, 16384
    s_nop 0
    buffer_load_dwordx4 v28, s[16:19], s40 offen lds
    ds_read_b64_tr_b16 v[120:121], v135 offset:20480
    ds_read_b64_tr_b16 v[122:123], v135 offset:20992
    s_add_u32 m0, s22, 16384
    s_nop 0
    buffer_load_dwordx4 v12, s[8:11], s20 offen lds
    s_add_u32 m0, s42, 20480
    s_nop 0
    buffer_load_dwordx4 v29, s[16:19], s40 offen lds
    s_mov_b32 s20, s90
    s_mov_b32 s40, s91
    s_add_u32 s22, s22, s93
    s_add_u32 s42, s42, s93
    s_setprio 0
    s_waitcnt vmcnt(11) lgkmcnt(0)
    s_barrier
    s_setprio 3
    s_add_u32 m0, s42, 0
    s_nop 0
    buffer_load_dwordx4 v24, s[16:19], s40 offen lds
    s_add_u32 s21, s21, 1
    s_cmp_eq_u32 s21, 16
    s_cselect_b32 s21, 0, s21
    s_add_u32 m0, s22, 0
    s_nop 0
    buffer_load_dwordx4 v8, s[8:11], s20 offen lds
    s_mul_i32 s90, s21, 128
    s_mul_i32 s91, s21, 393216
    s_add_u32 m0, s42, 4096
    s_nop 0
    buffer_load_dwordx4 v25, s[16:19], s40 offen lds
    s_add_u32 s23, s23, 1
    s_cmp_eq_u32 s23, 3
    s_cselect_b32 s93, 147456, 0
    s_cselect_b32 s23, 0, s23
    s_add_u32 m0, s22, 4096
    s_nop 0
    buffer_load_dwordx4 v9, s[8:11], s20 offen lds
    s_sub_u32 s93, 49152, s93
    v_mfma_f32_16x16x32_bf16 v[64:67], v[96:99], v[128:131], v[64:67]
    s_add_u32 m0, s42, 8192
    s_nop 0
    buffer_load_dwordx4 v26, s[16:19], s40 offen lds
    v_mfma_f32_16x16x32_bf16 v[68:71], v[100:103], v[128:131], v[68:71]
    v_mfma_f32_16x16x32_bf16 v[72:75], v[104:107], v[128:131], v[72:75]
    s_add_u32 m0, s22, 8192
    s_nop 0
    buffer_load_dwordx4 v10, s[8:11], s20 offen lds
    v_mfma_f32_16x16x32_bf16 v[64:67], v[112:115], v[128:131], v[64:67]
    v_mfma_f32_16x16x32_bf16 v[68:71], v[116:119], v[128:131], v[68:71]
    s_add_u32 m0, s42, 12288
    s_nop 0
    buffer_load_dwordx4 v27, s[16:19], s40 offen lds
    v_mfma_f32_16x16x32_bf16 v[72:75], v[120:123], v[128:131], v[72:75]
    s_add_u32 m0, s22, 12288
    s_nop 0
    buffer_load_dwordx4 v11, s[8:11], s20 offen lds
    s_add_u32 m0, s42, 16384
    s_nop 0
    buffer_load_dwordx4 v28, s[16:19], s40 offen lds
    s_add_u32 m0, s22, 16384
    s_nop 0
    buffer_load_dwordx4 v12, s[8:11], s20 offen lds
    s_add_u32 m0, s42, 20480
    s_nop 0
    buffer_load_dwordx4 v29, s[16:19], s40 offen lds
    s_mov_b32 s20, s90
    s_mov_b32 s40, s91
    s_add_u32 s22, s22, s93
    s_add_u32 s42, s42, s93
    s_setprio 0
    s_waitcnt vmcnt(11)
    s_barrier
    s_add_u32 m0, s42, 0
    s_nop 0
    buffer_load_dwordx4 v24, s[16:19], s40 offen lds
    s_add_u32 s21, s21, 1
    s_add_u32 m0, s22, 0
    s_nop 0
    buffer_load_dwordx4 v8, s[8:11], s20 offen lds
    s_cmp_eq_u32 s21, 16
    s_cselect_b32 s21, 0, s21
    s_add_u32 m0, s42, 4096
    s_nop 0
    buffer_load_dwordx4 v25, s[16:19], s40 offen lds
    s_mul_i32 s90, s21, 128
    s_add_u32 m0, s22, 4096
    s_nop 0
    buffer_load_dwordx4 v9, s[8:11], s20 offen lds
    s_mul_i32 s91, s21, 393216
    s_add_u32 m0, s42, 8192
    s_nop 0
    buffer_load_dwordx4 v26, s[16:19], s40 offen lds
    s_add_u32 s23, s23, 1
    s_add_u32 m0, s22, 8192
    s_nop 0
    buffer_load_dwordx4 v10, s[8:11], s20 offen lds
    s_cmp_eq_u32 s23, 3
    s_cselect_b32 s93, 147456, 0
    s_cselect_b32 s23, 0, s23
    s_add_u32 m0, s42, 12288
    s_nop 0
    buffer_load_dwordx4 v27, s[16:19], s40 offen lds
    s_sub_u32 s93, 49152, s93
    s_add_u32 m0, s22, 12288
    s_nop 0
    buffer_load_dwordx4 v11, s[8:11], s20 offen lds
    s_mov_b32 exec_lo, 0x10001
    s_mov_b32 exec_hi, 0x10001
    buffer_store_dwordx4 v[64:67], v136, s[24:27], 0 offen sc1
    s_mov_b64 exec, -1
    s_add_u32 m0, s42, 16384
    s_nop 0
    buffer_load_dwordx4 v28, s[16:19], s40 offen lds
    s_mov_b32 exec_lo, 0x10001
    s_mov_b32 exec_hi, 0x10001
    buffer_store_dwordx4 v[68:71], v136, s[24:27], s80 offen sc1
    s_mov_b64 exec, -1
    s_add_u32 m0, s22, 16384
    s_nop 0
    buffer_load_dwordx4 v12, s[8:11], s20 offen lds
    s_mov_b32 exec_lo, 0x10001
    s_mov_b32 exec_hi, 0x10001
    buffer_store_dwordx4 v[72:75], v136, s[24:27], s81 offen sc1
    s_mov_b64 exec, -1
    s_add_u32 m0, s42, 20480
    s_nop 0
    buffer_load_dwordx4 v29, s[16:19], s40 offen lds
    s_mov_b32 s20, s90
    s_mov_b32 s40, s91
    s_add_u32 s22, s22, s93
    s_add_u32 s42, s42, s93
    s_mov_b32 s3, 0x40000
LD1x_nl:
    v_readfirstlane_b32 s74, v34
    v_readfirstlane_b32 s75, v35
    s_cmp_lg_u32 s74, 0
    s_cbranch_scc1 LD1x_nd
    global_load_dwordx2 v[34:35], v32, s[66:67] sc1
    s_waitcnt vmcnt(0)
    s_sub_u32 s3, s3, 1
    s_cmp_lg_u32 s3, 0
    s_cbranch_scc1 LD1x_nl
LD1x_nd:
    v_mov_b32 v162, s74
    v_mov_b32 v163, s75
    ds_write_b64 v33, v[162:163]
    s_waitcnt vmcnt(11)
    s_barrier
    s_mov_b32 s44, 1
LD1_lt0x:
    s_add_u32 m0, s42, 0
    s_nop 0
    buffer_load_dwordx4 v24, s[16:19], s40 offen lds
    s_add_u32 s21, s21, 1
    s_add_u32 m0, s22, 0
    s_nop 0
    buffer_load_dwordx4 v8, s[8:11], s20 offen lds
    s_cmp_eq_u32 s21, 16
    s_cselect_b32 s21, 0, s21
    s_add_u32 m0, s42, 4096
    s_nop 0
    buffer_load_dwordx4 v25, s[16:19], s40 offen lds
    s_mul_i32 s90, s21, 128
    s_add_u32 m0, s22, 4096
    s_nop 0
    buffer_load_dwordx4 v9, s[8:11], s20 offen lds
    s_mul_i32 s91, s21, 393216
    s_add_u32 m0, s42, 8192
    s_nop 0
    buffer_load_dwordx4 v26, s[16:19], s40 offen lds
    s_add_u32 s23, s23, 1
    s_add_u32 m0, s22, 8192
    s_nop 0
    buffer_load_dwordx4 v10, s[8:11], s20 offen lds
    s_cmp_eq_u32 s23, 3
    s_cselect_b32 s93, 147456, 0
    s_cselect_b32 s23, 0, s23
    s_add_u32 m0, s42, 12288
    s_nop 0
    buffer_load_dwordx4 v27, s[16:19], s40 offen lds
    s_sub_u32 s93, 49152, s93
    s_add_u32 m0, s22, 12288
    s_nop 0
    buffer_load_dwordx4 v11, s[8:11], s20 offen lds
    s_add_u32 m0, s42, 16384
    s_nop 0
    buffer_load_dwordx4 v28, s[16:19], s40 offen lds
    s_add_u32 m0, s22, 16384
    s_nop 0
    buffer_load_dwordx4 v12, s[8:11], s20 offen lds
    s_add_u32 m0, s42, 20480
    s_nop 0
    buffer_load_dwordx4 v29, s[16:19], s40 offen lds
    s_mov_b32 s20, s90
    s_mov_b32 s40, s91
    s_add_u32 s22, s22, s93
    s_add_u32 s42, s42, s93
    s_waitcnt vmcnt(11)
    s_barrier
    s_sub_u32 s44, s44, 1
    s_cmp_lg_u32 s44, 0
    s_cbranch_scc1 LD1_lt0x
    s_add_u32 m0, s42, 0
    s_nop 0
    buffer_load_dwordx4 v24, s[16:19], s40 offen lds
    s_add_u32 s21, s21, 1
    s_add_u32 m0, s22, 0
    s_nop 0
    buffer_load_dwordx4 v8, s[8:11], s20 offen lds
    s_cmp_eq_u32 s21, 16
    s_cselect_b32 s21, 0, s21
    s_add_u32 m0, s42, 4096
    s_nop 0
    buffer_load_dwordx4 v25, s[16:19], s40 offen lds
    s_mul_i32 s90, s21, 128
    s_add_u32 m0, s22, 4096
    s_nop 0
    buffer_load_dwordx4 v9, s[8:11], s20 offen lds
    s_mul_i32 s91, s21, 393216
    s_add_u32 m0, s42, 8192
    s_nop 0
    buffer_load_dwordx4 v26, s[16:19], s40 offen lds
    s_add_u32 s23, s23, 1
    s_add_u32 m0, s22, 8192
    s_nop 0
    buffer_load_dwordx4 v10, s[8:11], s20 offen lds
    s_cmp_eq_u32 s23, 3
    s_cselect_b32 s93, 147456, 0
    s_cselect_b32 s23, 0, s23
    s_add_u32 m0, s42, 12288
    s_nop 0
    buffer_load_dwordx4 v27, s[16:19], s40 offen lds
    s_sub_u32 s93, 49152, s93
    s_add_u32 m0, s22, 12288
    s_nop 0
    buffer_load_dwordx4 v11, s[8:11], s20 offen lds
    s_mov_b64 exec, 1
    buffer_store_dwordx2 v[162:163], v160, s[84:87], 0 offen sc1
    buffer_store_dwordx2 v[162:163], v164, s[84:87], 0 offen sc1
    s_mov_b64 exec, -1
    s_add_u32 m0, s42, 16384
    s_nop 0
    buffer_load_dwordx4 v28, s[16:19], s40 offen lds
    s_add_u32 m0, s22, 16384
    s_nop 0
    buffer_load_dwordx4 v12, s[8:11], s20 offen lds
    s_add_u32 m0, s42, 20480
    s_nop 0
    buffer_load_dwordx4 v29, s[16:19], s40 offen lds
    s_mov_b32 s20, s90
    s_mov_b32 s40, s91
    s_add_u32 s22, s22, s93
    s_add_u32 s42, s42, s93
    s_waitcnt vmcnt(11)
    s_barrier
    s_mov_b32 s44, 5
LD1_lt1x:
    s_add_u32 m0, s42, 0
    s_nop 0
    buffer_load_dwordx4 v24, s[16:19], s40 offen lds
    s_add_u32 s21, s21, 1
    s_add_u32 m0, s22, 0
    s_nop 0
    buffer_load_dwordx4 v8, s[8:11], s20 offen lds
    s_cmp_eq_u32 s21, 16
    s_cselect_b32 s21, 0, s21
    s_add_u32 m0, s42, 4096
    s_nop 0
    buffer_load_dwordx4 v25, s[16:19], s40 offen lds
    s_mul_i32 s90, s21, 128
    s_add_u32 m0, s22, 4096
    s_nop 0
    buffer_load_dwordx4 v9, s[8:11], s20 offen lds
    s_mul_i32 s91, s21, 393216
    s_add_u32 m0, s42, 8192
    s_nop 0
    buffer_load_dwordx4 v26, s[16:19], s40 offen lds
    s_add_u32 s23, s23, 1
    s_add_u32 m0, s22, 8192
    s_nop 0
    buffer_load_dwordx4 v10, s[8:11], s20 offen lds
    s_cmp_eq_u32 s23, 3
    s_cselect_b32 s93, 147456, 0
    s_cselect_b32 s23, 0, s23
    s_add_u32 m0, s42, 12288
    s_nop 0
    buffer_load_dwordx4 v27, s[16:19], s40 offen lds
    s_sub_u32 s93, 49152, s93
    s_add_u32 m0, s22, 12288
    s_nop 0
    buffer_load_dwordx4 v11, s[8:11], s20 offen lds
    s_add_u32 m0, s42, 16384
    s_nop 0
    buffer_load_dwordx4 v28, s[16:19], s40 offen lds
    s_add_u32 m0, s22, 16384
    s_nop 0
    buffer_load_dwordx4 v12, s[8:11], s20 offen lds
    s_add_u32 m0, s42, 20480
    s_nop 0
    buffer_load_dwordx4 v29, s[16:19], s40 offen lds
    s_mov_b32 s20, s90
    s_mov_b32 s40, s91
    s_add_u32 s22, s22, s93
    s_add_u32 s42, s42, s93
    s_waitcnt vmcnt(11)
    s_barrier
    s_sub_u32 s44, s44, 1
    s_cmp_lg_u32 s44, 0
    s_cbranch_scc1 LD1_lt1x
    s_add_u32 m0, s42, 0
    s_nop 0
    buffer_load_dwordx4 v24, s[16:19], s40 offen lds
    s_add_u32 s21, s21, 1
    s_add_u32 m0, s22, 0
    s_nop 0
    buffer_load_dwordx4 v8, s[8:11], s20 offen lds
    s_cmp_eq_u32 s21, 16
    s_cselect_b32 s21, 0, s21
    s_add_u32 m0, s42, 4096
    s_nop 0
    buffer_load_dwordx4 v25, s[16:19], s40 offen lds
    s_mul_i32 s90, s21, 128
    s_add_u32 m0, s22, 4096
    s_nop 0
    buffer_load_dwordx4 v9, s[8:11], s20 offen lds
    s_mul_i32 s91, s21, 393216
    s_add_u32 m0, s42, 8192
    s_nop 0
    buffer_load_dwordx4 v26, s[16:19], s40 offen lds
    s_add_u32 s23, s23, 1
    s_add_u32 m0, s22, 8192
    s_nop 0
    buffer_load_dwordx4 v10, s[8:11], s20 offen lds
    s_cmp_eq_u32 s23, 3
    s_cselect_b32 s93, 147456, 0
    s_cselect_b32 s23, 0, s23
    s_add_u32 m0, s42, 12288
    s_nop 0
    buffer_load_dwordx4 v27, s[16:19], s40 offen lds
    s_sub_u32 s93, 49152, s93
    s_add_u32 m0, s22, 12288
    s_nop 0
    buffer_load_dwordx4 v11, s[8:11], s20 offen lds
    global_load_dwordx2 v[172:173], v168, s[68:69] sc1
    s_add_u32 m0, s42, 16384
    s_nop 0
    buffer_load_dwordx4 v28, s[16:19], s40 offen lds
    global_load_dwordx2 v[174:175], v169, s[68:69] sc1
    s_add_u32 m0, s22, 16384
    s_nop 0
    buffer_load_dwordx4 v12, s[8:11], s20 offen lds
    global_load_dwordx2 v[176:177], v170, s[68:69] sc1
    s_add_u32 m0, s42, 20480
    s_nop 0
    buffer_load_dwordx4 v29, s[16:19], s40 offen lds
    s_mov_b32 s20, s90
    s_mov_b32 s40, s91
    s_add_u32 s22, s22, s93
    s_add_u32 s42, s42, s93
    s_waitcnt vmcnt(11)
    s_barrier
    s_mov_b32 s44, 1
LD1_lt2x:
    s_add_u32 m0, s42, 0
    s_nop 0
    buffer_load_dwordx4 v24, s[16:19], s40 offen lds
    s_add_u32 s21, s21, 1
    s_add_u32 m0, s22, 0
    s_nop 0
    buffer_load_dwordx4 v8, s[8:11], s20 offen lds
    s_cmp_eq_u32 s21, 16
    s_cselect_b32 s21, 0, s21
    s_add_u32 m0, s42, 4096
    s_nop 0
    buffer_load_dwordx4 v25, s[16:19], s40 offen lds
    s_mul_i32 s90, s21, 128
    s_add_u32 m0, s22, 4096
    s_nop 0
    buffer_load_dwordx4 v9, s[8:11], s20 offen lds
    s_mul_i32 s91, s21, 393216
    s_add_u32 m0, s42, 8192
    s_nop 0
    buffer_load_dwordx4 v26, s[16:19], s40 offen lds
    s_add_u32 s23, s23, 1
    s_add_u32 m0, s22, 8192
    s_nop 0
    buffer_load_dwordx4 v10, s[8:11], s20 offen lds
    s_cmp_eq_u32 s23, 3
    s_cselect_b32 s93, 147456, 0
    s_cselect_b32 s23, 0, s23
    s_add_u32 m0, s42, 12288
    s_nop 0
    buffer_load_dwordx4 v27, s[16:19], s40 offen lds
    s_sub_u32 s93, 49152, s93
    s_add_u32 m0, s22, 12288
    s_nop 0
    buffer_load_dwordx4 v11, s[8:11], s20 offen lds
    s_add_u32 m0, s42, 16384
    s_nop 0
    buffer_load_dwordx4 v28, s[16:19], s40 offen lds
    s_add_u32 m0, s22, 16384
    s_nop 0
    buffer_load_dwordx4 v12, s[8:11], s20 offen lds
    s_add_u32 m0, s42, 20480
    s_nop 0
    buffer_load_dwordx4 v29, s[16:19], s40 offen lds
    s_mov_b32 s20, s90
    s_mov_b32 s40, s91
    s_add_u32 s22, s22, s93
    s_add_u32 s42, s42, s93
    s_waitcnt vmcnt(11)
    s_barrier
    s_sub_u32 s44, s44, 1
    s_cmp_lg_u32 s44, 0
    s_cbranch_scc1 LD1_lt2x
    s_add_u32 m0, s42, 0
    s_nop 0
    buffer_load_dwordx4 v24, s[16:19], s40 offen lds
    s_add_u32 s21, s21, 1
    s_add_u32 m0, s22, 0
    s_nop 0
    buffer_load_dwordx4 v8, s[8:11], s20 offen lds
    s_cmp_eq_u32 s21, 16
    s_cselect_b32 s21, 0, s21
    s_add_u32 m0, s42, 4096
    s_nop 0
    buffer_load_dwordx4 v25, s[16:19], s40 offen lds
    s_mul_i32 s90, s21, 128
    s_add_u32 m0, s22, 4096
    s_nop 0
    buffer_load_dwordx4 v9, s[8:11], s20 offen lds
    s_mul_i32 s91, s21, 393216
    s_add_u32 m0, s42, 8192
    s_nop 0
    buffer_load_dwordx4 v26, s[16:19], s40 offen lds
    s_add_u32 s23, s23, 1
    s_add_u32 m0, s22, 8192
    s_nop 0
    buffer_load_dwordx4 v10, s[8:11], s20 offen lds
    s_cmp_eq_u32 s23, 3
    s_cselect_b32 s93, 147456, 0
    s_cselect_b32 s23, 0, s23
    s_add_u32 m0, s42, 12288
    s_nop 0
    buffer_load_dwordx4 v27, s[16:19], s40 offen lds
    s_sub_u32 s93, 49152, s93
    s_add_u32 m0, s22, 12288
    s_nop 0
    buffer_load_dwordx4 v11, s[8:11], s20 offen lds
    s_add_u32 m0, s42, 16384
    s_nop 0
    buffer_load_dwordx4 v28, s[16:19], s40 offen lds
    s_add_u32 m0, s22, 16384
    s_nop 0
    buffer_load_dwordx4 v12, s[8:11], s20 offen lds
    s_add_u32 m0, s42, 20480
    s_nop 0
    buffer_load_dwordx4 v29, s[16:19], s40 offen lds
    s_mov_b32 s20, s90
    s_mov_b32 s40, s91
    s_add_u32 s22, s22, s93
    s_add_u32 s42, s42, s93
    s_mov_b32 s3, 0x40000
LD1xcs_pl:
    v_cmp_eq_u64 vcc, s[74:75], v[172:173]
    v_cmp_eq_u64 s[34:35], s[74:75], v[174:175]
    s_nop 0
    s_and_b64 vcc, vcc, s[34:35]
    v_cmp_eq_u64 s[34:35], s[74:75], v[176:177]
    s_nop 0
    s_and_b64 vcc, vcc, s[34:35]
    s_cmp_eq_u64 vcc, -1
    s_cbranch_scc1 LD1xcs_pd
    s_sleep 2
    global_load_dwordx2 v[172:173], v168, s[68:69] sc1
    global_load_dwordx2 v[174:175], v169, s[68:69] sc1
    global_load_dwordx2 v[176:177], v170, s[68:69] sc1
    s_waitcnt vmcnt(0)
    s_sub_u32 s3, s3, 1
    s_cmp_lg_u32 s3, 0
    s_cbranch_scc1 LD1xcs_pl
LD1xcs_pd:
    s_waitcnt vmcnt(11)
    s_barrier
    s_mov_b32 s3, s82
    buffer_load_dwordx4 v[64:67], v139, s[24:27], s3 offen sc1
    s_add_u32 s3, s3, 12288
    buffer_load_dwordx4 v[68:71], v139, s[24:27], s3 offen sc1
    buffer_load_dwordx2 v[140:141], v156, s[28:31], 0 offen sc1
    v_lshlrev_b32 v132, 2, v157
    v_add_u32 v133, 153856, v132
    v_add_u32 v132, 149760, v132
    v_lshlrev_b32 v134, 3, v157
    v_add_u32 v134, 147712, v134
    v_mov_b32 v32, 147476
    v_mov_b32 v33, 1
    s_add_u32 m0, s38, 0
    s_nop 0
    buffer_load_dwordx4 v16, s[12:15], s36 offen lds
    s_add_u32 m0, s38, 4096
    s_nop 0
    buffer_load_dwordx4 v17, s[12:15], s36 offen lds
    s_add_u32 m0, s38, 8192
    s_nop 0
    buffer_load_dwordx4 v18, s[12:15], s36 offen lds
    s_add_u32 m0, s38, 12288
    s_nop 0
    buffer_load_dwordx4 v19, s[12:15], s36 offen lds
    s_add_u32 s37, s37, 1
    s_cmp_eq_u32 s37, 8
    s_cselect_b32 s37, 0, s37
    s_add_u32 s7, s37, s46
    s_and_b32 s7, s7, 3
    s_andn2_b32 s36, s37, 3
    s_add_u32 s36, s36, s7
    s_mul_i32 s36, s36, 262144
    s_add_u32 s38, s38, 49152
    s_add_u32 s39, s39, 1
    s_cmp_eq_u32 s39, 3
    s_cselect_b32 s7, 147456, 0
    s_cselect_b32 s39, 0, s39
    s_sub_u32 s38, s38, s7
    s_waitcnt vmcnt(7)
    s_barrier
    s_waitcnt vmcnt(4)
    s_setprio 3
    v_add_f32 v64, v64, v68
    v_add_f32 v65, v65, v69
    v_add_f32 v66, v66, v70
    v_add_f32 v67, v67, v71
    ds_write_b128 v166, v[64:67]
    s_mov_b64 exec, 1
    s_waitcnt lgkmcnt(0)
    ds_add_u32 v32, v33
LD1x_ls:
    ds_read_b32 v34, v32
    s_waitcnt lgkmcnt(0)
    v_readfirstlane_b32 s3, v34
    s_nop 0
    s_cmp_lt_u32 s3, 4
    s_cbranch_scc1 LD1x_ls
    s_mov_b64 exec, -1
    ds_read2st64_b32 v[64:65], v133 offset0:0 offset1:4
    ds_read2st64_b32 v[66:67], v133 offset0:8 offset1:12
    ds_write_b32 v132, v140
    ds_write_b32 v132, v141 offset:1024
    ds_write_b64 v134, v[140:141]
    s_waitcnt lgkmcnt(0)
    v_add_f32 v64, v64, v65
    v_add_f32 v66, v66, v67
    v_add_f32 v64, v64, v66
    ds_write_b32 v132, v64 offset:2048
    s_waitcnt lgkmcnt(0)
    s_setprio 0
    s_getpc_b64 s[34:35]
CT3:
    s_add_u32 s34, s34, CT_e1-CT3
    s_addc_u32 s35, s35, (CT_e1-CT3)>>32
    s_lshl_b32 s3, s6, 7
    v_lshlrev_b32 v49, 9, v1
    v_add_u32 v49, s3, v49
    v_cmp_gt_u32 vcc, CT_e2-CT_e1, v49
    s_nop 0
    s_mov_b64 exec, vcc
    s_cbranch_execz CT3_e
    global_load_dword v48, v49, s[34:35]
CT3_e:
    s_mov_b64 exec, -1
    s_getpc_b64 s[34:35]
CT4:
    s_add_u32 s34, s34, LD1_e-CT4
    s_addc_u32 s35, s35, (LD1_e-CT4)>>32
    s_lshl_b32 s3, s6, 7
    v_lshlrev_b32 v49, 9, v1
    v_add_u32 v49, s3, v49
    v_cmp_gt_u32 vcc, LD2_e-LD1_e, v49
    s_nop 0
    s_mov_b64 exec, vcc
    s_cbranch_execz CT4_e
    global_load_dword v50, v49, s[34:35]
CT4_e:
    s_mov_b64 exec, -1
    s_barrier
    s_add_u32 m0, s38, 0
    s_nop 0
    buffer_load_dwordx4 v16, s[12:15], s36 offen lds
    s_add_u32 m0, s38, 4096
    s_nop 0
    buffer_load_dwordx4 v17, s[12:15], s36 offen lds
    s_add_u32 m0, s38, 8192
    s_nop 0
    buffer_load_dwordx4 v18, s[12:15], s36 offen lds
    s_add_u32 m0, s38, 12288
    s_nop 0
    buffer_load_dwordx4 v19, s[12:15], s36 offen lds
    s_add_u32 s37, s37, 1
    s_cmp_eq_u32 s37, 8
    s_cselect_b32 s37, 0, s37
    s_add_u32 s7, s37, s46
    s_and_b32 s7, s7, 3
    s_andn2_b32 s36, s37, 3
    s_add_u32 s36, s36, s7
    s_mul_i32 s36, s36, 262144
    s_add_u32 s38, s38, 49152
    s_add_u32 s39, s39, 1
    s_cmp_eq_u32 s39, 3
    s_cselect_b32 s7, 147456, 0
    s_cselect_b32 s39, 0, s39
    s_sub_u32 s38, s38, s7
    s_load_dwordx2 s[100:101], s[88:89], 60
    s_load_dwordx2 s[100:101], s[88:89], 188
    s_load_dwordx2 s[100:101], s[88:89], 316
    s_load_dwordx2 s[100:101], s[88:89], 444
    s_load_dwordx2 s[100:101], s[88:89], 572
    s_load_dwordx2 s[100:101], s[88:89], 700
    s_load_dwordx2 s[100:101], s[88:89], 828
    s_add_u32 s88, s88, 896
    s_addc_u32 s89, s89, 0
    s_branch LD1_e
LD1_y:
    s_add_u32 m0, s42, 0
    s_nop 0
    buffer_load_dwordx4 v24, s[16:19], s40 offen lds
    s_add_u32 s21, s21, 1
    s_add_u32 m0, s22, 0
    s_nop 0
    buffer_load_dwordx4 v8, s[8:11], s20 offen lds
    s_cmp_eq_u32 s21, 16
    s_cselect_b32 s21, 0, s21
    s_add_u32 m0, s42, 4096
    s_nop 0
    buffer_load_dwordx4 v25, s[16:19], s40 offen lds
    s_mul_i32 s90, s21, 128
    s_add_u32 m0, s22, 4096
    s_nop 0
    buffer_load_dwordx4 v9, s[8:11], s20 offen lds
    s_mul_i32 s91, s21, 393216
    s_add_u32 m0, s42, 8192
    s_nop 0
    buffer_load_dwordx4 v26, s[16:19], s40 offen lds
    s_add_u32 s23, s23, 1
    s_add_u32 m0, s22, 8192
    s_nop 0
    buffer_load_dwordx4 v10, s[8:11], s20 offen lds
    s_cmp_eq_u32 s23, 3
    s_cselect_b32 s93, 147456, 0
    s_cselect_b32 s23, 0, s23
    s_add_u32 m0, s42, 12288
    s_nop 0
    buffer_load_dwordx4 v27, s[16:19], s40 offen lds
    s_sub_u32 s93, 49152, s93
    s_add_u32 m0, s22, 12288
    s_nop 0
    buffer_load_dwordx4 v11, s[8:11], s20 offen lds
    s_add_u32 m0, s42, 16384
    s_nop 0
    buffer_load_dwordx4 v28, s[16:19], s40 offen lds
    s_add_u32 m0, s42, 20480
    s_nop 0
    buffer_load_dwordx4 v29, s[16:19], s40 offen lds
    s_mov_b32 s20, s90
    s_mov_b32 s40, s91
    s_add_u32 s22, s22, s93
    s_add_u32 s42, s42, s93
    s_mov_b32 s12, s52
    s_mov_b32 s13, s53
    s_mov_b32 s14, 2097152
    s_mov_b32 s15, 0x20000
    v_bfe_u32 v5, v1, 4, 1
    s_and_b32 s7, s6, 1
    s_lshl_b32 s7, s7, 1
    v_or_b32 v5, s7, v5
    v_lshlrev_b32 v5, 1, v5
    v_xor_b32 v5, v3, v5
    v_lshlrev_b32 v5, 4, v5
    s_lshl_b32 s7, s71, 7
    v_add_u32 v5, s7, v5
    s_lshl_b32 s7, s6, 3
    v_add_u32 v6, s7, v2
    v_mul_u32_u24 v6, 2048, v6
    v_add_u32 v5, v5, v6
    v_add_u32 v16, 0, v5
    v_add_u32 v17, 65536, v5
    v_add_u32 v18, 131072, v5
    v_add_u32 v19, 196608, v5
    s_and_b32 s37, s70, 7
    s_mul_i32 s37, s37, 2
    s_lshr_b32 s37, s37, 3
    s_lshl_b32 s37, s37, 2
    s_add_u32 s46, s70, s71
    s_add_u32 s7, s37, s46
    s_and_b32 s7, s7, 3
    s_andn2_b32 s36, s37, 3
    s_add_u32 s36, s36, s7
    s_mul_i32 s36, s36, 262144
    s_mul_i32 s38, s6, 1024
    s_add_u32 s38, s38, 81920
    s_mov_b32 s39, 1
    v_and_b32 v134, 15, v1
    v_lshrrev_b32 v132, 2, v134
    v_lshrrev_b32 v133, 4, v1
    v_lshl_add_u32 v132, v133, 3, v132
    v_mul_u32_u24 v132, 128, v132
    v_and_b32 v134, 3, v1
    v_lshl_add_u32 v132, v134, 3, v132
    v_and_b32 v133, 1, v133
    v_bfe_u32 v134, v1, 3, 1
    v_lshl_or_b32 v133, v133, 1, v134
    v_xor_b32 v133, s6, v133
    v_lshl_add_u32 v132, v133, 5, v132
    v_add_u32 v132, 24576, v132
    v_add_u32 v135, 49152, v132
    v_mov_b32 v128, 0x3f803f80
    v_mov_b32 v129, 0x3f803f80
    v_mov_b32 v130, 0x3f803f80
    v_mov_b32 v131, 0x3f803f80
    v_mov_b32 v64, 0
    v_mov_b32 v65, 0
    v_mov_b32 v66, 0
    v_mov_b32 v67, 0
    v_mov_b32 v68, 0
    v_mov_b32 v69, 0
    v_mov_b32 v70, 0
    v_mov_b32 v71, 0
    v_mov_b32 v72, 0
    v_mov_b32 v73, 0
    v_mov_b32 v74, 0
    v_mov_b32 v75, 0
    v_mov_b32 v76, 0
    v_mov_b32 v77, 0
    v_mov_b32 v78, 0
    v_mov_b32 v79, 0
    s_add_u32 s24, s68, 1048576
    s_addc_u32 s25, s69, 0
    s_mov_b32 s26, 196608
    s_mov_b32 s27, 0x20000
    s_mov_b32 s28, s68
    s_mov_b32 s29, s69
    s_mov_b32 s30, 16384
    s_mov_b32 s31, 0x20000
    v_lshrrev_b32 v134, 4, v1
    v_lshlrev_b32 v134, 4, v134
    s_mul_i32 s3, s70, 12288
    s_mul_i32 s7, s71, 256
    s_add_u32 s3, s3, s7
    s_lshl_b32 s7, s6, 6
    s_add_u32 s3, s3, s7
    v_add_u32 v134, s3, v134
    v_and_b32 v133, 15, v1
    v_cmp_eq_u32 vcc, 0, v133
    v_mov_b32 v133, 0x7ffffff0
    s_nop 0
    v_cndmask_b32 v136, v133, v134, vcc
    s_lshl_b32 s3, s6, 6
    v_add_u32 v157, s3, v1
    s_mov_b32 s80, 4096
    s_mov_b32 s81, 8192
    s_lshl_b32 s3, s70, 10
    s_lshl_b32 s7, s71, 6
    s_add_u32 s3, s3, s7
    s_lshl_b32 s7, s6, 4
    s_add_u32 s3, s3, s7
    v_mov_b32 v134, s3
    v_cmp_eq_u32 vcc, 0, v1
    s_nop 1
    v_cndmask_b32 v138, v133, v134, vcc
    v_cmp_gt_u32 vcc, 48, v1
    v_lshrrev_b32 v134, 4, v1
    v_lshlrev_b32 v134, 12, v134
    v_and_b32 v139, 15, v1
    v_lshl_add_u32 v134, v139, 4, v134
    s_lshl_b32 s3, s71, 8
    v_add_u32 v134, s3, v134
    v_cndmask_b32 v139, v133, v134, vcc
    s_lshl_b32 s3, s70, 7
    s_sub_u32 s3, s3, 16
    v_add_u32 v134, s3, v157
    v_max_i32 v134, 0, v134
    v_lshlrev_b32 v134, 3, v134
    v_cmp_gt_u32 vcc, 144, v157
    s_nop 1
    v_cndmask_b32 v156, v133, v134, vcc
    s_and_b32 s82, s70, 8
    s_mul_i32 s82, s82, 12288
    s_mul_i32 s3, s6, 24576
    s_add_u32 s82, s82, s3
    v_lshlrev_b32 v166, 4, v1
    s_lshl_b32 s3, s6, 10
    s_add_u32 s3, s3, 153856
    v_add_u32 v166, s3, v166
    s_add_u32 s84, s68, 31457280
    s_addc_u32 s85, s69, 0
    s_mov_b32 s86, 65536
    s_mov_b32 s87, 0x20000
    v_cmp_eq_u32 vcc, 0, v1
    s_lshl_b32 s7, s70, 2
    s_add_u32 s7, s7, s6
    s_lshl_b32 s7, s7, 3
    s_lshl_b32 s3, s71, 9
    s_add_u32 s7, s7, s3
    s_add_u32 s7, s7, 40960
    v_mov_b32 v134, s7
    v_cndmask_b32 v160, v133, v134, vcc
    s_lshl_b32 s7, s71, 2
    s_add_u32 s7, s7, s6
    s_lshl_b32 s7, s7, 3
    s_lshl_b32 s3, s70, 9
    s_add_u32 s7, s7, s3
    s_add_u32 s7, s7, 0
    v_mov_b32 v134, s7
    v_cndmask_b32 v164, v133, v134, vcc
    v_lshlrev_b32 v168, 3, v1
    s_lshl_b32 s3, s71, 9
    s_add_u32 s3, s3, 31498240
    s_lshl_b32 s7, s70, 9
    s_add_u32 s7, s7, 31457280
    v_add_u32 v169, s7, v168
    v_or_b32 v170, 56, v1
    v_lshlrev_b32 v170, 3, v170
    s_cmp_eq_u32 s70, 0
    s_cselect_b32 s34, 0, 512
    s_sub_u32 s7, s7, s34
    v_add_u32 v170, s7, v170
    v_and_b32 v168, 0xff, v168
    s_and_b32 s7, s70, 8
    s_lshl_b32 s7, s7, 5
    s_add_u32 s3, s3, s7
    v_add_u32 v168, s3, v168
    s_lshl_b32 s3, s6, 4
    s_add_u32 s3, s3, 147520
    v_mov_b32 v133, s3
    v_mov_b32 v32, 0
    v_mov_b32 v33, 147488
    s_lshl_b32 s3, s2, 2
    s_add_u32 s3, s3, s6
    s_lshl_b32 s3, s3, 13
    s_add_u32 s3, s3, 50331648
    v_lshlrev_b32 v180, 4, v1
    v_add_u32 v180, s3, v180
    v_add_u32 v181, 4096, v180
    v_mov_b32 v184, 0
    v_mov_b32 v185, 0
    v_mov_b32 v186, 0
    v_mov_b32 v187, 0
    s_add_u32 m0, s42, 0
    s_nop 0
    buffer_load_dwordx4 v24, s[16:19], s40 offen lds
    s_add_u32 s21, s21, 1
    s_add_u32 m0, s22, 0
    s_nop 0
    buffer_load_dwordx4 v8, s[8:11], s20 offen lds
    s_cmp_eq_u32 s21, 16
    s_cselect_b32 s21, 0, s21
    s_add_u32 m0, s42, 4096
    s_nop 0
    buffer_load_dwordx4 v25, s[16:19], s40 offen lds
    s_mul_i32 s90, s21, 128
    s_add_u32 m0, s22, 4096
    s_nop 0
    buffer_load_dwordx4 v9, s[8:11], s20 offen lds
    s_mul_i32 s91, s21, 393216
    s_add_u32 m0, s42, 8192
    s_nop 0
    buffer_load_dwordx4 v26, s[16:19], s40 offen lds
    s_waitcnt vmcnt(5)
    s_barrier
    s_add_u32 s23, s23, 1
    s_add_u32 m0, s22, 8192
    s_nop 0
    buffer_load_dwordx4 v10, s[8:11], s20 offen lds
    s_cmp_eq_u32 s23, 3
    s_cselect_b32 s93, 147456, 0
    s_cselect_b32 s23, 0, s23
    s_add_u32 m0, s42, 12288
    s_nop 0
    buffer_load_dwordx4 v27, s[16:19], s40 offen lds
    s_sub_u32 s93, 49152, s93
    s_add_u32 m0, s22, 12288
    s_nop 0
    buffer_load_dwordx4 v11, s[8:11], s20 offen lds
    s_add_u32 m0, s42, 16384
    s_nop 0
    buffer_load_dwordx4 v28, s[16:19], s40 offen lds
    s_add_u32 m0, s42, 20480
    s_nop 0
    buffer_load_dwordx4 v29, s[16:19], s40 offen lds
    s_mov_b32 s20, s90
    s_mov_b32 s40, s91
    s_add_u32 s22, s22, s93
    s_add_u32 s42, s42, s93
    s_add_u32 m0, s42, 0
    s_nop 0
    buffer_load_dwordx4 v24, s[16:19], s40 offen lds
    s_add_u32 s21, s21, 1
    s_cmp_eq_u32 s21, 16
    s_cselect_b32 s21, 0, s21
    s_mul_i32 s90, s21, 128
    s_add_u32 m0, s22, 0
    s_nop 0
    buffer_load_dwordx4 v8, s[8:11], s20 offen lds
    s_mul_i32 s91, s21, 393216
    s_add_u32 s23, s23, 1
    s_cmp_eq_u32 s23, 3
    s_cselect_b32 s93, 147456, 0
    s_cselect_b32 s23, 0, s23
    s_add_u32 m0, s42, 4096
    s_nop 0
    buffer_load_dwordx4 v25, s[16:19], s40 offen lds
    s_sub_u32 s93, 49152, s93
    ds_read_b128 v[140:143], v133
    ds_read_b64_tr_b16 v[96:97], v132 offset:0
    s_add_u32 m0, s22, 4096
    s_nop 0
    buffer_load_dwordx4 v9, s[8:11], s20 offen lds
    ds_read_b64_tr_b16 v[98:99], v132 offset:512
    ds_read_b64_tr_b16 v[100:101], v132 offset:8192
    ds_read_b64_tr_b16 v[102:103], v132 offset:8704
    s_add_u32 m0, s42, 8192
    s_nop 0
    buffer_load_dwordx4 v26, s[16:19], s40 offen lds
    ds_read_b64_tr_b16 v[104:105], v132 offset:16384
    ds_read_b64_tr_b16 v[106:107], v132 offset:16896
    ds_read_b64_tr_b16 v[112:113], v132 offset:4096
    s_add_u32 m0, s22, 8192
    s_nop 0
    buffer_load_dwordx4 v10, s[8:11], s20 offen lds
    ds_read_b64_tr_b16 v[114:115], v132 offset:4608
    ds_read_b64_tr_b16 v[116:117], v132 offset:12288
    ds_read_b64_tr_b16 v[118:119], v132 offset:12800
    s_add_u32 m0, s42, 12288
    s_nop 0
    buffer_load_dwordx4 v27, s[16:19], s40 offen lds
    ds_read_b64_tr_b16 v[120:121], v132 offset:20480
    ds_read_b64_tr_b16 v[122:123], v132 offset:20992
    s_add_u32 m0, s22, 12288
    s_nop 0
    buffer_load_dwordx4 v11, s[8:11], s20 offen lds
    s_add_u32 m0, s42, 16384
    s_nop 0
    buffer_load_dwordx4 v28, s[16:19], s40 offen lds
    s_add_u32 m0, s42, 20480
    s_nop 0
    buffer_load_dwordx4 v29, s[16:19], s40 offen lds
    s_mov_b32 s20, s90
    s_mov_b32 s40, s91
    s_add_u32 s22, s22, s93
    s_add_u32 s42, s42, s93
    s_waitcnt vmcnt(10) lgkmcnt(0)
    s_barrier
    s_setprio 3
    s_add_u32 m0, s42, 0
    s_nop 0
    buffer_load_dwordx4 v24, s[16:19], s40 offen lds
    s_add_u32 s21, s21, 1
    s_cmp_eq_u32 s21, 16
    s_cselect_b32 s21, 0, s21
    s_mul_i32 s90, s21, 128
    s_add_u32 m0, s22, 0
    s_nop 0
    buffer_load_dwordx4 v8, s[8:11], s20 offen lds
    s_mul_i32 s91, s21, 393216
    s_add_u32 s23, s23, 1
    s_cmp_eq_u32 s23, 3
    s_cselect_b32 s93, 147456, 0
    s_cselect_b32 s23, 0, s23
    s_add_u32 m0, s42, 4096
    s_nop 0
    buffer_load_dwordx4 v25, s[16:19], s40 offen lds
    s_sub_u32 s93, 49152, s93
    s_mov_b64 exec, 1
    buffer_store_dwordx4 v[140:143], v138, s[28:31], 0 offen sc1
    global_load_dwordx2 v[34:35], v32, s[66:67] sc1
    s_mov_b64 exec, -1
    v_mfma_f32_16x16x32_bf16 v[64:67], v[96:99], v[128:131], v[64:67]
    s_add_u32 m0, s22, 4096
    s_nop 0
    buffer_load_dwordx4 v9, s[8:11], s20 offen lds
    v_mfma_f32_16x16x32_bf16 v[68:71], v[100:103], v[128:131], v[68:71]
    v_mfma_f32_16x16x32_bf16 v[72:75], v[104:107], v[128:131], v[72:75]
    v_mfma_f32_16x16x32_bf16 v[64:67], v[112:115], v[128:131], v[64:67]
    s_add_u32 m0, s42, 8192
    s_nop 0
    buffer_load_dwordx4 v26, s[16:19], s40 offen lds
    v_mfma_f32_16x16x32_bf16 v[68:71], v[116:119], v[128:131], v[68:71]
    v_mfma_f32_16x16x32_bf16 v[72:75], v[120:123], v[128:131], v[72:75]
    ds_read_b64_tr_b16 v[96:97], v135 offset:0
    s_add_u32 m0, s22, 8192
    s_nop 0
    buffer_load_dwordx4 v10, s[8:11], s20 offen lds
    ds_read_b64_tr_b16 v[98:99], v135 offset:512
    ds_read_b64_tr_b16 v[100:101], v135 offset:8192
    ds_read_b64_tr_b16 v[102:103], v135 offset:8704
    s_add_u32 m0, s42, 12288
    s_nop 0
    buffer_load_dwordx4 v27, s[16:19], s40 offen lds
    ds_read_b64_tr_b16 v[104:105], v135 offset:16384
    ds_read_b64_tr_b16 v[106:107], v135 offset:16896
    ds_read_b64_tr_b16 v[112:113], v135 offset:4096
    s_add_u32 m0, s22, 12288
    s_nop 0
    buffer_load_dwordx4 v11, s[8:11], s20 offen lds
    ds_read_b64_tr_b16 v[114:115], v135 offset:4608
    ds_read_b64_tr_b16 v[116:117], v135 offset:12288
    ds_read_b64_tr_b16 v[118:119], v135 offset:12800
    s_add_u32 m0, s42, 16384
    s_nop 0
    buffer_load_dwordx4 v28, s[16:19], s40 offen lds
    ds_read_b64_tr_b16 v[120:121], v135 offset:20480
    ds_read_b64_tr_b16 v[122:123], v135 offset:20992
    s_add_u32 m0, s42, 20480
    s_nop 0
    buffer_load_dwordx4 v29, s[16:19], s40 offen lds
    s_mov_b32 s20, s90
    s_mov_b32 s40, s91
    s_add_u32 s22, s22, s93
    s_add_u32 s42, s42, s93
    s_setprio 0
    s_waitcnt vmcnt(10) lgkmcnt(0)
    s_barrier
    s_setprio 3
    s_add_u32 m0, s42, 0
    s_nop 0
    buffer_load_dwordx4 v24, s[16:19], s40 offen lds
    s_add_u32 s21, s21, 1
    s_cmp_eq_u32 s21, 16
    s_cselect_b32 s21, 0, s21
    s_add_u32 m0, s22, 0
    s_nop 0
    buffer_load_dwordx4 v8, s[8:11], s20 offen lds
    s_mul_i32 s90, s21, 128
    s_mul_i32 s91, s21, 393216
    s_add_u32 m0, s42, 4096
    s_nop 0
    buffer_load_dwordx4 v25, s[16:19], s40 offen lds
    s_add_u32 s23, s23, 1
    s_cmp_eq_u32 s23, 3
    s_cselect_b32 s93, 147456, 0
    s_cselect_b32 s23, 0, s23
    s_add_u32 m0, s22, 4096
    s_nop 0
    buffer_load_dwordx4 v9, s[8:11], s20 offen lds
    s_sub_u32 s93, 49152, s93
    v_mfma_f32_16x16x32_bf16 v[64:67], v[96:99], v[128:131], v[64:67]
    s_add_u32 m0, s42, 8192
    s_nop 0
    buffer_load_dwordx4 v26, s[16:19], s40 offen lds
    v_mfma_f32_16x16x32_bf16 v[68:71], v[100:103], v[128:131], v[68:71]
    v_mfma_f32_16x16x32_bf16 v[72:75], v[104:107], v[128:131], v[72:75]
    s_add_u32 m0, s22, 8192
    s_nop 0
    buffer_load_dwordx4 v10, s[8:11], s20 offen lds
    v_mfma_f32_16x16x32_bf16 v[64:67], v[112:115], v[128:131], v[64:67]
    v_mfma_f32_16x16x32_bf16 v[68:71], v[116:119], v[128:131], v[68:71]
    s_add_u32 m0, s42, 12288
    s_nop 0
    buffer_load_dwordx4 v27, s[16:19], s40 offen lds
    v_mfma_f32_16x16x32_bf16 v[72:75], v[120:123], v[128:131], v[72:75]
    s_add_u32 m0, s22, 12288
    s_nop 0
    buffer_load_dwordx4 v11, s[8:11], s20 offen lds
    s_add_u32 m0, s42, 16384
    s_nop 0
    buffer_load_dwordx4 v28, s[16:19], s40 offen lds
    s_add_u32 m0, s42, 20480
    s_nop 0
    buffer_load_dwordx4 v29, s[16:19], s40 offen lds
    s_mov_b32 s20, s90
    s_mov_b32 s40, s91
    s_add_u32 s22, s22, s93
    s_add_u32 s42, s42, s93
    s_setprio 0
    s_waitcnt vmcnt(10)
    s_barrier
    s_add_u32 m0, s42, 0
    s_nop 0
    buffer_load_dwordx4 v24, s[16:19], s40 offen lds
    s_add_u32 s21, s21, 1
    s_cmp_eq_u32 s21, 16
    s_cselect_b32 s21, 0, s21
    s_add_u32 m0, s22, 0
    s_nop 0
    buffer_load_dwordx4 v8, s[8:11], s20 offen lds
    s_mul_i32 s90, s21, 128
    s_mul_i32 s91, s21, 393216
    s_add_u32 m0, s42, 4096
    s_nop 0
    buffer_load_dwordx4 v25, s[16:19], s40 offen lds
    s_add_u32 s23, s23, 1
    s_cmp_eq_u32 s23, 3
    s_cselect_b32 s93, 147456, 0
    s_cselect_b32 s23, 0, s23
    s_add_u32 m0, s22, 4096
    s_nop 0
    buffer_load_dwordx4 v9, s[8:11], s20 offen lds
    s_sub_u32 s93, 49152, s93
    s_mov_b32 exec_lo, 0x10001
    s_mov_b32 exec_hi, 0x10001
    buffer_store_dwordx4 v[64:67], v136, s[24:27], 0 offen sc1
    s_mov_b64 exec, -1
    s_add_u32 m0, s42, 8192
    s_nop 0
    buffer_load_dwordx4 v26, s[16:19], s40 offen lds
    s_mov_b32 exec_lo, 0x10001
    s_mov_b32 exec_hi, 0x10001
    buffer_store_dwordx4 v[68:71], v136, s[24:27], s80 offen sc1
    s_mov_b64 exec, -1
    s_mov_b32 exec_lo, 0x10001
    s_mov_b32 exec_hi, 0x10001
    buffer_store_dwordx4 v[72:75], v136, s[24:27], s81 offen sc1
    s_mov_b64 exec, -1
    s_add_u32 m0, s22, 8192
    s_nop 0
    buffer_load_dwordx4 v10, s[8:11], s20 offen lds
    s_add_u32 m0, s42, 12288
    s_nop 0
    buffer_load_dwordx4 v27, s[16:19], s40 offen lds
    s_add_u32 m0, s22, 12288
    s_nop 0
    buffer_load_dwordx4 v11, s[8:11], s20 offen lds
    s_add_u32 m0, s42, 16384
    s_nop 0
    buffer_load_dwordx4 v28, s[16:19], s40 offen lds
    s_add_u32 m0, s42, 20480
    s_nop 0
    buffer_load_dwordx4 v29, s[16:19], s40 offen lds
    s_mov_b32 s20, s90
    s_mov_b32 s40, s91
    s_add_u32 s22, s22, s93
    s_add_u32 s42, s42, s93
    s_mov_b32 s3, 0x40000
LD1y_nl:
    v_readfirstlane_b32 s74, v34
    v_readfirstlane_b32 s75, v35
    s_cmp_lg_u32 s74, 0
    s_cbranch_scc1 LD1y_nd
    global_load_dwordx2 v[34:35], v32, s[66:67] sc1
    s_waitcnt vmcnt(0)
    s_sub_u32 s3, s3, 1
    s_cmp_lg_u32 s3, 0
    s_cbranch_scc1 LD1y_nl
LD1y_nd:
    v_mov_b32 v162, s74
    v_mov_b32 v163, s75
    ds_write_b64 v33, v[162:163]
    s_waitcnt vmcnt(10)
    s_barrier
    s_mov_b32 s44, 1
LD1_lt0y:
    s_add_u32 m0, s42, 0
    s_nop 0
    buffer_load_dwordx4 v24, s[16:19], s40 offen lds
    s_add_u32 s21, s21, 1
    s_add_u32 m0, s22, 0
    s_nop 0
    buffer_load_dwordx4 v8, s[8:11], s20 offen lds
    s_cmp_eq_u32 s21, 16
    s_cselect_b32 s21, 0, s21
    s_add_u32 m0, s42, 4096
    s_nop 0
    buffer_load_dwordx4 v25, s[16:19], s40 offen lds
    s_mul_i32 s90, s21, 128
    s_add_u32 m0, s22, 4096
    s_nop 0
    buffer_load_dwordx4 v9, s[8:11], s20 offen lds
    s_mul_i32 s91, s21, 393216
    s_add_u32 m0, s42, 8192
    s_nop 0
    buffer_load_dwordx4 v26, s[16:19], s40 offen lds
    s_add_u32 s23, s23, 1
    s_add_u32 m0, s22, 8192
    s_nop 0
    buffer_load_dwordx4 v10, s[8:11], s20 offen lds
    s_cmp_eq_u32 s23, 3
    s_cselect_b32 s93, 147456, 0
    s_cselect_b32 s23, 0, s23
    s_add_u32 m0, s42, 12288
    s_nop 0
    buffer_load_dwordx4 v27, s[16:19], s40 offen lds
    s_sub_u32 s93, 49152, s93
    s_add_u32 m0, s22, 12288
    s_nop 0
    buffer_load_dwordx4 v11, s[8:11], s20 offen lds
    s_add_u32 m0, s42, 16384
    s_nop 0
    buffer_load_dwordx4 v28, s[16:19], s40 offen lds
    s_add_u32 m0, s42, 20480
    s_nop 0
    buffer_load_dwordx4 v29, s[16:19], s40 offen lds
    s_mov_b32 s20, s90
    s_mov_b32 s40, s91
    s_add_u32 s22, s22, s93
    s_add_u32 s42, s42, s93
    s_waitcnt vmcnt(10)
    s_barrier
    s_sub_u32 s44, s44, 1
    s_cmp_lg_u32 s44, 0
    s_cbranch_scc1 LD1_lt0y
    s_add_u32 m0, s42, 0
    s_nop 0
    buffer_load_dwordx4 v24, s[16:19], s40 offen lds
    s_add_u32 s21, s21, 1
    s_add_u32 m0, s22, 0
    s_nop 0
    buffer_load_dwordx4 v8, s[8:11], s20 offen lds
    s_cmp_eq_u32 s21, 16
    s_cselect_b32 s21, 0, s21
    s_add_u32 m0, s42, 4096
    s_nop 0
    buffer_load_dwordx4 v25, s[16:19], s40 offen lds
    s_mul_i32 s90, s21, 128
    s_add_u32 m0, s22, 4096
    s_nop 0
    buffer_load_dwordx4 v9, s[8:11], s20 offen lds
    s_mul_i32 s91, s21, 393216
    s_add_u32 m0, s42, 8192
    s_nop 0
    buffer_load_dwordx4 v26, s[16:19], s40 offen lds
    s_add_u32 s23, s23, 1
    s_add_u32 m0, s22, 8192
    s_nop 0
    buffer_load_dwordx4 v10, s[8:11], s20 offen lds
    s_cmp_eq_u32 s23, 3
    s_cselect_b32 s93, 147456, 0
    s_cselect_b32 s23, 0, s23
    s_add_u32 m0, s42, 12288
    s_nop 0
    buffer_load_dwordx4 v27, s[16:19], s40 offen lds
    s_sub_u32 s93, 49152, s93
    s_add_u32 m0, s22, 12288
    s_nop 0
    buffer_load_dwordx4 v11, s[8:11], s20 offen lds
    s_mov_b64 exec, 1
    buffer_store_dwordx2 v[162:163], v160, s[84:87], 0 offen sc1
    buffer_store_dwordx2 v[162:163], v164, s[84:87], 0 offen sc1
    s_mov_b64 exec, -1
    s_add_u32 m0, s42, 16384
    s_nop 0
    buffer_load_dwordx4 v28, s[16:19], s40 offen lds
    s_add_u32 m0, s42, 20480
    s_nop 0
    buffer_load_dwordx4 v29, s[16:19], s40 offen lds
    s_mov_b32 s20, s90
    s_mov_b32 s40, s91
    s_add_u32 s22, s22, s93
    s_add_u32 s42, s42, s93
    s_waitcnt vmcnt(10)
    s_barrier
    s_mov_b32 s44, 5
LD1_lt1y:
    s_add_u32 m0, s42, 0
    s_nop 0
    buffer_load_dwordx4 v24, s[16:19], s40 offen lds
    s_add_u32 s21, s21, 1
    s_add_u32 m0, s22, 0
    s_nop 0
    buffer_load_dwordx4 v8, s[8:11], s20 offen lds
    s_cmp_eq_u32 s21, 16
    s_cselect_b32 s21, 0, s21
    s_add_u32 m0, s42, 4096
    s_nop 0
    buffer_load_dwordx4 v25, s[16:19], s40 offen lds
    s_mul_i32 s90, s21, 128
    s_add_u32 m0, s22, 4096
    s_nop 0
    buffer_load_dwordx4 v9, s[8:11], s20 offen lds
    s_mul_i32 s91, s21, 393216
    s_add_u32 m0, s42, 8192
    s_nop 0
    buffer_load_dwordx4 v26, s[16:19], s40 offen lds
    s_add_u32 s23, s23, 1
    s_add_u32 m0, s22, 8192
    s_nop 0
    buffer_load_dwordx4 v10, s[8:11], s20 offen lds
    s_cmp_eq_u32 s23, 3
    s_cselect_b32 s93, 147456, 0
    s_cselect_b32 s23, 0, s23
    s_add_u32 m0, s42, 12288
    s_nop 0
    buffer_load_dwordx4 v27, s[16:19], s40 offen lds
    s_sub_u32 s93, 49152, s93
    s_add_u32 m0, s22, 12288
    s_nop 0
    buffer_load_dwordx4 v11, s[8:11], s20 offen lds
    s_add_u32 m0, s42, 16384
    s_nop 0
    buffer_load_dwordx4 v28, s[16:19], s40 offen lds
    s_add_u32 m0, s42, 20480
    s_nop 0
    buffer_load_dwordx4 v29, s[16:19], s40 offen lds
    s_mov_b32 s20, s90
    s_mov_b32 s40, s91
    s_add_u32 s22, s22, s93
    s_add_u32 s42, s42, s93
    s_waitcnt vmcnt(10)
    s_barrier
    s_sub_u32 s44, s44, 1
    s_cmp_lg_u32 s44, 0
    s_cbranch_scc1 LD1_lt1y
    s_add_u32 m0, s42, 0
    s_nop 0
    buffer_load_dwordx4 v24, s[16:19], s40 offen lds
    s_add_u32 s21, s21, 1
    s_cmp_eq_u32 s21, 16
    s_cselect_b32 s21, 0, s21
    s_add_u32 m0, s22, 0
    s_nop 0
    buffer_load_dwordx4 v8, s[8:11], s20 offen lds
    s_mul_i32 s90, s21, 128
    s_mul_i32 s91, s21, 393216
    s_add_u32 m0, s42, 4096
    s_nop 0
    buffer_load_dwordx4 v25, s[16:19], s40 offen lds
    s_add_u32 s23, s23, 1
    s_cmp_eq_u32 s23, 3
    s_cselect_b32 s93, 147456, 0
    s_cselect_b32 s23, 0, s23
    s_add_u32 m0, s22, 4096
    s_nop 0
    buffer_load_dwordx4 v9, s[8:11], s20 offen lds
    s_sub_u32 s93, 49152, s93
    global_load_dwordx2 v[172:173], v168, s[68:69] sc1
    s_add_u32 m0, s42, 8192
    s_nop 0
    buffer_load_dwordx4 v26, s[16:19], s40 offen lds
    global_load_dwordx2 v[174:175], v169, s[68:69] sc1
    global_load_dwordx2 v[176:177], v170, s[68:69] sc1
    s_add_u32 m0, s22, 8192
    s_nop 0
    buffer_load_dwordx4 v10, s[8:11], s20 offen lds
    s_add_u32 m0, s42, 12288
    s_nop 0
    buffer_load_dwordx4 v27, s[16:19], s40 offen lds
    s_add_u32 m0, s22, 12288
    s_nop 0
    buffer_load_dwordx4 v11, s[8:11], s20 offen lds
    s_add_u32 m0, s42, 16384
    s_nop 0
    buffer_load_dwordx4 v28, s[16:19], s40 offen lds
    s_add_u32 m0, s42, 20480
    s_nop 0
    buffer_load_dwordx4 v29, s[16:19], s40 offen lds
    s_mov_b32 s20, s90
    s_mov_b32 s40, s91
    s_add_u32 s22, s22, s93
    s_add_u32 s42, s42, s93
    s_waitcnt vmcnt(10)
    s_barrier
    s_mov_b32 s44, 1
LD1_lt2y:
    s_add_u32 m0, s42, 0
    s_nop 0
    buffer_load_dwordx4 v24, s[16:19], s40 offen lds
    s_add_u32 s21, s21, 1
    s_add_u32 m0, s22, 0
    s_nop 0
    buffer_load_dwordx4 v8, s[8:11], s20 offen lds
    s_cmp_eq_u32 s21, 16
    s_cselect_b32 s21, 0, s21
    s_add_u32 m0, s42, 4096
    s_nop 0
    buffer_load_dwordx4 v25, s[16:19], s40 offen lds
    s_mul_i32 s90, s21, 128
    s_add_u32 m0, s22, 4096
    s_nop 0
    buffer_load_dwordx4 v9, s[8:11], s20 offen lds
    s_mul_i32 s91, s21, 393216
    s_add_u32 m0, s42, 8192
    s_nop 0
    buffer_load_dwordx4 v26, s[16:19], s40 offen lds
    s_add_u32 s23, s23, 1
    s_add_u32 m0, s22, 8192
    s_nop 0
    buffer_load_dwordx4 v10, s[8:11], s20 offen lds
    s_cmp_eq_u32 s23, 3
    s_cselect_b32 s93, 147456, 0
    s_cselect_b32 s23, 0, s23
    s_add_u32 m0, s42, 12288
    s_nop 0
    buffer_load_dwordx4 v27, s[16:19], s40 offen lds
    s_sub_u32 s93, 49152, s93
    s_add_u32 m0, s22, 12288
    s_nop 0
    buffer_load_dwordx4 v11, s[8:11], s20 offen lds
    s_add_u32 m0, s42, 16384
    s_nop 0
    buffer_load_dwordx4 v28, s[16:19], s40 offen lds
    s_add_u32 m0, s42, 20480
    s_nop 0
    buffer_load_dwordx4 v29, s[16:19], s40 offen lds
    s_mov_b32 s20, s90
    s_mov_b32 s40, s91
    s_add_u32 s22, s22, s93
    s_add_u32 s42, s42, s93
    s_waitcnt vmcnt(10)
    s_barrier
    s_sub_u32 s44, s44, 1
    s_cmp_lg_u32 s44, 0
    s_cbranch_scc1 LD1_lt2y
    s_add_u32 m0, s42, 0
    s_nop 0
    buffer_load_dwordx4 v24, s[16:19], s40 offen lds
    s_add_u32 s21, s21, 1
    s_add_u32 m0, s22, 0
    s_nop 0
    buffer_load_dwordx4 v8, s[8:11], s20 offen lds
    s_cmp_eq_u32 s21, 16
    s_cselect_b32 s21, 0, s21
    s_add_u32 m0, s42, 4096
    s_nop 0
    buffer_load_dwordx4 v25, s[16:19], s40 offen lds
    s_mul_i32 s90, s21, 128
    s_add_u32 m0, s22, 4096
    s_nop 0
    buffer_load_dwordx4 v9, s[8:11], s20 offen lds
    s_mul_i32 s91, s21, 393216
    s_add_u32 m0, s42, 8192
    s_nop 0
    buffer_load_dwordx4 v26, s[16:19], s40 offen lds
    s_add_u32 s23, s23, 1
    s_add_u32 m0, s22, 8192
    s_nop 0
    buffer_load_dwordx4 v10, s[8:11], s20 offen lds
    s_cmp_eq_u32 s23, 3
    s_cselect_b32 s93, 147456, 0
    s_cselect_b32 s23, 0, s23
    s_add_u32 m0, s42, 12288
    s_nop 0
    buffer_load_dwordx4 v27, s[16:19], s40 offen lds
    s_sub_u32 s93, 49152, s93
    s_add_u32 m0, s22, 12288
    s_nop 0
    buffer_load_dwordx4 v11, s[8:11], s20 offen lds
    s_add_u32 m0, s42, 16384
    s_nop 0
    buffer_load_dwordx4 v28, s[16:19], s40 offen lds
    s_add_u32 m0, s42, 20480
    s_nop 0
    buffer_load_dwordx4 v29, s[16:19], s40 offen lds
    s_mov_b32 s20, s90
    s_mov_b32 s40, s91
    s_add_u32 s22, s22, s93
    s_add_u32 s42, s42, s93
    s_mov_b32 s3, 0x40000
LD1ycs_pl:
    v_cmp_eq_u64 vcc, s[74:75], v[172:173]
    v_cmp_eq_u64 s[34:35], s[74:75], v[174:175]
    s_nop 0
    s_and_b64 vcc, vcc, s[34:35]
    v_cmp_eq_u64 s[34:35], s[74:75], v[176:177]
    s_nop 0
    s_and_b64 vcc, vcc, s[34:35]
    s_cmp_eq_u64 vcc, -1
    s_cbranch_scc1 LD1ycs_pd
    s_sleep 2
    global_load_dwordx2 v[172:173], v168, s[68:69] sc1
    global_load_dwordx2 v[174:175], v169, s[68:69] sc1
    global_load_dwordx2 v[176:177], v170, s[68:69] sc1
    s_waitcnt vmcnt(0)
    s_sub_u32 s3, s3, 1
    s_cmp_lg_u32 s3, 0
    s_cbranch_scc1 LD1ycs_pl
LD1ycs_pd:
    s_waitcnt vmcnt(10)
    s_barrier
    s_mov_b32 s3, s82
    buffer_load_dwordx4 v[64:67], v139, s[24:27], s3 offen sc1
    s_add_u32 s3, s3, 12288
    buffer_load_dwordx4 v[68:71], v139, s[24:27], s3 offen sc1
    buffer_load_dwordx2 v[140:141], v156, s[28:31], 0 offen sc1
    v_lshlrev_b32 v132, 2, v157
    v_add_u32 v133, 153856, v132
    v_add_u32 v132, 149760, v132
    v_lshlrev_b32 v134, 3, v157
    v_add_u32 v134, 147712, v134
    v_mov_b32 v32, 147476
    v_mov_b32 v33, 1
    s_add_u32 m0, s38, 0
    s_nop 0
    buffer_load_dwordx4 v16, s[12:15], s36 offen lds
    s_add_u32 m0, s38, 4096
    s_nop 0
    buffer_load_dwordx4 v17, s[12:15], s36 offen lds
    s_add_u32 m0, s38, 8192
    s_nop 0
    buffer_load_dwordx4 v18, s[12:15], s36 offen lds
    s_add_u32 m0, s38, 12288
    s_nop 0
    buffer_load_dwordx4 v19, s[12:15], s36 offen lds
    s_add_u32 s37, s37, 1
    s_cmp_eq_u32 s37, 8
    s_cselect_b32 s37, 0, s37
    s_add_u32 s7, s37, s46
    s_and_b32 s7, s7, 3
    s_andn2_b32 s36, s37, 3
    s_add_u32 s36, s36, s7
    s_mul_i32 s36, s36, 262144
    s_add_u32 s38, s38, 49152
    s_add_u32 s39, s39, 1
    s_cmp_eq_u32 s39, 3
    s_cselect_b32 s7, 147456, 0
    s_cselect_b32 s39, 0, s39
    s_sub_u32 s38, s38, s7
    s_waitcnt vmcnt(7)
    s_barrier
    s_waitcnt vmcnt(4)
    s_setprio 3
    v_add_f32 v64, v64, v68
    v_add_f32 v65, v65, v69
    v_add_f32 v66, v66, v70
    v_add_f32 v67, v67, v71
    ds_write_b128 v166, v[64:67]
    s_mov_b64 exec, 1
    s_waitcnt lgkmcnt(0)
    ds_add_u32 v32, v33
LD1y_ls:
    ds_read_b32 v34, v32
    s_waitcnt lgkmcnt(0)
    v_readfirstlane_b32 s3, v34
    s_nop 0
    s_cmp_lt_u32 s3, 4
    s_cbranch_scc1 LD1y_ls
    s_mov_b64 exec, -1
    ds_read2st64_b32 v[64:65], v133 offset0:0 offset1:4
    ds_read2st64_b32 v[66:67], v133 offset0:8 offset1:12
    ds_write_b32 v132, v140
    ds_write_b32 v132, v141 offset:1024
    ds_write_b64 v134, v[140:141]
    s_waitcnt lgkmcnt(0)
    v_add_f32 v64, v64, v65
    v_add_f32 v66, v66, v67
    v_add_f32 v64, v64, v66
    ds_write_b32 v132, v64 offset:2048
    s_waitcnt lgkmcnt(0)
    s_setprio 0
    s_getpc_b64 s[34:35]
CT5:
    s_add_u32 s34, s34, CT_e1-CT5
    s_addc_u32 s35, s35, (CT_e1-CT5)>>32
    s_lshl_b32 s3, s6, 7
    v_lshlrev_b32 v49, 9, v1
    v_add_u32 v49, s3, v49
    v_cmp_gt_u32 vcc, CT_e2-CT_e1, v49
    s_nop 0
    s_mov_b64 exec, vcc
    s_cbranch_execz CT5_e
    global_load_dword v48, v49, s[34:35]
CT5_e:
    s_mov_b64 exec, -1
    s_getpc_b64 s[34:35]
CT6:
    s_add_u32 s34, s34, LD1_e-CT6
    s_addc_u32 s35, s35, (LD1_e-CT6)>>32
    s_lshl_b32 s3, s6, 7
    v_lshlrev_b32 v49, 9, v1
    v_add_u32 v49, s3, v49
    v_cmp_gt_u32 vcc, LD2_e-LD1_e, v49
    s_nop 0
    s_mov_b64 exec, vcc
    s_cbranch_execz CT6_e
    global_load_dword v50, v49, s[34:35]
CT6_e:
    s_mov_b64 exec, -1
    s_barrier
    s_add_u32 m0, s38, 0
    s_nop 0
    buffer_load_dwordx4 v16, s[12:15], s36 offen lds
    s_add_u32 m0, s38, 4096
    s_nop 0
    buffer_load_dwordx4 v17, s[12:15], s36 offen lds
    s_add_u32 m0, s38, 8192
    s_nop 0
    buffer_load_dwordx4 v18, s[12:15], s36 offen lds
    s_add_u32 m0, s38, 12288
    s_nop 0
    buffer_load_dwordx4 v19, s[12:15], s36 offen lds
    s_add_u32 s37, s37, 1
    s_cmp_eq_u32 s37, 8
    s_cselect_b32 s37, 0, s37
    s_add_u32 s7, s37, s46
    s_and_b32 s7, s7, 3
    s_andn2_b32 s36, s37, 3
    s_add_u32 s36, s36, s7
    s_mul_i32 s36, s36, 262144
    s_add_u32 s38, s38, 49152
    s_add_u32 s39, s39, 1
    s_cmp_eq_u32 s39, 3
    s_cselect_b32 s7, 147456, 0
    s_cselect_b32 s39, 0, s39
    s_sub_u32 s38, s38, s7
    s_load_dwordx2 s[100:101], s[88:89], 60
    s_load_dwordx2 s[100:101], s[88:89], 188
    s_load_dwordx2 s[100:101], s[88:89], 316
    s_load_dwordx2 s[100:101], s[88:89], 444
    s_load_dwordx2 s[100:101], s[88:89], 572
    s_load_dwordx2 s[100:101], s[88:89], 700
    s_load_dwordx2 s[100:101], s[88:89], 828
    s_add_u32 s88, s88, 896
    s_addc_u32 s89, s89, 0
LD1_e:
    s_add_u32 s8, s68, 4194304
    s_addc_u32 s9, s69, 0
    s_mov_b32 s10, 4194304
    s_mov_b32 s11, 0x20000
    s_lshl_b32 s7, s70, 3
    s_add_u32 s7, s7, s6
    s_mul_i32 s7, s7, 32768
    v_lshlrev_b32 v8, 4, v1
    v_add_u32 v8, s7, v8
    v_add_u32 v9, 131072, v8
    s_and_b32 s21, s70, 7
    s_mul_i32 s21, s21, 2
    s_lshr_b32 s21, s21, 3
    s_lshl_b32 s21, s21, 2
    s_add_u32 s45, s70, s71
    s_add_u32 s7, s21, s45
    s_and_b32 s7, s7, 3
    s_andn2_b32 s20, s21, 3
    s_add_u32 s20, s20, s7
    s_mov_b32 s97, s20
    s_mul_i32 s20, s20, 4096
    s_mul_i32 s22, s6, 4096
    s_add_u32 s22, s22, 49152
    s_mov_b32 s23, 1
    s_lshl_b32 s3, s70, 11
    s_add_u32 s3, s3, 31555584
    s_mov_b32 s83, s3
    v_mov_b32 v44, 147508
    v_lshlrev_b32 v40, 7, v1
    v_add_u32 v40, s3, v40
    s_mov_b64 s[94:95], 0
    s_mov_b32 s96, 0x40000
    s_mov_b32 s16, s56
    s_mov_b32 s17, s57
    s_mov_b32 s18, 7340032
    s_mov_b32 s19, 0x20000
    v_lshrrev_b32 v5, 5, v1
    s_lshl_b32 s7, s6, 1
    v_add_u32 v5, s7, v5
    v_and_b32 v6, 3, v5
    v_lshlrev_b32 v6, 1, v6
    v_and_b32 v7, 31, v1
    v_xor_b32 v6, v6, v7
    v_mul_u32_u24 v5, 7168, v5
    s_mul_i32 s35, s71, 448
    s_andn2_b32 s35, s35, 127
    v_add_u32 v5, s35, v5
    v_lshl_add_u32 v24, v6, 4, v5
    v_xor_b32 v6, 8, v6
    v_lshl_add_u32 v25, v6, 4, v5
    v_add_u32 v25, 57344, v25
    v_add_u32 v26, 114688, v24
    v_add_u32 v27, 114688, v25
    v_add_u32 v28, 114688, v26
    v_add_u32 v29, 114688, v27
    v_add_u32 v30, 114688, v28
    v_add_u32 v31, 114688, v29
    s_and_b32 s41, s70, 7
    s_lshl_b32 s41, s41, 1
    s_mul_i32 s40, s41, 458752
    s_mul_i32 s42, s6, 1024
    s_add_u32 s42, s42, 16384
    s_mov_b32 s43, 0
    s_cmp_eq_u32 s94, 0xffff
    s_cbranch_scc1 WR7_ok
    s_lshl_b32 s3, s97, 1
    s_lshl_b32 s34, 3, s3
    s_andn2_b32 s3, s34, s94
    s_cbranch_scc0 WR7_ok
WR7_t:
    s_cmp_lg_u32 s6, 0
    s_cbranch_scc1 WR7_w
    s_mov_b64 exec, 0xffff
    global_load_dwordx2 v[42:43], v40, s[68:69] sc1
    s_max_u32 s96, s96, 1
    s_sub_u32 s96, s96, 1
    s_waitcnt vmcnt(0)
    v_cmp_eq_u64 s[94:95], s[74:75], v[42:43]
    s_mov_b64 exec, -1
    s_cmp_eq_u32 s96, 0
    s_cselect_b32 s94, 0xffff, s94
    s_cselect_b32 s96, 1, s96
    v_mov_b32 v45, s94
    ds_write_b32 v44, v45
    s_branch WR7_c
WR7_w:
    ds_read_b32 v45, v44
    s_sub_u32 s96, s96, 1
    s_cselect_b32 s96, 0, s96
    s_cselect_b32 s7, -1, 0
    s_waitcnt lgkmcnt(0)
    v_readfirstlane_b32 s3, v45
    s_nop 0
    s_or_b32 s94, s94, s3
    s_or_b32 s94, s94, s7
WR7_c:
    s_andn2_b32 s3, s34, s94
    s_cbranch_scc0 WR7_ok
    s_sleep 2
    s_branch WR7_t
WR7_ok:
    s_add_u32 m0, s22, 0
    s_nop 0
    buffer_load_dwordx4 v8, s[8:11], s20 offen offset:0 sc1 lds
    buffer_load_dwordx4 v8, s[8:11], s20 offen offset:1024 sc1 lds
    buffer_load_dwordx4 v8, s[8:11], s20 offen offset:2048 sc1 lds
    buffer_load_dwordx4 v8, s[8:11], s20 offen offset:3072 sc1 lds
    s_add_u32 m0, s22, 16384
    s_nop 0
    buffer_load_dwordx4 v9, s[8:11], s20 offen offset:0 sc1 lds
    buffer_load_dwordx4 v9, s[8:11], s20 offen offset:1024 sc1 lds
    buffer_load_dwordx4 v9, s[8:11], s20 offen offset:2048 sc1 lds
    buffer_load_dwordx4 v9, s[8:11], s20 offen offset:3072 sc1 lds
    s_add_u32 s21, s21, 1
    s_cmp_eq_u32 s21, 8
    s_cselect_b32 s21, 0, s21
    s_add_u32 s7, s21, s45
    s_and_b32 s7, s7, 3
    s_andn2_b32 s20, s21, 3
    s_add_u32 s20, s20, s7
    s_mov_b32 s97, s20
    s_mul_i32 s20, s20, 4096
    s_add_u32 s22, s22, 49152
    s_add_u32 s23, s23, 1
    s_cmp_eq_u32 s23, 3
    s_cselect_b32 s7, 147456, 0
    s_cselect_b32 s23, 0, s23
    s_sub_u32 s22, s22, s7
    s_cmp_eq_u32 s94, 0xffff
    s_cbranch_scc1 LD2_x1
    s_lshl_b32 s3, s97, 1
    s_lshl_b32 s34, 3, s3
    s_andn2_b32 s3, s34, s94
    s_cbranch_scc0 LD2_x1
    s_waitcnt vmcnt(0)
    s_barrier
    s_cmp_eq_u32 s94, 0xffff
    s_cbranch_scc1 WR8_ok
    s_lshl_b32 s3, s97, 1
    s_lshl_b32 s34, 3, s3
    s_andn2_b32 s3, s34, s94
    s_cbranch_scc0 WR8_ok
WR8_t:
    s_cmp_lg_u32 s6, 0
    s_cbranch_scc1 WR8_w
    s_mov_b64 exec, 0xffff
    global_load_dwordx2 v[42:43], v40, s[68:69] sc1
    s_max_u32 s96, s96, 1
    s_sub_u32 s96, s96, 1
    s_waitcnt vmcnt(0)
    v_cmp_eq_u64 s[94:95], s[74:75], v[42:43]
    s_mov_b64 exec, -1
    s_cmp_eq_u32 s96, 0
    s_cselect_b32 s94, 0xffff, s94
    s_cselect_b32 s96, 1, s96
    v_mov_b32 v45, s94
    ds_write_b32 v44, v45
    s_branch WR8_c
WR8_w:
    ds_read_b32 v45, v44
    s_sub_u32 s96, s96, 1
    s_cselect_b32 s96, 0, s96
    s_cselect_b32 s7, -1, 0
    s_waitcnt lgkmcnt(0)
    v_readfirstlane_b32 s3, v45
    s_nop 0
    s_or_b32 s94, s94, s3
    s_or_b32 s94, s94, s7
WR8_c:
    s_andn2_b32 s3, s34, s94
    s_cbranch_scc0 WR8_ok
    s_sleep 2
    s_branch WR8_t
WR8_ok:
    s_add_u32 m0, s22, 0
    s_nop 0
    buffer_load_dwordx4 v8, s[8:11], s20 offen offset:0 sc1 lds
    buffer_load_dwordx4 v8, s[8:11], s20 offen offset:1024 sc1 lds
    buffer_load_dwordx4 v8, s[8:11], s20 offen offset:2048 sc1 lds
    buffer_load_dwordx4 v8, s[8:11], s20 offen offset:3072 sc1 lds
    s_add_u32 m0, s22, 16384
    s_nop 0
    buffer_load_dwordx4 v9, s[8:11], s20 offen offset:0 sc1 lds
    buffer_load_dwordx4 v9, s[8:11], s20 offen offset:1024 sc1 lds
    buffer_load_dwordx4 v9, s[8:11], s20 offen offset:2048 sc1 lds
    buffer_load_dwordx4 v9, s[8:11], s20 offen offset:3072 sc1 lds
    s_add_u32 s21, s21, 1
    s_cmp_eq_u32 s21, 8
    s_cselect_b32 s21, 0, s21
    s_add_u32 s7, s21, s45
    s_and_b32 s7, s7, 3
    s_andn2_b32 s20, s21, 3
    s_add_u32 s20, s20, s7
    s_mov_b32 s97, s20
    s_mul_i32 s20, s20, 4096
    s_add_u32 s22, s22, 49152
    s_add_u32 s23, s23, 1
    s_cmp_eq_u32 s23, 3
    s_cselect_b32 s7, 147456, 0
    s_cselect_b32 s23, 0, s23
    s_sub_u32 s22, s22, s7
    s_branch LD2_x2
LD2_x1:
    s_add_u32 m0, s22, 0
    s_nop 0
    buffer_load_dwordx4 v8, s[8:11], s20 offen offset:0 sc1 lds
    buffer_load_dwordx4 v8, s[8:11], s20 offen offset:1024 sc1 lds
    buffer_load_dwordx4 v8, s[8:11], s20 offen offset:2048 sc1 lds
    buffer_load_dwordx4 v8, s[8:11], s20 offen offset:3072 sc1 lds
    s_add_u32 m0, s22, 16384
    s_nop 0
    buffer_load_dwordx4 v9, s[8:11], s20 offen offset:0 sc1 lds
    s_waitcnt vmcnt(5)
    s_barrier
    buffer_load_dwordx4 v9, s[8:11], s20 offen offset:1024 sc1 lds
    buffer_load_dwordx4 v9, s[8:11], s20 offen offset:2048 sc1 lds
    buffer_load_dwordx4 v9, s[8:11], s20 offen offset:3072 sc1 lds
    s_add_u32 s21, s21, 1
    s_cmp_eq_u32 s21, 8
    s_cselect_b32 s21, 0, s21
    s_add_u32 s7, s21, s45
    s_and_b32 s7, s7, 3
    s_andn2_b32 s20, s21, 3
    s_add_u32 s20, s20, s7
    s_mov_b32 s97, s20
    s_mul_i32 s20, s20, 4096
    s_add_u32 s22, s22, 49152
    s_add_u32 s23, s23, 1
    s_cmp_eq_u32 s23, 3
    s_cselect_b32 s7, 147456, 0
    s_cselect_b32 s23, 0, s23
    s_sub_u32 s22, s22, s7
LD2_x2:
    s_mov_b32 s44, 6
LD2_la:
    s_cmp_eq_u32 s94, 0xffff
    s_cbranch_scc1 WR9_ok
    s_lshl_b32 s3, s97, 1
    s_lshl_b32 s34, 3, s3
    s_andn2_b32 s3, s34, s94
    s_cbranch_scc0 WR9_ok
WR9_t:
    s_mov_b64 exec, 0xffff
    global_load_dwordx2 v[42:43], v40, s[68:69] sc1
    s_max_u32 s96, s96, 1
    s_sub_u32 s96, s96, 1
    s_waitcnt vmcnt(0)
    v_cmp_eq_u64 s[94:95], s[74:75], v[42:43]
    s_mov_b64 exec, -1
    s_cmp_eq_u32 s96, 0
    s_cselect_b32 s94, 0xffff, s94
    s_cselect_b32 s96, 1, s96
    s_andn2_b32 s3, s34, s94
    s_cbranch_scc0 WR9_ok
    s_sleep 2
    s_branch WR9_t
WR9_ok:
    s_add_u32 m0, s38, 0
    s_nop 0
    buffer_load_dwordx4 v16, s[12:15], s36 offen lds
    s_add_u32 s21, s21, 1
    s_add_u32 m0, s22, 0
    s_nop 0
    buffer_load_dwordx4 v8, s[8:11], s20 offen offset:0 sc1 lds
    s_cmp_eq_u32 s21, 8
    s_cselect_b32 s21, 0, s21
    s_add_u32 m0, s38, 4096
    s_nop 0
    buffer_load_dwordx4 v17, s[12:15], s36 offen lds
    s_add_u32 s92, s21, s45
    s_add_u32 m0, s22, 0
    s_nop 0
    buffer_load_dwordx4 v8, s[8:11], s20 offen offset:1024 sc1 lds
    s_and_b32 s92, s92, 3
    s_add_u32 m0, s38, 8192
    s_nop 0
    buffer_load_dwordx4 v18, s[12:15], s36 offen lds
    s_andn2_b32 s93, s21, 3
    s_add_u32 m0, s22, 0
    s_nop 0
    buffer_load_dwordx4 v8, s[8:11], s20 offen offset:2048 sc1 lds
    s_add_u32 s97, s93, s92
    s_add_u32 m0, s38, 12288
    s_nop 0
    buffer_load_dwordx4 v19, s[12:15], s36 offen lds
    s_mul_i32 s90, s97, 4096
    s_add_u32 m0, s22, 0
    s_nop 0
    buffer_load_dwordx4 v8, s[8:11], s20 offen offset:3072 sc1 lds
    s_mul_i32 s91, s97, 262144
    s_add_u32 m0, s22, 16384
    s_nop 0
    buffer_load_dwordx4 v9, s[8:11], s20 offen offset:0 sc1 lds
    s_add_u32 s23, s23, 1
    buffer_load_dwordx4 v9, s[8:11], s20 offen offset:1024 sc1 lds
    s_cmp_eq_u32 s23, 3
    s_cselect_b32 s93, 147456, 0
    s_cselect_b32 s23, 0, s23
    buffer_load_dwordx4 v9, s[8:11], s20 offen offset:2048 sc1 lds
    s_sub_u32 s93, 49152, s93
    buffer_load_dwordx4 v9, s[8:11], s20 offen offset:3072 sc1 lds
    s_mov_b32 s20, s90
    s_mov_b32 s36, s91
    s_add_u32 s22, s22, s93
    s_add_u32 s38, s38, s93
    s_load_dwordx2 s[100:101], s[88:89], 60
    s_load_dwordx2 s[100:101], s[88:89], 188
    s_add_u32 s88, s88, 256
    s_addc_u32 s89, s89, 0
    s_waitcnt vmcnt(12)
    s_barrier
    s_sub_u32 s44, s44, 1
    s_cmp_lg_u32 s44, 0
    s_cbranch_scc1 LD2_la
    s_add_u32 m0, s42, 0
    s_nop 0
    buffer_load_dwordx4 v24, s[16:19], s40 offen lds
    s_add_u32 m0, s42, 4096
    s_nop 0
    buffer_load_dwordx4 v25, s[16:19], s40 offen lds
    s_add_u32 m0, s42, 8192
    s_nop 0
    buffer_load_dwordx4 v26, s[16:19], s40 offen lds
    s_add_u32 m0, s42, 12288
    s_nop 0
    buffer_load_dwordx4 v27, s[16:19], s40 offen lds
    s_add_u32 m0, s42, 16384
    s_nop 0
    buffer_load_dwordx4 v28, s[16:19], s40 offen lds
    s_add_u32 m0, s42, 20480
    s_nop 0
    buffer_load_dwordx4 v29, s[16:19], s40 offen lds
    s_add_u32 m0, s42, 24576
    s_nop 0
    buffer_load_dwordx4 v30, s[16:19], s40 offen lds
    s_add_u32 m0, s42, 28672
    s_nop 0
    buffer_load_dwordx4 v31, s[16:19], s40 offen lds
    s_add_u32 s40, s40, 458752
    s_add_u32 s41, s41, 1
    s_cmp_eq_u32 s41, 16
    s_cselect_b32 s41, 0, s41
    s_cselect_b32 s40, 0, s40
    s_add_u32 s42, s42, 49152
    s_add_u32 s43, s43, 1
    s_cmp_eq_u32 s43, 3
    s_cselect_b32 s7, 147456, 0
    s_cselect_b32 s43, 0, s43
    s_sub_u32 s42, s42, s7
    s_waitcnt vmcnt(8)
    s_barrier
    s_getpc_b64 s[34:35]
CT10:
    s_add_u32 s34, s34, CT_e2-CT10
    s_addc_u32 s35, s35, (CT_e2-CT10)>>32
    s_lshl_b32 s3, s6, 7
    v_lshlrev_b32 v49, 9, v1
    v_add_u32 v49, s3, v49
    v_cmp_gt_u32 vcc, CT_e3-CT_e2, v49
    s_nop 0
    s_mov_b64 exec, vcc
    s_cbranch_execz CT10_e
    global_load_dword v48, v49, s[34:35]
CT10_e:
    s_mov_b64 exec, -1
    s_getpc_b64 s[34:35]
CT11:
    s_add_u32 s34, s34, LD2_e-CT11
    s_addc_u32 s35, s35, (LD2_e-CT11)>>32
    s_lshl_b32 s3, s6, 7
    v_lshlrev_b32 v49, 9, v1
    v_add_u32 v49, s3, v49
    v_cmp_gt_u32 vcc, LD3_e-LD2_e, v49
    s_nop 0
    s_mov_b64 exec, vcc
    s_cbranch_execz CT11_e
    global_load_dword v50, v49, s[34:35]
CT11_e:
    s_mov_b64 exec, -1
    s_barrier
    s_add_u32 m0, s42, 0
    s_nop 0
    buffer_load_dwordx4 v24, s[16:19], s40 offen lds
    s_add_u32 m0, s42, 4096
    s_nop 0
    buffer_load_dwordx4 v25, s[16:19], s40 offen lds
    s_add_u32 m0, s42, 8192
    s_nop 0
    buffer_load_dwordx4 v26, s[16:19], s40 offen lds
    s_add_u32 m0, s42, 12288
    s_nop 0
    buffer_load_dwordx4 v27, s[16:19], s40 offen lds
    s_add_u32 m0, s42, 16384
    s_nop 0
    buffer_load_dwordx4 v28, s[16:19], s40 offen lds
    s_add_u32 m0, s42, 20480
    s_nop 0
    buffer_load_dwordx4 v29, s[16:19], s40 offen lds
    s_add_u32 m0, s42, 24576
    s_nop 0
    buffer_load_dwordx4 v30, s[16:19], s40 offen lds
    s_add_u32 m0, s42, 28672
    s_nop 0
    buffer_load_dwordx4 v31, s[16:19], s40 offen lds
    s_add_u32 s40, s40, 458752
    s_add_u32 s41, s41, 1
    s_cmp_eq_u32 s41, 16
    s_cselect_b32 s41, 0, s41
    s_cselect_b32 s40, 0, s40
    s_add_u32 s42, s42, 49152
    s_add_u32 s43, s43, 1
    s_cmp_eq_u32 s43, 3
    s_cselect_b32 s7, 147456, 0
    s_cselect_b32 s43, 0, s43
    s_sub_u32 s42, s42, s7
    s_load_dwordx2 s[100:101], s[88:89], 60
    s_load_dwordx2 s[100:101], s[88:89], 188
    s_load_dwordx2 s[100:101], s[88:89], 316
    s_load_dwordx2 s[100:101], s[88:89], 444
    s_load_dwordx2 s[100:101], s[88:89], 572
    s_load_dwordx2 s[100:101], s[88:89], 700
    s_load_dwordx2 s[100:101], s[88:89], 828
    s_add_u32 s88, s88, 896
    s_addc_u32 s89, s89, 0
LD2_e:
    s_add_u32 s8, s68, 8388608
    s_addc_u32 s9, s69, 0
    s_mov_b32 s10, 4194304
    s_mov_b32 s11, 0x20000
    s_lshl_b32 s7, s70, 3
    s_add_u32 s7, s7, s6
    s_mul_i32 s7, s7, 32768
    v_lshlrev_b32 v8, 4, v1
    v_add_u32 v8, s7, v8
    v_add_u32 v9, 131072, v8
    s_and_b32 s21, s70, 7
    s_lshl_b32 s21, s21, 1
    s_mul_i32 s20, s21, 2048
    s_mul_i32 s22, s6, 2048
    s_mov_b32 s23, 0
    s_lshl_b32 s3, s70, 11
    s_add_u32 s3, s3, 31588352
    s_mov_b32 s83, s3
    v_mov_b32 v44, 147512
    v_lshlrev_b32 v40, 7, v1
    v_add_u32 v40, s3, v40
    s_mov_b64 s[94:95], 0
    s_mov_b32 s96, 0x40000
    s_mov_b32 s12, s60
    s_mov_b32 s13, s61
    s_mov_b32 s14, 7340032
    s_mov_b32 s15, 0x20000
    v_bfe_u32 v5, v1, 4, 1
    s_and_b32 s7, s6, 1
    s_lshl_b32 s7, s7, 1
    v_or_b32 v5, s7, v5
    v_lshlrev_b32 v5, 1, v5
    v_xor_b32 v5, v3, v5
    v_lshlrev_b32 v5, 4, v5
    s_lshl_b32 s7, s4, 8
    v_add_u32 v5, s7, v5
    s_mul_i32 s7, s5, 3670016
    v_add_u32 v5, s7, v5
    s_lshl_b32 s7, s6, 3
    v_add_u32 v6, s7, v2
    v_mul_u32_u24 v6, 2048, v6
    v_add_u32 v5, v5, v6
    v_add_u32 v16, 0, v5
    v_add_u32 v17, 0, v5
    v_add_u32 v18, 128, v5
    v_add_u32 v19, 128, v5
    v_and_b32 v134, 15, v1
    v_lshrrev_b32 v132, 2, v134
    v_lshrrev_b32 v133, 4, v1
    v_lshl_add_u32 v132, v133, 3, v132
    v_mul_u32_u24 v132, 512, v132
    v_and_b32 v134, 3, v1
    v_lshl_add_u32 v132, v134, 3, v132
    v_and_b32 v133, 1, v133
    v_bfe_u32 v134, v1, 2, 2
    v_lshl_or_b32 v133, v133, 2, v134
    s_and_b32 s3, s71, 1
    s_lshl_b32 s3, s3, 1
    s_add_u32 s3, s3, s6
    v_add_u32 v132, 16384, v132
    s_add_u32 s7, s3, 4
    v_xor_b32 v134, s7, v133
    v_lshl_add_u32 v158, v134, 5, v132
    v_xor_b32 v134, s3, v133
    v_lshl_add_u32 v132, v134, 5, v132
    v_add_u32 v135, 49152, v132
    v_add_u32 v159, 49152, v158
    v_mov_b32 v128, 0x3f803f80
    v_mov_b32 v129, 0x3f803f80
    v_mov_b32 v130, 0x3f803f80
    v_mov_b32 v131, 0x3f803f80
    v_mov_b32 v64, 0
    v_mov_b32 v65, 0
    v_mov_b32 v66, 0
    v_mov_b32 v67, 0
    v_mov_b32 v68, 0
    v_mov_b32 v69, 0
    v_mov_b32 v70, 0
    v_mov_b32 v71, 0
    v_mov_b32 v72, 0
    v_mov_b32 v73, 0
    v_mov_b32 v74, 0
    v_mov_b32 v75, 0
    v_mov_b32 v76, 0
    v_mov_b32 v77, 0
    v_mov_b32 v78, 0
    v_mov_b32 v79, 0
    s_add_u32 s24, s68, 30408704
    s_addc_u32 s25, s69, 0
    s_mov_b32 s26, 229376
    s_mov_b32 s27, 0x20000
    s_add_u32 s28, s68, 29360128
    s_addc_u32 s29, s69, 0
    s_mov_b32 s30, 262144
    s_mov_b32 s31, 0x20000
    s_mov_b32 s76, s58
    s_mov_b32 s77, s59
    s_mov_b32 s78, 7168
    s_mov_b32 s79, 0x20000
    v_lshrrev_b32 v134, 4, v1
    v_lshlrev_b32 v134, 4, v134
    s_mul_i32 s3, s70, 14336
    s_mul_i32 s7, s71, 896
    s_add_u32 s3, s3, s7
    s_lshl_b32 s7, s6, 6
    s_add_u32 s3, s3, s7
    v_add_u32 v134, s3, v134
    v_and_b32 v133, 15, v1
    v_cmp_eq_u32 vcc, 0, v133
    v_mov_b32 v133, 0x7ffffff0
    s_nop 0
    v_cndmask_b32 v136, v133, v134, vcc
    s_lshl_b32 s3, s6, 6
    v_add_u32 v157, s3, v1
    s_cmp_ge_u32 s6, 2
    s_cselect_b32 s3, 0x7ffffff0, 0
    v_max_u32 v137, s3, v136
    v_lshlrev_b32 v138, 4, v1
    s_lshl_b32 s3, s70, 10
    s_lshl_b32 s7, s6, 16
    s_add_u32 s3, s3, s7
    v_add_u32 v138, s3, v138
    v_cmp_gt_u32 vcc, 56, v1
    v_lshlrev_b32 v134, 4, v1
    s_mul_i32 s3, s71, 896
    v_add_u32 v134, s3, v134
    v_cndmask_b32 v139, v133, v134, vcc
    v_cmp_gt_u32 vcc, 224, v157
    v_lshlrev_b32 v134, 1, v157
    s_mul_i32 s3, s71, 448
    v_add_u32 v134, s3, v134
    v_cndmask_b32 v156, v133, v134, vcc
    s_and_b32 s82, s70, 8
    s_mul_i32 s82, s82, 14336
    s_mul_i32 s3, s6, 28672
    s_add_u32 s82, s82, s3
    v_lshlrev_b32 v166, 4, v1
    s_lshl_b32 s3, s6, 10
    s_add_u32 s3, s3, 153856
    v_add_u32 v166, s3, v166
    s_add_u32 s84, s68, 31457280
    s_addc_u32 s85, s69, 0
    s_mov_b32 s86, 65536
    s_mov_b32 s87, 0x20000
    v_cmp_eq_u32 vcc, 0, v1
    s_lshl_b32 s7, s70, 2
    s_add_u32 s7, s7, s6
    s_lshl_b32 s7, s7, 3
    s_lshl_b32 s3, s71, 9
    s_add_u32 s7, s7, s3
    s_add_u32 s7, s7, 32768
    v_mov_b32 v134, s7
    v_cndmask_b32 v160, v133, v134, vcc
    v_mov_b32 v162, s74
    v_mov_b32 v163, s75
    v_lshlrev_b32 v168, 3, v1
    s_lshl_b32 s3, s71, 9
    s_add_u32 s3, s3, 31490048
    v_and_b32 v168, 0xff, v168
    s_and_b32 s7, s70, 8
    s_lshl_b32 s7, s7, 5
    s_add_u32 s3, s3, s7
    v_add_u32 v168, s3, v168
    s_cmp_eq_u32 s94, 0xffff
    s_cbranch_scc1 WR12_ok
    s_lshl_b32 s34, 1, s21
    s_andn2_b32 s3, s34, s94
    s_cbranch_scc0 WR12_ok
WR12_t:
    s_cmp_lg_u32 s6, 0
    s_cbranch_scc1 WR12_w
    s_mov_b64 exec, 0xffff
    global_load_dwordx2 v[42:43], v40, s[68:69] sc1
    s_max_u32 s96, s96, 1
    s_sub_u32 s96, s96, 1
    s_waitcnt vmcnt(0)
    v_cmp_eq_u64 s[94:95], s[74:75], v[42:43]
    s_mov_b64 exec, -1
    s_cmp_eq_u32 s96, 0
    s_cselect_b32 s94, 0xffff, s94
    s_cselect_b32 s96, 1, s96
    v_mov_b32 v45, s94
    ds_write_b32 v44, v45
    s_branch WR12_c
WR12_w:
    ds_read_b32 v45, v44
    s_sub_u32 s96, s96, 1
    s_cselect_b32 s96, 0, s96
    s_cselect_b32 s7, -1, 0
    s_waitcnt lgkmcnt(0)
    v_readfirstlane_b32 s3, v45
    s_nop 0
    s_or_b32 s94, s94, s3
    s_or_b32 s94, s94, s7
WR12_c:
    s_andn2_b32 s3, s34, s94
    s_cbranch_scc0 WR12_ok
    s_sleep 2
    s_branch WR12_t
WR12_ok:
    s_add_u32 m0, s22, 0
    s_nop 0
    buffer_load_dwordx4 v8, s[8:11], s20 offen offset:0 sc1 lds
    buffer_load_dwordx4 v8, s[8:11], s20 offen offset:1024 sc1 lds
    s_add_u32 m0, s22, 8192
    s_nop 0
    buffer_load_dwordx4 v9, s[8:11], s20 offen offset:0 sc1 lds
    buffer_load_dwordx4 v9, s[8:11], s20 offen offset:1024 sc1 lds
    s_add_u32 s20, s20, 2048
    s_add_u32 s21, s21, 1
    s_cmp_eq_u32 s21, 16
    s_cselect_b32 s21, 0, s21
    s_cselect_b32 s20, 0, s20
    s_add_u32 s22, s22, 49152
    s_add_u32 s23, s23, 1
    s_cmp_eq_u32 s23, 3
    s_cselect_b32 s7, 147456, 0
    s_cselect_b32 s23, 0, s23
    s_sub_u32 s22, s22, s7
    s_cmp_eq_u32 s94, 0xffff
    s_cbranch_scc1 LD3_x1
    s_lshl_b32 s34, 1, s21
    s_andn2_b32 s3, s34, s94
    s_cbranch_scc0 LD3_x1
    s_waitcnt vmcnt(0)
    s_barrier
    s_cmp_eq_u32 s94, 0xffff
    s_cbranch_scc1 WR13_ok
    s_lshl_b32 s34, 1, s21
    s_andn2_b32 s3, s34, s94
    s_cbranch_scc0 WR13_ok
WR13_t:
    s_cmp_lg_u32 s6, 0
    s_cbranch_scc1 WR13_w
    s_mov_b64 exec, 0xffff
    global_load_dwordx2 v[42:43], v40, s[68:69] sc1
    s_max_u32 s96, s96, 1
    s_sub_u32 s96, s96, 1
    s_waitcnt vmcnt(0)
    v_cmp_eq_u64 s[94:95], s[74:75], v[42:43]
    s_mov_b64 exec, -1
    s_cmp_eq_u32 s96, 0
    s_cselect_b32 s94, 0xffff, s94
    s_cselect_b32 s96, 1, s96
    v_mov_b32 v45, s94
    ds_write_b32 v44, v45
    s_branch WR13_c
WR13_w:
    ds_read_b32 v45, v44
    s_sub_u32 s96, s96, 1
    s_cselect_b32 s96, 0, s96
    s_cselect_b32 s7, -1, 0
    s_waitcnt lgkmcnt(0)
    v_readfirstlane_b32 s3, v45
    s_nop 0
    s_or_b32 s94, s94, s3
    s_or_b32 s94, s94, s7
WR13_c:
    s_andn2_b32 s3, s34, s94
    s_cbranch_scc0 WR13_ok
    s_sleep 2
    s_branch WR13_t
WR13_ok:
    s_add_u32 m0, s22, 0
    s_nop 0
    buffer_load_dwordx4 v8, s[8:11], s20 offen offset:0 sc1 lds
    buffer_load_dwordx4 v8, s[8:11], s20 offen offset:1024 sc1 lds
    s_add_u32 m0, s22, 8192
    s_nop 0
    buffer_load_dwordx4 v9, s[8:11], s20 offen offset:0 sc1 lds
    buffer_load_dwordx4 v9, s[8:11], s20 offen offset:1024 sc1 lds
    s_add_u32 s20, s20, 2048
    s_add_u32 s21, s21, 1
    s_cmp_eq_u32 s21, 16
    s_cselect_b32 s21, 0, s21
    s_cselect_b32 s20, 0, s20
    s_add_u32 s22, s22, 49152
    s_add_u32 s23, s23, 1
    s_cmp_eq_u32 s23, 3
    s_cselect_b32 s7, 147456, 0
    s_cselect_b32 s23, 0, s23
    s_sub_u32 s22, s22, s7
    s_branch LD3_x2
LD3_x1:
    s_add_u32 m0, s22, 0
    s_nop 0
    buffer_load_dwordx4 v8, s[8:11], s20 offen offset:0 sc1 lds
    buffer_load_dwordx4 v8, s[8:11], s20 offen offset:1024 sc1 lds
    s_add_u32 m0, s22, 8192
    s_nop 0
    buffer_load_dwordx4 v9, s[8:11], s20 offen offset:0 sc1 lds
    buffer_load_dwordx4 v9, s[8:11], s20 offen offset:1024 sc1 lds
    s_waitcnt vmcnt(4)
    s_barrier
    s_add_u32 s20, s20, 2048
    s_add_u32 s21, s21, 1
    s_cmp_eq_u32 s21, 16
    s_cselect_b32 s21, 0, s21
    s_cselect_b32 s20, 0, s20
    s_add_u32 s22, s22, 49152
    s_add_u32 s23, s23, 1
    s_cmp_eq_u32 s23, 3
    s_cselect_b32 s7, 147456, 0
    s_cselect_b32 s23, 0, s23
    s_sub_u32 s22, s22, s7
LD3_x2:
    s_cmp_eq_u32 s94, 0xffff
    s_cbranch_scc1 WR14_ok
    s_lshl_b32 s34, 1, s21
    s_andn2_b32 s3, s34, s94
    s_cbranch_scc0 WR14_ok
WR14_t:
    s_mov_b64 exec, 0xffff
    global_load_dwordx2 v[42:43], v40, s[68:69] sc1
    s_max_u32 s96, s96, 1
    s_sub_u32 s96, s96, 1
    s_waitcnt vmcnt(0)
    v_cmp_eq_u64 s[94:95], s[74:75], v[42:43]
    s_mov_b64 exec, -1
    s_cmp_eq_u32 s96, 0
    s_cselect_b32 s94, 0xffff, s94
    s_cselect_b32 s96, 1, s96
    s_andn2_b32 s3, s34, s94
    s_cbranch_scc0 WR14_ok
    s_sleep 2
    s_branch WR14_t
WR14_ok:
    s_add_u32 m0, s42, 0
    s_nop 0
    buffer_load_dwordx4 v24, s[16:19], s40 offen lds
    s_add_u32 s21, s21, 1
    s_cmp_eq_u32 s21, 16
    s_cselect_b32 s21, 0, s21
    s_mul_i32 s90, s21, 2048
    s_add_u32 m0, s22, 0
    s_nop 0
    buffer_load_dwordx4 v8, s[8:11], s20 offen offset:0 sc1 lds
    s_mul_i32 s91, s21, 458752
    s_add_u32 s23, s23, 1
    s_cmp_eq_u32 s23, 3
    s_cselect_b32 s93, 147456, 0
    s_cselect_b32 s23, 0, s23
    s_add_u32 m0, s42, 4096
    s_nop 0
    buffer_load_dwordx4 v25, s[16:19], s40 offen lds
    s_sub_u32 s93, 49152, s93
    ds_read_b64_tr_b16 v[96:97], v132 offset:0
    ds_read_b64_tr_b16 v[98:99], v132 offset:2048
    s_add_u32 m0, s22, 0
    s_nop 0
    buffer_load_dwordx4 v8, s[8:11], s20 offen offset:1024 sc1 lds
    ds_read_b64_tr_b16 v[100:101], v158 offset:0
    ds_read_b64_tr_b16 v[102:103], v158 offset:2048
    ds_read_b64_tr_b16 v[104:105], v132 offset:256
    s_add_u32 m0, s42, 8192
    s_nop 0
    buffer_load_dwordx4 v26, s[16:19], s40 offen lds
    ds_read_b64_tr_b16 v[106:107], v132 offset:2304
    ds_read_b64_tr_b16 v[108:109], v158 offset:256
    ds_read_b64_tr_b16 v[110:111], v158 offset:2304
    s_add_u32 m0, s22, 8192
    s_nop 0
    buffer_load_dwordx4 v9, s[8:11], s20 offen offset:0 sc1 lds
    ds_read_b64_tr_b16 v[112:113], v132 offset:16384
    ds_read_b64_tr_b16 v[114:115], v132 offset:18432
    ds_read_b64_tr_b16 v[116:117], v158 offset:16384
    s_add_u32 m0, s42, 12288
    s_nop 0
    buffer_load_dwordx4 v27, s[16:19], s40 offen lds
    ds_read_b64_tr_b16 v[118:119], v158 offset:18432
    ds_read_b64_tr_b16 v[120:121], v132 offset:16640
    ds_read_b64_tr_b16 v[122:123], v132 offset:18688
    s_add_u32 m0, s22, 8192
    s_nop 0
    buffer_load_dwordx4 v9, s[8:11], s20 offen offset:1024 sc1 lds
    s_waitcnt lgkmcnt(8)
    ds_read_b64_tr_b16 v[124:125], v158 offset:16640
    ds_read_b64_tr_b16 v[126:127], v158 offset:18688
    s_add_u32 m0, s42, 16384
    s_nop 0
    buffer_load_dwordx4 v28, s[16:19], s40 offen lds
    s_add_u32 m0, s42, 20480
    s_nop 0
    buffer_load_dwordx4 v29, s[16:19], s40 offen lds
    s_add_u32 m0, s42, 24576
    s_nop 0
    buffer_load_dwordx4 v30, s[16:19], s40 offen lds
    s_add_u32 m0, s42, 28672
    s_nop 0
    buffer_load_dwordx4 v31, s[16:19], s40 offen lds
    s_mov_b32 s20, s90
    s_mov_b32 s40, s91
    s_add_u32 s22, s22, s93
    s_add_u32 s42, s42, s93
    s_waitcnt vmcnt(12) lgkmcnt(0)
    s_barrier
    s_setprio 3
    s_cmp_eq_u32 s94, 0xffff
    s_cbranch_scc1 WR15_ok
    s_lshl_b32 s34, 1, s21
    s_andn2_b32 s3, s34, s94
    s_cbranch_scc0 WR15_ok
WR15_t:
    s_mov_b64 exec, 0xffff
    global_load_dwordx2 v[42:43], v40, s[68:69] sc1
    s_max_u32 s96, s96, 1
    s_sub_u32 s96, s96, 1
    s_waitcnt vmcnt(0)
    v_cmp_eq_u64 s[94:95], s[74:75], v[42:43]
    s_mov_b64 exec, -1
    s_cmp_eq_u32 s96, 0
    s_cselect_b32 s94, 0xffff, s94
    s_cselect_b32 s96, 1, s96
    s_andn2_b32 s3, s34, s94
    s_cbranch_scc0 WR15_ok
    s_sleep 2
    s_branch WR15_t
WR15_ok:
    s_add_u32 m0, s42, 0
    s_nop 0
    buffer_load_dwordx4 v24, s[16:19], s40 offen lds
    s_add_u32 s21, s21, 1
    s_cmp_eq_u32 s21, 16
    s_cselect_b32 s21, 0, s21
    s_mul_i32 s90, s21, 2048
    s_add_u32 m0, s22, 0
    s_nop 0
    buffer_load_dwordx4 v8, s[8:11], s20 offen offset:0 sc1 lds
    s_mul_i32 s91, s21, 458752
    s_add_u32 s23, s23, 1
    s_cmp_eq_u32 s23, 3
    s_cselect_b32 s93, 147456, 0
    s_cselect_b32 s23, 0, s23
    s_add_u32 m0, s42, 4096
    s_nop 0
    buffer_load_dwordx4 v25, s[16:19], s40 offen lds
    s_sub_u32 s93, 49152, s93
    v_mfma_f32_16x16x32_bf16 v[64:67], v[96:99], v[128:131], v[64:67]
    v_mfma_f32_16x16x32_bf16 v[68:71], v[100:103], v[128:131], v[68:71]
    s_add_u32 m0, s22, 0
    s_nop 0
    buffer_load_dwordx4 v8, s[8:11], s20 offen offset:1024 sc1 lds
    v_mfma_f32_16x16x32_bf16 v[72:75], v[104:107], v[128:131], v[72:75]
    v_mfma_f32_16x16x32_bf16 v[76:79], v[108:111], v[128:131], v[76:79]
    v_mfma_f32_16x16x32_bf16 v[64:67], v[112:115], v[128:131], v[64:67]
    s_add_u32 m0, s42, 8192
    s_nop 0
    buffer_load_dwordx4 v26, s[16:19], s40 offen lds
    v_mfma_f32_16x16x32_bf16 v[68:71], v[116:119], v[128:131], v[68:71]
    v_mfma_f32_16x16x32_bf16 v[72:75], v[120:123], v[128:131], v[72:75]
    v_mfma_f32_16x16x32_bf16 v[76:79], v[124:127], v[128:131], v[76:79]
    s_add_u32 m0, s22, 8192
    s_nop 0
    buffer_load_dwordx4 v9, s[8:11], s20 offen offset:0 sc1 lds
    ds_read_b64_tr_b16 v[96:97], v135 offset:0
    ds_read_b64_tr_b16 v[98:99], v135 offset:2048
    ds_read_b64_tr_b16 v[100:101], v159 offset:0
    s_add_u32 m0, s42, 12288
    s_nop 0
    buffer_load_dwordx4 v27, s[16:19], s40 offen lds
    ds_read_b64_tr_b16 v[102:103], v159 offset:2048
    ds_read_b64_tr_b16 v[104:105], v135 offset:256
    ds_read_b64_tr_b16 v[106:107], v135 offset:2304
    s_add_u32 m0, s22, 8192
    s_nop 0
    buffer_load_dwordx4 v9, s[8:11], s20 offen offset:1024 sc1 lds
    ds_read_b64_tr_b16 v[108:109], v159 offset:256
    ds_read_b64_tr_b16 v[110:111], v159 offset:2304
    ds_read_b64_tr_b16 v[112:113], v135 offset:16384
    s_add_u32 m0, s42, 16384
    s_nop 0
    buffer_load_dwordx4 v28, s[16:19], s40 offen lds
    ds_read_b64_tr_b16 v[114:115], v135 offset:18432
    ds_read_b64_tr_b16 v[116:117], v159 offset:16384
    ds_read_b64_tr_b16 v[118:119], v159 offset:18432
    s_add_u32 m0, s42, 20480
    s_nop 0
    buffer_load_dwordx4 v29, s[16:19], s40 offen lds
    ds_read_b64_tr_b16 v[120:121], v135 offset:16640
    ds_read_b64_tr_b16 v[122:123], v135 offset:18688
    s_waitcnt lgkmcnt(8)
    ds_read_b64_tr_b16 v[124:125], v159 offset:16640
    s_add_u32 m0, s42, 24576
    s_nop 0
    buffer_load_dwordx4 v30, s[16:19], s40 offen lds
    ds_read_b64_tr_b16 v[126:127], v159 offset:18688
    s_add_u32 m0, s42, 28672
    s_nop 0
    buffer_load_dwordx4 v31, s[16:19], s40 offen lds
    s_mov_b32 s20, s90
    s_mov_b32 s40, s91
    s_add_u32 s22, s22, s93
    s_add_u32 s42, s42, s93
    s_setprio 0
    s_waitcnt vmcnt(12) lgkmcnt(0)
    s_barrier
    s_setprio 3
    s_cmp_eq_u32 s94, 0xffff
    s_cbranch_scc1 WR16_ok
    s_lshl_b32 s34, 1, s21
    s_andn2_b32 s3, s34, s94
    s_cbranch_scc0 WR16_ok
WR16_t:
    s_mov_b64 exec, 0xffff
    global_load_dwordx2 v[42:43], v40, s[68:69] sc1
    s_max_u32 s96, s96, 1
    s_sub_u32 s96, s96, 1
    s_waitcnt vmcnt(0)
    v_cmp_eq_u64 s[94:95], s[74:75], v[42:43]
    s_mov_b64 exec, -1
    s_cmp_eq_u32 s96, 0
    s_cselect_b32 s94, 0xffff, s94
    s_cselect_b32 s96, 1, s96
    s_andn2_b32 s3, s34, s94
    s_cbranch_scc0 WR16_ok
    s_sleep 2
    s_branch WR16_t
WR16_ok:
    s_add_u32 m0, s42, 0
    s_nop 0
    buffer_load_dwordx4 v24, s[16:19], s40 offen lds
    s_add_u32 s21, s21, 1
    s_cmp_eq_u32 s21, 16
    s_cselect_b32 s21, 0, s21
    s_add_u32 m0, s22, 0
    s_nop 0
    buffer_load_dwordx4 v8, s[8:11], s20 offen offset:0 sc1 lds
    s_mul_i32 s90, s21, 2048
    s_mul_i32 s91, s21, 458752
    s_add_u32 m0, s42, 4096
    s_nop 0
    buffer_load_dwordx4 v25, s[16:19], s40 offen lds
    s_add_u32 s23, s23, 1
    s_cmp_eq_u32 s23, 3
    s_cselect_b32 s93, 147456, 0
    s_cselect_b32 s23, 0, s23
    s_add_u32 m0, s22, 0
    s_nop 0
    buffer_load_dwordx4 v8, s[8:11], s20 offen offset:1024 sc1 lds
    s_sub_u32 s93, 49152, s93
    v_mfma_f32_16x16x32_bf16 v[64:67], v[96:99], v[128:131], v[64:67]
    s_add_u32 m0, s42, 8192
    s_nop 0
    buffer_load_dwordx4 v26, s[16:19], s40 offen lds
    v_mfma_f32_16x16x32_bf16 v[68:71], v[100:103], v[128:131], v[68:71]
    v_mfma_f32_16x16x32_bf16 v[72:75], v[104:107], v[128:131], v[72:75]
    s_add_u32 m0, s22, 8192
    s_nop 0
    buffer_load_dwordx4 v9, s[8:11], s20 offen offset:0 sc1 lds
    v_mfma_f32_16x16x32_bf16 v[76:79], v[108:111], v[128:131], v[76:79]
    v_mfma_f32_16x16x32_bf16 v[64:67], v[112:115], v[128:131], v[64:67]
    s_add_u32 m0, s42, 12288
    s_nop 0
    buffer_load_dwordx4 v27, s[16:19], s40 offen lds
    v_mfma_f32_16x16x32_bf16 v[68:71], v[116:119], v[128:131], v[68:71]
    v_mfma_f32_16x16x32_bf16 v[72:75], v[120:123], v[128:131], v[72:75]
    s_add_u32 m0, s22, 8192
    s_nop 0
    buffer_load_dwordx4 v9, s[8:11], s20 offen offset:1024 sc1 lds
    v_mfma_f32_16x16x32_bf16 v[76:79], v[124:127], v[128:131], v[76:79]
    s_add_u32 m0, s42, 16384
    s_nop 0
    buffer_load_dwordx4 v28, s[16:19], s40 offen lds
    s_add_u32 m0, s42, 20480
    s_nop 0
    buffer_load_dwordx4 v29, s[16:19], s40 offen lds
    s_add_u32 m0, s42, 24576
    s_nop 0
    buffer_load_dwordx4 v30, s[16:19], s40 offen lds
    s_add_u32 m0, s42, 28672
    s_nop 0
    buffer_load_dwordx4 v31, s[16:19], s40 offen lds
    s_mov_b32 s20, s90
    s_mov_b32 s40, s91
    s_add_u32 s22, s22, s93
    s_add_u32 s42, s42, s93
    s_setprio 0
    s_load_dwordx2 s[100:101], s[88:89], 60
    s_load_dwordx2 s[100:101], s[88:89], 188
    s_load_dwordx2 s[100:101], s[88:89], 316
    s_add_u32 s88, s88, 384
    s_addc_u32 s89, s89, 0
    s_waitcnt vmcnt(12)
    s_barrier
    s_cmp_eq_u32 s94, 0xffff
    s_cbranch_scc1 WR17_ok
    s_lshl_b32 s34, 1, s21
    s_andn2_b32 s3, s34, s94
    s_cbranch_scc0 WR17_ok
WR17_t:
    s_mov_b64 exec, 0xffff
    global_load_dwordx2 v[42:43], v40, s[68:69] sc1
    s_max_u32 s96, s96, 1
    s_sub_u32 s96, s96, 1
    s_waitcnt vmcnt(0)
    v_cmp_eq_u64 s[94:95], s[74:75], v[42:43]
    s_mov_b64 exec, -1
    s_cmp_eq_u32 s96, 0
    s_cselect_b32 s94, 0xffff, s94
    s_cselect_b32 s96, 1, s96
    s_andn2_b32 s3, s34, s94
    s_cbranch_scc0 WR17_ok
    s_sleep 2
    s_branch WR17_t
WR17_ok:
    s_add_u32 m0, s42, 0
    s_nop 0
    buffer_load_dwordx4 v24, s[16:19], s40 offen lds
    s_add_u32 s21, s21, 1
    s_add_u32 m0, s22, 0
    s_nop 0
    buffer_load_dwordx4 v8, s[8:11], s20 offen offset:0 sc1 lds
    s_cmp_eq_u32 s21, 16
    s_cselect_b32 s21, 0, s21
    s_add_u32 m0, s42, 4096
    s_nop 0
    buffer_load_dwordx4 v25, s[16:19], s40 offen lds
    s_mul_i32 s90, s21, 2048
    s_add_u32 m0, s22, 0
    s_nop 0
    buffer_load_dwordx4 v8, s[8:11], s20 offen offset:1024 sc1 lds
    s_mul_i32 s91, s21, 458752
    s_add_u32 m0, s42, 8192
    s_nop 0
    buffer_load_dwordx4 v26, s[16:19], s40 offen lds
    s_add_u32 s23, s23, 1
    s_add_u32 m0, s22, 8192
    s_nop 0
    buffer_load_dwordx4 v9, s[8:11], s20 offen offset:0 sc1 lds
    s_cmp_eq_u32 s23, 3
    s_cselect_b32 s93, 147456, 0
    s_cselect_b32 s23, 0, s23
    s_add_u32 m0, s42, 12288
    s_nop 0
    buffer_load_dwordx4 v27, s[16:19], s40 offen lds
    s_sub_u32 s93, 49152, s93
    s_add_u32 m0, s22, 8192
    s_nop 0
    buffer_load_dwordx4 v9, s[8:11], s20 offen offset:1024 sc1 lds
    s_mov_b32 exec_lo, 0x10001
    s_mov_b32 exec_hi, 0x10001
    buffer_store_dwordx4 v[64:67], v136, s[24:27], 0 offen offset:0 sc1
    s_mov_b64 exec, -1
    s_add_u32 m0, s42, 16384
    s_nop 0
    buffer_load_dwordx4 v28, s[16:19], s40 offen lds
    s_mov_b32 exec_lo, 0x10001
    s_mov_b32 exec_hi, 0x10001
    buffer_store_dwordx4 v[68:71], v136, s[24:27], 0 offen offset:256 sc1
    s_mov_b64 exec, -1
    s_add_u32 m0, s42, 20480
    s_nop 0
    buffer_load_dwordx4 v29, s[16:19], s40 offen lds
    s_mov_b32 exec_lo, 0x10001
    s_mov_b32 exec_hi, 0x10001
    buffer_store_dwordx4 v[72:75], v136, s[24:27], 0 offen offset:512 sc1
    s_mov_b64 exec, -1
    s_add_u32 m0, s42, 24576
    s_nop 0
    buffer_load_dwordx4 v30, s[16:19], s40 offen lds
    s_mov_b32 exec_lo, 0x10001
    s_mov_b32 exec_hi, 0x10001
    buffer_store_dwordx4 v[76:79], v137, s[24:27], 0 offen offset:768 sc1
    s_mov_b64 exec, -1
    s_add_u32 m0, s42, 28672
    s_nop 0
    buffer_load_dwordx4 v31, s[16:19], s40 offen lds
    s_mov_b32 s20, s90
    s_mov_b32 s40, s91
    s_add_u32 s22, s22, s93
    s_add_u32 s42, s42, s93
    s_load_dwordx2 s[100:101], s[88:89], 60
    s_load_dwordx2 s[100:101], s[88:89], 188
    s_load_dwordx2 s[100:101], s[88:89], 316
    s_add_u32 s88, s88, 384
    s_addc_u32 s89, s89, 0
    s_waitcnt vmcnt(12)
    s_barrier
    s_mov_b32 s44, 1
LD3_lt0:
    s_cmp_eq_u32 s94, 0xffff
    s_cbranch_scc1 WR18_ok
    s_lshl_b32 s34, 1, s21
    s_andn2_b32 s3, s34, s94
    s_cbranch_scc0 WR18_ok
WR18_t:
    s_mov_b64 exec, 0xffff
    global_load_dwordx2 v[42:43], v40, s[68:69] sc1
    s_max_u32 s96, s96, 1
    s_sub_u32 s96, s96, 1
    s_waitcnt vmcnt(0)
    v_cmp_eq_u64 s[94:95], s[74:75], v[42:43]
    s_mov_b64 exec, -1
    s_cmp_eq_u32 s96, 0
    s_cselect_b32 s94, 0xffff, s94
    s_cselect_b32 s96, 1, s96
    s_andn2_b32 s3, s34, s94
    s_cbranch_scc0 WR18_ok
    s_sleep 2
    s_branch WR18_t
WR18_ok:
    s_add_u32 m0, s42, 0
    s_nop 0
    buffer_load_dwordx4 v24, s[16:19], s40 offen lds
    s_add_u32 s21, s21, 1
    s_add_u32 m0, s22, 0
    s_nop 0
    buffer_load_dwordx4 v8, s[8:11], s20 offen offset:0 sc1 lds
    s_cmp_eq_u32 s21, 16
    s_cselect_b32 s21, 0, s21
    s_add_u32 m0, s42, 4096
    s_nop 0
    buffer_load_dwordx4 v25, s[16:19], s40 offen lds
    s_mul_i32 s90, s21, 2048
    s_add_u32 m0, s22, 0
    s_nop 0
    buffer_load_dwordx4 v8, s[8:11], s20 offen offset:1024 sc1 lds
    s_mul_i32 s91, s21, 458752
    s_add_u32 m0, s42, 8192
    s_nop 0
    buffer_load_dwordx4 v26, s[16:19], s40 offen lds
    s_add_u32 s23, s23, 1
    s_add_u32 m0, s22, 8192
    s_nop 0
    buffer_load_dwordx4 v9, s[8:11], s20 offen offset:0 sc1 lds
    s_cmp_eq_u32 s23, 3
    s_cselect_b32 s93, 147456, 0
    s_cselect_b32 s23, 0, s23
    s_add_u32 m0, s42, 12288
    s_nop 0
    buffer_load_dwordx4 v27, s[16:19], s40 offen lds
    s_sub_u32 s93, 49152, s93
    s_add_u32 m0, s22, 8192
    s_nop 0
    buffer_load_dwordx4 v9, s[8:11], s20 offen offset:1024 sc1 lds
    s_add_u32 m0, s42, 16384
    s_nop 0
    buffer_load_dwordx4 v28, s[16:19], s40 offen lds
    s_add_u32 m0, s42, 20480
    s_nop 0
    buffer_load_dwordx4 v29, s[16:19], s40 offen lds
    s_add_u32 m0, s42, 24576
    s_nop 0
    buffer_load_dwordx4 v30, s[16:19], s40 offen lds
    s_add_u32 m0, s42, 28672
    s_nop 0
    buffer_load_dwordx4 v31, s[16:19], s40 offen lds
    s_mov_b32 s20, s90
    s_mov_b32 s40, s91
    s_add_u32 s22, s22, s93
    s_add_u32 s42, s42, s93
    s_load_dwordx2 s[100:101], s[88:89], 60
    s_load_dwordx2 s[100:101], s[88:89], 188
    s_load_dwordx2 s[100:101], s[88:89], 316
    s_add_u32 s88, s88, 384
    s_addc_u32 s89, s89, 0
    s_waitcnt vmcnt(12)
    s_barrier
    s_sub_u32 s44, s44, 1
    s_cmp_lg_u32 s44, 0
    s_cbranch_scc1 LD3_lt0
    s_cmp_eq_u32 s94, 0xffff
    s_cbranch_scc1 WR19_ok
    s_lshl_b32 s34, 1, s21
    s_andn2_b32 s3, s34, s94
    s_cbranch_scc0 WR19_ok
WR19_t:
    s_mov_b64 exec, 0xffff
    global_load_dwordx2 v[42:43], v40, s[68:69] sc1
    s_max_u32 s96, s96, 1
    s_sub_u32 s96, s96, 1
    s_waitcnt vmcnt(0)
    v_cmp_eq_u64 s[94:95], s[74:75], v[42:43]
    s_mov_b64 exec, -1
    s_cmp_eq_u32 s96, 0
    s_cselect_b32 s94, 0xffff, s94
    s_cselect_b32 s96, 1, s96
    s_andn2_b32 s3, s34, s94
    s_cbranch_scc0 WR19_ok
    s_sleep 2
    s_branch WR19_t
WR19_ok:
    s_add_u32 m0, s42, 0
    s_nop 0
    buffer_load_dwordx4 v24, s[16:19], s40 offen lds
    s_add_u32 s21, s21, 1
    s_add_u32 m0, s22, 0
    s_nop 0
    buffer_load_dwordx4 v8, s[8:11], s20 offen offset:0 sc1 lds
    s_cmp_eq_u32 s21, 16
    s_cselect_b32 s21, 0, s21
    s_add_u32 m0, s42, 4096
    s_nop 0
    buffer_load_dwordx4 v25, s[16:19], s40 offen lds
    s_mul_i32 s90, s21, 2048
    s_add_u32 m0, s22, 0
    s_nop 0
    buffer_load_dwordx4 v8, s[8:11], s20 offen offset:1024 sc1 lds
    s_mul_i32 s91, s21, 458752
    s_add_u32 m0, s42, 8192
    s_nop 0
    buffer_load_dwordx4 v26, s[16:19], s40 offen lds
    s_add_u32 s23, s23, 1
    s_add_u32 m0, s22, 8192
    s_nop 0
    buffer_load_dwordx4 v9, s[8:11], s20 offen offset:0 sc1 lds
    s_cmp_eq_u32 s23, 3
    s_cselect_b32 s93, 147456, 0
    s_cselect_b32 s23, 0, s23
    s_add_u32 m0, s42, 12288
    s_nop 0
    buffer_load_dwordx4 v27, s[16:19], s40 offen lds
    s_sub_u32 s93, 49152, s93
    s_add_u32 m0, s22, 8192
    s_nop 0
    buffer_load_dwordx4 v9, s[8:11], s20 offen offset:1024 sc1 lds
    s_mov_b64 exec, 1
    buffer_store_dwordx2 v[162:163], v160, s[84:87], 0 offen sc1
    s_mov_b64 exec, -1
    s_add_u32 m0, s42, 16384
    s_nop 0
    buffer_load_dwordx4 v28, s[16:19], s40 offen lds
    s_add_u32 m0, s42, 20480
    s_nop 0
    buffer_load_dwordx4 v29, s[16:19], s40 offen lds
    s_add_u32 m0, s42, 24576
    s_nop 0
    buffer_load_dwordx4 v30, s[16:19], s40 offen lds
    s_add_u32 m0, s42, 28672
    s_nop 0
    buffer_load_dwordx4 v31, s[16:19], s40 offen lds
    s_mov_b32 s20, s90
    s_mov_b32 s40, s91
    s_add_u32 s22, s22, s93
    s_add_u32 s42, s42, s93
    s_load_dwordx2 s[100:101], s[88:89], 60
    s_load_dwordx2 s[100:101], s[88:89], 188
    s_load_dwordx2 s[100:101], s[88:89], 316
    s_add_u32 s88, s88, 384
    s_addc_u32 s89, s89, 0
    s_waitcnt vmcnt(12)
    s_barrier
    s_mov_b32 s44, 5
LD3_lt1:
    s_cmp_eq_u32 s94, 0xffff
    s_cbranch_scc1 WR20_ok
    s_lshl_b32 s34, 1, s21
    s_andn2_b32 s3, s34, s94
    s_cbranch_scc0 WR20_ok
WR20_t:
    s_mov_b64 exec, 0xffff
    global_load_dwordx2 v[42:43], v40, s[68:69] sc1
    s_max_u32 s96, s96, 1
    s_sub_u32 s96, s96, 1
    s_waitcnt vmcnt(0)
    v_cmp_eq_u64 s[94:95], s[74:75], v[42:43]
    s_mov_b64 exec, -1
    s_cmp_eq_u32 s96, 0
    s_cselect_b32 s94, 0xffff, s94
    s_cselect_b32 s96, 1, s96
    s_andn2_b32 s3, s34, s94
    s_cbranch_scc0 WR20_ok
    s_sleep 2
    s_branch WR20_t
WR20_ok:
    s_add_u32 m0, s42, 0
    s_nop 0
    buffer_load_dwordx4 v24, s[16:19], s40 offen lds
    s_add_u32 s21, s21, 1
    s_add_u32 m0, s22, 0
    s_nop 0
    buffer_load_dwordx4 v8, s[8:11], s20 offen offset:0 sc1 lds
    s_cmp_eq_u32 s21, 16
    s_cselect_b32 s21, 0, s21
    s_add_u32 m0, s42, 4096
    s_nop 0
    buffer_load_dwordx4 v25, s[16:19], s40 offen lds
    s_mul_i32 s90, s21, 2048
    s_add_u32 m0, s22, 0
    s_nop 0
    buffer_load_dwordx4 v8, s[8:11], s20 offen offset:1024 sc1 lds
    s_mul_i32 s91, s21, 458752
    s_add_u32 m0, s42, 8192
    s_nop 0
    buffer_load_dwordx4 v26, s[16:19], s40 offen lds
    s_add_u32 s23, s23, 1
    s_add_u32 m0, s22, 8192
    s_nop 0
    buffer_load_dwordx4 v9, s[8:11], s20 offen offset:0 sc1 lds
    s_cmp_eq_u32 s23, 3
    s_cselect_b32 s93, 147456, 0
    s_cselect_b32 s23, 0, s23
    s_add_u32 m0, s42, 12288
    s_nop 0
    buffer_load_dwordx4 v27, s[16:19], s40 offen lds
    s_sub_u32 s93, 49152, s93
    s_add_u32 m0, s22, 8192
    s_nop 0
    buffer_load_dwordx4 v9, s[8:11], s20 offen offset:1024 sc1 lds
    s_add_u32 m0, s42, 16384
    s_nop 0
    buffer_load_dwordx4 v28, s[16:19], s40 offen lds
    s_add_u32 m0, s42, 20480
    s_nop 0
    buffer_load_dwordx4 v29, s[16:19], s40 offen lds
    s_add_u32 m0, s42, 24576
    s_nop 0
    buffer_load_dwordx4 v30, s[16:19], s40 offen lds
    s_add_u32 m0, s42, 28672
    s_nop 0
    buffer_load_dwordx4 v31, s[16:19], s40 offen lds
    s_mov_b32 s20, s90
    s_mov_b32 s40, s91
    s_add_u32 s22, s22, s93
    s_add_u32 s42, s42, s93
    s_load_dwordx2 s[100:101], s[88:89], 60
    s_load_dwordx2 s[100:101], s[88:89], 188
    s_load_dwordx2 s[100:101], s[88:89], 316
    s_add_u32 s88, s88, 384
    s_addc_u32 s89, s89, 0
    s_waitcnt vmcnt(12)
    s_barrier
    s_sub_u32 s44, s44, 1
    s_cmp_lg_u32 s44, 0
    s_cbranch_scc1 LD3_lt1
    s_cmp_eq_u32 s94, 0xffff
    s_cbranch_scc1 WR21_ok
    s_lshl_b32 s34, 1, s21
    s_andn2_b32 s3, s34, s94
    s_cbranch_scc0 WR21_ok
WR21_t:
    s_mov_b64 exec, 0xffff
    global_load_dwordx2 v[42:43], v40, s[68:69] sc1
    s_max_u32 s96, s96, 1
    s_sub_u32 s96, s96, 1
    s_waitcnt vmcnt(0)
    v_cmp_eq_u64 s[94:95], s[74:75], v[42:43]
    s_mov_b64 exec, -1
    s_cmp_eq_u32 s96, 0
    s_cselect_b32 s94, 0xffff, s94
    s_cselect_b32 s96, 1, s96
    s_andn2_b32 s3, s34, s94
    s_cbranch_scc0 WR21_ok
    s_sleep 2
    s_branch WR21_t
WR21_ok:
    s_add_u32 m0, s42, 0
    s_nop 0
    buffer_load_dwordx4 v24, s[16:19], s40 offen lds
    s_add_u32 s21, s21, 1
    s_add_u32 m0, s22, 0
    s_nop 0
    buffer_load_dwordx4 v8, s[8:11], s20 offen offset:0 sc1 lds
    s_cmp_eq_u32 s21, 16
    s_cselect_b32 s21, 0, s21
    s_add_u32 m0, s42, 4096
    s_nop 0
    buffer_load_dwordx4 v25, s[16:19], s40 offen lds
    s_mul_i32 s90, s21, 2048
    s_add_u32 m0, s22, 0
    s_nop 0
    buffer_load_dwordx4 v8, s[8:11], s20 offen offset:1024 sc1 lds
    s_mul_i32 s91, s21, 458752
    s_add_u32 m0, s42, 8192
    s_nop 0
    buffer_load_dwordx4 v26, s[16:19], s40 offen lds
    s_add_u32 s23, s23, 1
    s_add_u32 m0, s22, 8192
    s_nop 0
    buffer_load_dwordx4 v9, s[8:11], s20 offen offset:0 sc1 lds
    s_cmp_eq_u32 s23, 3
    s_cselect_b32 s93, 147456, 0
    s_cselect_b32 s23, 0, s23
    s_add_u32 m0, s42, 12288
    s_nop 0
    buffer_load_dwordx4 v27, s[16:19], s40 offen lds
    s_sub_u32 s93, 49152, s93
    s_add_u32 m0, s22, 8192
    s_nop 0
    buffer_load_dwordx4 v9, s[8:11], s20 offen offset:1024 sc1 lds
    global_load_dwordx2 v[172:173], v168, s[68:69] sc1
    s_add_u32 m0, s42, 16384
    s_nop 0
    buffer_load_dwordx4 v28, s[16:19], s40 offen lds
    s_add_u32 m0, s42, 20480
    s_nop 0
    buffer_load_dwordx4 v29, s[16:19], s40 offen lds
    s_add_u32 m0, s42, 24576
    s_nop 0
    buffer_load_dwordx4 v30, s[16:19], s40 offen lds
    s_add_u32 m0, s42, 28672
    s_nop 0
    buffer_load_dwordx4 v31, s[16:19], s40 offen lds
    s_mov_b32 s20, s90
    s_mov_b32 s40, s91
    s_add_u32 s22, s22, s93
    s_add_u32 s42, s42, s93
    s_load_dwordx2 s[100:101], s[88:89], 60
    s_load_dwordx2 s[100:101], s[88:89], 188
    s_load_dwordx2 s[100:101], s[88:89], 316
    s_add_u32 s88, s88, 384
    s_addc_u32 s89, s89, 0
    s_waitcnt vmcnt(12)
    s_barrier
    s_mov_b32 s44, 1
LD3_lt2:
    s_cmp_eq_u32 s94, 0xffff
    s_cbranch_scc1 WR22_ok
    s_lshl_b32 s34, 1, s21
    s_andn2_b32 s3, s34, s94
    s_cbranch_scc0 WR22_ok
WR22_t:
    s_mov_b64 exec, 0xffff
    global_load_dwordx2 v[42:43], v40, s[68:69] sc1
    s_max_u32 s96, s96, 1
    s_sub_u32 s96, s96, 1
    s_waitcnt vmcnt(0)
    v_cmp_eq_u64 s[94:95], s[74:75], v[42:43]
    s_mov_b64 exec, -1
    s_cmp_eq_u32 s96, 0
    s_cselect_b32 s94, 0xffff, s94
    s_cselect_b32 s96, 1, s96
    s_andn2_b32 s3, s34, s94
    s_cbranch_scc0 WR22_ok
    s_sleep 2
    s_branch WR22_t
WR22_ok:
    s_add_u32 m0, s42, 0
    s_nop 0
    buffer_load_dwordx4 v24, s[16:19], s40 offen lds
    s_add_u32 s21, s21, 1
    s_add_u32 m0, s22, 0
    s_nop 0
    buffer_load_dwordx4 v8, s[8:11], s20 offen offset:0 sc1 lds
    s_cmp_eq_u32 s21, 16
    s_cselect_b32 s21, 0, s21
    s_add_u32 m0, s42, 4096
    s_nop 0
    buffer_load_dwordx4 v25, s[16:19], s40 offen lds
    s_mul_i32 s90, s21, 2048
    s_add_u32 m0, s22, 0
    s_nop 0
    buffer_load_dwordx4 v8, s[8:11], s20 offen offset:1024 sc1 lds
    s_mul_i32 s91, s21, 458752
    s_add_u32 m0, s42, 8192
    s_nop 0
    buffer_load_dwordx4 v26, s[16:19], s40 offen lds
    s_add_u32 s23, s23, 1
    s_add_u32 m0, s22, 8192
    s_nop 0
    buffer_load_dwordx4 v9, s[8:11], s20 offen offset:0 sc1 lds
    s_cmp_eq_u32 s23, 3
    s_cselect_b32 s93, 147456, 0
    s_cselect_b32 s23, 0, s23
    s_add_u32 m0, s42, 12288
    s_nop 0
    buffer_load_dwordx4 v27, s[16:19], s40 offen lds
    s_sub_u32 s93, 49152, s93
    s_add_u32 m0, s22, 8192
    s_nop 0
    buffer_load_dwordx4 v9, s[8:11], s20 offen offset:1024 sc1 lds
    s_add_u32 m0, s42, 16384
    s_nop 0
    buffer_load_dwordx4 v28, s[16:19], s40 offen lds
    s_add_u32 m0, s42, 20480
    s_nop 0
    buffer_load_dwordx4 v29, s[16:19], s40 offen lds
    s_add_u32 m0, s42, 24576
    s_nop 0
    buffer_load_dwordx4 v30, s[16:19], s40 offen lds
    s_add_u32 m0, s42, 28672
    s_nop 0
    buffer_load_dwordx4 v31, s[16:19], s40 offen lds
    s_mov_b32 s20, s90
    s_mov_b32 s40, s91
    s_add_u32 s22, s22, s93
    s_add_u32 s42, s42, s93
    s_waitcnt vmcnt(12)
    s_barrier
    s_sub_u32 s44, s44, 1
    s_cmp_lg_u32 s44, 0
    s_cbranch_scc1 LD3_lt2
    s_cmp_eq_u32 s94, 0xffff
    s_cbranch_scc1 WR23_ok
    s_lshl_b32 s34, 1, s21
    s_andn2_b32 s3, s34, s94
    s_cbranch_scc0 WR23_ok
WR23_t:
    s_mov_b64 exec, 0xffff
    global_load_dwordx2 v[42:43], v40, s[68:69] sc1
    s_max_u32 s96, s96, 1
    s_sub_u32 s96, s96, 1
    s_waitcnt vmcnt(0)
    v_cmp_eq_u64 s[94:95], s[74:75], v[42:43]
    s_mov_b64 exec, -1
    s_cmp_eq_u32 s96, 0
    s_cselect_b32 s94, 0xffff, s94
    s_cselect_b32 s96, 1, s96
    s_andn2_b32 s3, s34, s94
    s_cbranch_scc0 WR23_ok
    s_sleep 2
    s_branch WR23_t
WR23_ok:
    s_add_u32 m0, s42, 0
    s_nop 0
    buffer_load_dwordx4 v24, s[16:19], s40 offen lds
    s_add_u32 s21, s21, 1
    s_add_u32 m0, s22, 0
    s_nop 0
    buffer_load_dwordx4 v8, s[8:11], s20 offen offset:0 sc1 lds
    s_cmp_eq_u32 s21, 16
    s_cselect_b32 s21, 0, s21
    s_add_u32 m0, s42, 4096
    s_nop 0
    buffer_load_dwordx4 v25, s[16:19], s40 offen lds
    s_mul_i32 s90, s21, 2048
    s_add_u32 m0, s22, 0
    s_nop 0
    buffer_load_dwordx4 v8, s[8:11], s20 offen offset:1024 sc1 lds
    s_mul_i32 s91, s21, 458752
    s_add_u32 m0, s42, 8192
    s_nop 0
    buffer_load_dwordx4 v26, s[16:19], s40 offen lds
    s_add_u32 s23, s23, 1
    s_add_u32 m0, s22, 8192
    s_nop 0
    buffer_load_dwordx4 v9, s[8:11], s20 offen offset:0 sc1 lds
    s_cmp_eq_u32 s23, 3
    s_cselect_b32 s93, 147456, 0
    s_cselect_b32 s23, 0, s23
    s_add_u32 m0, s42, 12288
    s_nop 0
    buffer_load_dwordx4 v27, s[16:19], s40 offen lds
    s_sub_u32 s93, 49152, s93
    s_add_u32 m0, s22, 8192
    s_nop 0
    buffer_load_dwordx4 v9, s[8:11], s20 offen offset:1024 sc1 lds
    s_add_u32 m0, s42, 16384
    s_nop 0
    buffer_load_dwordx4 v28, s[16:19], s40 offen lds
    s_add_u32 m0, s42, 20480
    s_nop 0
    buffer_load_dwordx4 v29, s[16:19], s40 offen lds
    s_add_u32 m0, s42, 24576
    s_nop 0
    buffer_load_dwordx4 v30, s[16:19], s40 offen lds
    s_add_u32 m0, s42, 28672
    s_nop 0
    buffer_load_dwordx4 v31, s[16:19], s40 offen lds
    s_mov_b32 s20, s90
    s_mov_b32 s40, s91
    s_add_u32 s22, s22, s93
    s_add_u32 s42, s42, s93
    s_mov_b32 s3, 0x40000
LD3cs_pl:
    v_cmp_eq_u64 vcc, s[74:75], v[172:173]
    s_nop 0
    s_cmp_eq_u64 vcc, -1
    s_cbranch_scc1 LD3cs_pd
    s_sleep 2
    global_load_dwordx2 v[172:173], v168, s[68:69] sc1
    s_waitcnt vmcnt(0)
    s_sub_u32 s3, s3, 1
    s_cmp_lg_u32 s3, 0
    s_cbranch_scc1 LD3cs_pl
LD3cs_pd:
    s_waitcnt vmcnt(12)
    s_barrier
    s_mov_b32 s3, s82
    buffer_load_dwordx4 v[64:67], v139, s[24:27], s3 offen sc1
    s_add_u32 s3, s3, 14336
    buffer_load_dwordx4 v[68:71], v139, s[24:27], s3 offen sc1
    buffer_load_ushort v96, v156, s[76:79], 0 offen
LD3_ar:
    s_cmp_eq_u32 s94, 0xffff
    s_cbranch_scc1 LD3_ar2
    s_mov_b64 exec, 0xffff
    global_load_dwordx2 v[42:43], v40, s[68:69] sc1
    s_max_u32 s96, s96, 1
    s_sub_u32 s96, s96, 1
    s_waitcnt vmcnt(0)
    v_cmp_eq_u64 s[94:95], s[74:75], v[42:43]
    s_mov_b64 exec, -1
    s_cmp_eq_u32 s96, 0
    s_cselect_b32 s94, 0xffff, s94
    s_cselect_b32 s96, 1, s96
    s_branch LD3_ar
LD3_ar2:
    s_mov_b32 s3, 0
    buffer_load_dwordx4 v[140:143], v138, s[28:31], s3 offen sc1
    s_mov_b32 s3, 16384
    buffer_load_dwordx4 v[144:147], v138, s[28:31], s3 offen sc1
    s_mov_b32 s3, 32768
    buffer_load_dwordx4 v[148:151], v138, s[28:31], s3 offen sc1
    s_mov_b32 s3, 49152
    buffer_load_dwordx4 v[152:155], v138, s[28:31], s3 offen sc1
    v_lshlrev_b32 v132, 2, v157
    v_add_u32 v133, 153856, v132
    v_add_u32 v132, 149760, v132
    v_and_b32 v134, 127, v157
    v_lshlrev_b32 v134, 3, v134
    v_add_u32 v158, 157952, v134
    v_add_u32 v134, 147712, v134
    v_mov_b32 v32, 147476
    v_mov_b32 v33, 1
    s_mov_b32 s37, 0
    s_add_u32 s46, s70, s4
    s_add_u32 s30, s37, s46
    s_and_b32 s30, s30, 3
    s_andn2_b32 s24, s37, 3
    s_add_u32 s24, s24, s30
    s_sub_u32 s25, s24, 8
    s_lshr_b32 s25, s25, 1
    s_and_b32 s26, s24, 1
    s_mul_i32 s26, s26, 3
    s_add_u32 s26, s26, 1
    s_cmp_lt_u32 s24, 8
    s_cselect_b32 s25, s24, s25
    s_cselect_b32 s26, 0, s26
    s_cselect_b32 s27, 3, 1
    s_cselect_b32 s29, 16, 0
    s_sub_u32 s30, s24, 24
    s_lshl_b32 s30, s30, 1
    s_cmp_ge_u32 s24, 24
    s_cselect_b32 s25, s30, s25
    s_cselect_b32 s26, 6, s26
    s_cselect_b32 s27, 7, s27
    s_cselect_b32 s28, 3, 1
    s_mul_i32 s30, s25, 7
    s_add_u32 s26, s26, s30
    s_add_u32 s27, s27, s26
    s_lshl_b32 s36, s26, 16
    s_lshl_b32 s81, s27, 16
    s_mul_i32 s38, s6, 1024
    s_add_u32 s38, s38, 65536
    s_mov_b32 s39, 1
    s_add_u32 m0, s38, 0
    s_nop 0
    buffer_load_dwordx4 v16, s[12:15], s36 offen lds
    s_add_u32 m0, s38, 4096
    s_nop 0
    buffer_load_dwordx4 v17, s[12:15], s81 offen lds
    s_add_u32 m0, s38, 8192
    s_nop 0
    buffer_load_dwordx4 v18, s[12:15], s36 offen lds
    s_add_u32 m0, s38, 12288
    s_nop 0
    buffer_load_dwordx4 v19, s[12:15], s81 offen lds
    s_add_u32 s37, s37, 1
    s_add_u32 s30, s37, s46
    s_and_b32 s30, s30, 3
    s_andn2_b32 s24, s37, 3
    s_add_u32 s24, s24, s30
    s_sub_u32 s25, s24, 8
    s_lshr_b32 s25, s25, 1
    s_and_b32 s26, s24, 1
    s_mul_i32 s26, s26, 3
    s_add_u32 s26, s26, 1
    s_cmp_lt_u32 s24, 8
    s_cselect_b32 s25, s24, s25
    s_cselect_b32 s26, 0, s26
    s_cselect_b32 s27, 3, 1
    s_cselect_b32 s29, 16, 0
    s_sub_u32 s30, s24, 24
    s_lshl_b32 s30, s30, 1
    s_cmp_ge_u32 s24, 24
    s_cselect_b32 s25, s30, s25
    s_cselect_b32 s26, 6, s26
    s_cselect_b32 s27, 7, s27
    s_cselect_b32 s28, 3, 1
    s_mul_i32 s30, s25, 7
    s_add_u32 s26, s26, s30
    s_add_u32 s27, s27, s26
    s_lshl_b32 s36, s26, 16
    s_lshl_b32 s81, s27, 16
    s_add_u32 s38, s38, 49152
    s_add_u32 s39, s39, 1
    s_cmp_eq_u32 s39, 3
    s_cselect_b32 s7, 147456, 0
    s_cselect_b32 s39, 0, s39
    s_sub_u32 s38, s38, s7
    s_waitcnt vmcnt(11)
    s_barrier
    s_waitcnt vmcnt(4)
    s_setprio 3
    v_add_f32 v64, v64, v68
    v_add_f32 v65, v65, v69
    v_add_f32 v66, v66, v70
    v_add_f32 v67, v67, v71
    ds_write_b128 v166, v[64:67]
    v_add_f32 v140, v140, v148
    v_add_f32 v141, v141, v149
    v_add_f32 v142, v142, v150
    v_add_f32 v143, v143, v151
    v_add_f32 v144, v144, v152
    v_add_f32 v145, v145, v153
    v_add_f32 v146, v146, v154
    v_add_f32 v147, v147, v155
    v_add_f32 v140, v140, v144
    v_add_f32 v141, v141, v145
    v_add_f32 v142, v142, v146
    v_add_f32 v143, v143, v147
    ds_write_b128 v166, v[140:143] offset:4096
    s_mov_b64 exec, 1
    s_waitcnt lgkmcnt(0)
    ds_add_u32 v32, v33
LD3_ls:
    ds_read_b32 v34, v32
    s_waitcnt lgkmcnt(0)
    v_readfirstlane_b32 s3, v34
    s_nop 0
    s_cmp_lt_u32 s3, 8
    s_cbranch_scc1 LD3_ls
    s_mov_b64 exec, -1
    ds_read2st64_b64 v[140:143], v158 offset0:0 offset1:2
    ds_read2st64_b64 v[144:147], v158 offset0:4 offset1:6
    ds_read2st64_b32 v[64:65], v133 offset0:0 offset1:4
    ds_read2st64_b32 v[66:67], v133 offset0:8 offset1:12
    v_lshlrev_b32 v96, 16, v96
    ds_write_b32 v132, v96 offset:3072
    s_waitcnt lgkmcnt(0)
    v_add_f32 v64, v64, v65
    v_add_f32 v66, v66, v67
    v_add_f32 v64, v64, v66
    ds_write_b32 v132, v64 offset:2048
    v_add_f32 v140, v140, v144
    v_add_f32 v141, v141, v145
    v_add_f32 v142, v142, v146
    v_add_f32 v143, v143, v147
    v_add_f32 v140, v140, v142
    v_add_f32 v141, v141, v143
    v_mul_f32 v140, 0x3a800000, v140
    v_mul_f32 v141, 0x3a800000, v141
    v_fma_f32 v141, -v140, v140, v141
    v_max_f32 v141, 0, v141
    v_cvt_pk_bf16_f32 v140, v140, v140
    v_lshlrev_b32 v140, 16, v140
    v_cvt_pk_bf16_f32 v141, v141, v141
    v_lshlrev_b32 v141, 16, v141
    v_add_f32 v141, 0x3727c5ac, v141
    v_cvt_pk_bf16_f32 v141, v141, v141
    v_lshlrev_b32 v141, 16, v141
    v_sqrt_f32 v141, v141
    s_nop 0
    v_cvt_pk_bf16_f32 v141, v141, v141
    v_lshlrev_b32 v141, 16, v141
    v_rcp_f32 v142, v141
    s_nop 0
    v_mul_f32 v143, v140, v142
    v_sub_f32 v143, 0, v143
    ds_write_b64 v134, v[142:143]
    s_waitcnt lgkmcnt(0)
    s_setprio 0
    s_getpc_b64 s[34:35]
CT24:
    s_add_u32 s34, s34, CT_e3-CT24
    s_addc_u32 s35, s35, (CT_e3-CT24)>>32
    s_lshl_b32 s3, s6, 7
    v_lshlrev_b32 v49, 9, v1
    v_add_u32 v49, s3, v49
    v_cmp_gt_u32 vcc, CT_e4-CT_e3, v49
    s_nop 0
    s_mov_b64 exec, vcc
    s_cbranch_execz CT24_e
    global_load_dword v48, v49, s[34:35]
CT24_e:
    s_mov_b64 exec, -1
    s_getpc_b64 s[34:35]
CT25:
    s_add_u32 s34, s34, LD3_e-CT25
    s_addc_u32 s35, s35, (LD3_e-CT25)>>32
    s_lshl_b32 s3, s6, 7
    v_lshlrev_b32 v49, 9, v1
    v_add_u32 v49, s3, v49
    v_cmp_gt_u32 vcc, LD4_e-LD3_e, v49
    s_nop 0
    s_mov_b64 exec, vcc
    s_cbranch_execz CT25_e
    global_load_dword v50, v49, s[34:35]
CT25_e:
    s_mov_b64 exec, -1
    s_barrier
    s_add_u32 m0, s38, 0
    s_nop 0
    buffer_load_dwordx4 v16, s[12:15], s36 offen lds
    s_add_u32 m0, s38, 4096
    s_nop 0
    buffer_load_dwordx4 v17, s[12:15], s81 offen lds
    s_add_u32 m0, s38, 8192
    s_nop 0
    buffer_load_dwordx4 v18, s[12:15], s36 offen lds
    s_add_u32 m0, s38, 12288
    s_nop 0
    buffer_load_dwordx4 v19, s[12:15], s81 offen lds
    s_add_u32 s37, s37, 1
    s_add_u32 s30, s37, s46
    s_and_b32 s30, s30, 3
    s_andn2_b32 s24, s37, 3
    s_add_u32 s24, s24, s30
    s_sub_u32 s25, s24, 8
    s_lshr_b32 s25, s25, 1
    s_and_b32 s26, s24, 1
    s_mul_i32 s26, s26, 3
    s_add_u32 s26, s26, 1
    s_cmp_lt_u32 s24, 8
    s_cselect_b32 s25, s24, s25
    s_cselect_b32 s26, 0, s26
    s_cselect_b32 s27, 3, 1
    s_cselect_b32 s29, 16, 0
    s_sub_u32 s30, s24, 24
    s_lshl_b32 s30, s30, 1
    s_cmp_ge_u32 s24, 24
    s_cselect_b32 s25, s30, s25
    s_cselect_b32 s26, 6, s26
    s_cselect_b32 s27, 7, s27
    s_cselect_b32 s28, 3, 1
    s_mul_i32 s30, s25, 7
    s_add_u32 s26, s26, s30
    s_add_u32 s27, s27, s26
    s_lshl_b32 s36, s26, 16
    s_lshl_b32 s81, s27, 16
    s_add_u32 s38, s38, 49152
    s_add_u32 s39, s39, 1
    s_cmp_eq_u32 s39, 3
    s_cselect_b32 s7, 147456, 0
    s_cselect_b32 s39, 0, s39
    s_sub_u32 s38, s38, s7
    global_store_dwordx4 v180, v[184:187], s[68:69] offset:0 sc1
    global_store_dwordx4 v180, v[184:187], s[68:69] offset:1024 sc1
    global_store_dwordx4 v180, v[184:187], s[68:69] offset:2048 sc1
    global_store_dwordx4 v180, v[184:187], s[68:69] offset:3072 sc1
    global_store_dwordx4 v181, v[184:187], s[68:69] offset:0 sc1
    global_store_dwordx4 v181, v[184:187], s[68:69] offset:1024 sc1
LD3_e:
    s_add_u32 s8, s68, 12582912
    s_addc_u32 s9, s69, 0
    s_mov_b32 s10, 14680064
    s_mov_b32 s11, 0x20000
    s_lshl_b32 s7, s70, 3
    s_add_u32 s7, s7, s6
    s_mul_i32 s7, s7, 114688
    s_mul_i32 s3, s5, 57344
    s_add_u32 s7, s7, s3
    v_lshlrev_b32 v8, 4, v1
    v_add_u32 v8, s7, v8
    v_add_u32 v9, 458752, v8
    s_mov_b32 s21, 0
    s_add_u32 s45, s70, s4
    s_add_u32 s30, s21, s45
    s_and_b32 s30, s30, 3
    s_andn2_b32 s24, s21, 3
    s_add_u32 s24, s24, s30
    s_sub_u32 s25, s24, 8
    s_lshr_b32 s25, s25, 1
    s_and_b32 s26, s24, 1
    s_mul_i32 s26, s26, 3
    s_add_u32 s26, s26, 1
    s_cmp_lt_u32 s24, 8
    s_cselect_b32 s25, s24, s25
    s_cselect_b32 s26, 0, s26
    s_cselect_b32 s27, 3, 1
    s_cselect_b32 s29, 16, 0
    s_sub_u32 s30, s24, 24
    s_lshl_b32 s30, s30, 1
    s_cmp_ge_u32 s24, 24
    s_cselect_b32 s25, s30, s25
    s_cselect_b32 s26, 6, s26
    s_cselect_b32 s27, 7, s27
    s_cselect_b32 s28, 3, 1
    s_mul_i32 s30, s25, 7
    s_add_u32 s26, s26, s30
    s_add_u32 s27, s27, s26
    s_lshl_b32 s20, s26, 10
    s_lshl_b32 s80, s27, 10
    s_sub_u32 s80, s80, 1024
    s_lshl_b32 s30, s5, 3
    s_add_u32 s29, s29, s25
    s_add_u32 s29, s29, s30
    s_lshl_b32 s82, s28, s29
    s_mul_i32 s22, s6, 2048
    s_add_u32 s22, s22, 49152
    s_mov_b32 s23, 1
    s_lshl_b32 s3, s70, 11
    s_add_u32 s3, s3, 31621120
    s_mov_b32 s83, s3
    v_mov_b32 v44, 147516
    v_lshlrev_b32 v40, 7, v1
    v_add_u32 v40, s3, v40
    v_add_u32 v41, 4294866944, v40
    v_cmp_gt_u32 vcc, 16, v1
    s_nop 1
    v_cndmask_b32 v40, v41, v40, vcc
    s_mov_b64 s[94:95], 0
    s_mov_b32 s96, 0x40000
    s_mov_b32 s34, s82
    s_andn2_b32 s3, s34, s94
    s_cbranch_scc0 WR26_ok
WR26_t:
    s_cmp_lg_u32 s6, 0
    s_cbranch_scc1 WR26_w
    s_mov_b32 exec_hi, 0
    global_load_dwordx2 v[42:43], v40, s[68:69] sc1
    s_max_u32 s96, s96, 1
    s_sub_u32 s96, s96, 1
    s_waitcnt vmcnt(0)
    v_cmp_eq_u64 s[94:95], s[74:75], v[42:43]
    s_mov_b64 exec, -1
    s_cmp_eq_u32 s96, 0
    s_cselect_b32 s94, -1, s94
    s_cselect_b32 s96, 1, s96
    v_mov_b32 v45, s94
    ds_write_b32 v44, v45
    s_branch WR26_c
WR26_w:
    ds_read_b32 v45, v44
    s_sub_u32 s96, s96, 1
    s_cselect_b32 s96, 0, s96
    s_cselect_b32 s7, -1, 0
    s_waitcnt lgkmcnt(0)
    v_readfirstlane_b32 s3, v45
    s_nop 0
    s_or_b32 s94, s94, s3
    s_or_b32 s94, s94, s7
WR26_c:
    s_andn2_b32 s3, s34, s94
    s_cbranch_scc0 WR26_ok
    s_sleep 2
    s_branch WR26_t
WR26_ok:
    s_add_u32 m0, s22, 0
    s_nop 0
    buffer_load_dwordx4 v8, s[8:11], s20 offen offset:0 sc1 lds
    buffer_load_dwordx4 v8, s[8:11], s80 offen offset:1024 sc1 lds
    s_add_u32 m0, s22, 8192
    s_nop 0
    buffer_load_dwordx4 v9, s[8:11], s20 offen offset:0 sc1 lds
    buffer_load_dwordx4 v9, s[8:11], s80 offen offset:1024 sc1 lds
    s_add_u32 s21, s21, 1
    s_add_u32 s30, s21, s45
    s_and_b32 s30, s30, 3
    s_andn2_b32 s24, s21, 3
    s_add_u32 s24, s24, s30
    s_sub_u32 s25, s24, 8
    s_lshr_b32 s25, s25, 1
    s_and_b32 s26, s24, 1
    s_mul_i32 s26, s26, 3
    s_add_u32 s26, s26, 1
    s_cmp_lt_u32 s24, 8
    s_cselect_b32 s25, s24, s25
    s_cselect_b32 s26, 0, s26
    s_cselect_b32 s27, 3, 1
    s_cselect_b32 s29, 16, 0
    s_sub_u32 s30, s24, 24
    s_lshl_b32 s30, s30, 1
    s_cmp_ge_u32 s24, 24
    s_cselect_b32 s25, s30, s25
    s_cselect_b32 s26, 6, s26
    s_cselect_b32 s27, 7, s27
    s_cselect_b32 s28, 3, 1
    s_mul_i32 s30, s25, 7
    s_add_u32 s26, s26, s30
    s_add_u32 s27, s27, s26
    s_lshl_b32 s20, s26, 10
    s_lshl_b32 s80, s27, 10
    s_sub_u32 s80, s80, 1024
    s_lshl_b32 s30, s5, 3
    s_add_u32 s29, s29, s25
    s_add_u32 s29, s29, s30
    s_lshl_b32 s82, s28, s29
    s_add_u32 s22, s22, 49152
    s_add_u32 s23, s23, 1
    s_cmp_eq_u32 s23, 3
    s_cselect_b32 s7, 147456, 0
    s_cselect_b32 s23, 0, s23
    s_sub_u32 s22, s22, s7
    s_mov_b32 s34, s82
    s_andn2_b32 s3, s34, s94
    s_cbranch_scc0 LD4_x1
    s_waitcnt vmcnt(0)
    s_barrier
    s_mov_b32 s34, s82
    s_andn2_b32 s3, s34, s94
    s_cbranch_scc0 WR27_ok
WR27_t:
    s_cmp_lg_u32 s6, 0
    s_cbranch_scc1 WR27_w
    s_mov_b32 exec_hi, 0
    global_load_dwordx2 v[42:43], v40, s[68:69] sc1
    s_max_u32 s96, s96, 1
    s_sub_u32 s96, s96, 1
    s_waitcnt vmcnt(0)
    v_cmp_eq_u64 s[94:95], s[74:75], v[42:43]
    s_mov_b64 exec, -1
    s_cmp_eq_u32 s96, 0
    s_cselect_b32 s94, -1, s94
    s_cselect_b32 s96, 1, s96
    v_mov_b32 v45, s94
    ds_write_b32 v44, v45
    s_branch WR27_c
WR27_w:
    ds_read_b32 v45, v44
    s_sub_u32 s96, s96, 1
    s_cselect_b32 s96, 0, s96
    s_cselect_b32 s7, -1, 0
    s_waitcnt lgkmcnt(0)
    v_readfirstlane_b32 s3, v45
    s_nop 0
    s_or_b32 s94, s94, s3
    s_or_b32 s94, s94, s7
WR27_c:
    s_andn2_b32 s3, s34, s94
    s_cbranch_scc0 WR27_ok
    s_sleep 2
    s_branch WR27_t
WR27_ok:
    s_add_u32 m0, s22, 0
    s_nop 0
    buffer_load_dwordx4 v8, s[8:11], s20 offen offset:0 sc1 lds
    buffer_load_dwordx4 v8, s[8:11], s80 offen offset:1024 sc1 lds
    s_add_u32 m0, s22, 8192
    s_nop 0
    buffer_load_dwordx4 v9, s[8:11], s20 offen offset:0 sc1 lds
    buffer_load_dwordx4 v9, s[8:11], s80 offen offset:1024 sc1 lds
    s_add_u32 s21, s21, 1
    s_add_u32 s30, s21, s45
    s_and_b32 s30, s30, 3
    s_andn2_b32 s24, s21, 3
    s_add_u32 s24, s24, s30
    s_sub_u32 s25, s24, 8
    s_lshr_b32 s25, s25, 1
    s_and_b32 s26, s24, 1
    s_mul_i32 s26, s26, 3
    s_add_u32 s26, s26, 1
    s_cmp_lt_u32 s24, 8
    s_cselect_b32 s25, s24, s25
    s_cselect_b32 s26, 0, s26
    s_cselect_b32 s27, 3, 1
    s_cselect_b32 s29, 16, 0
    s_sub_u32 s30, s24, 24
    s_lshl_b32 s30, s30, 1
    s_cmp_ge_u32 s24, 24
    s_cselect_b32 s25, s30, s25
    s_cselect_b32 s26, 6, s26
    s_cselect_b32 s27, 7, s27
    s_cselect_b32 s28, 3, 1
    s_mul_i32 s30, s25, 7
    s_add_u32 s26, s26, s30
    s_add_u32 s27, s27, s26
    s_lshl_b32 s20, s26, 10
    s_lshl_b32 s80, s27, 10
    s_sub_u32 s80, s80, 1024
    s_lshl_b32 s30, s5, 3
    s_add_u32 s29, s29, s25
    s_add_u32 s29, s29, s30
    s_lshl_b32 s82, s28, s29
    s_add_u32 s22, s22, 49152
    s_add_u32 s23, s23, 1
    s_cmp_eq_u32 s23, 3
    s_cselect_b32 s7, 147456, 0
    s_cselect_b32 s23, 0, s23
    s_sub_u32 s22, s22, s7
    s_branch LD4_x2
LD4_x1:
    s_add_u32 m0, s22, 0
    s_nop 0
    buffer_load_dwordx4 v8, s[8:11], s20 offen offset:0 sc1 lds
    buffer_load_dwordx4 v8, s[8:11], s80 offen offset:1024 sc1 lds
    s_add_u32 m0, s22, 8192
    s_nop 0
    buffer_load_dwordx4 v9, s[8:11], s20 offen offset:0 sc1 lds
    buffer_load_dwordx4 v9, s[8:11], s80 offen offset:1024 sc1 lds
    s_waitcnt vmcnt(4)
    s_barrier
    s_add_u32 s21, s21, 1
    s_add_u32 s30, s21, s45
    s_and_b32 s30, s30, 3
    s_andn2_b32 s24, s21, 3
    s_add_u32 s24, s24, s30
    s_sub_u32 s25, s24, 8
    s_lshr_b32 s25, s25, 1
    s_and_b32 s26, s24, 1
    s_mul_i32 s26, s26, 3
    s_add_u32 s26, s26, 1
    s_cmp_lt_u32 s24, 8
    s_cselect_b32 s25, s24, s25
    s_cselect_b32 s26, 0, s26
    s_cselect_b32 s27, 3, 1
    s_cselect_b32 s29, 16, 0
    s_sub_u32 s30, s24, 24
    s_lshl_b32 s30, s30, 1
    s_cmp_ge_u32 s24, 24
    s_cselect_b32 s25, s30, s25
    s_cselect_b32 s26, 6, s26
    s_cselect_b32 s27, 7, s27
    s_cselect_b32 s28, 3, 1
    s_mul_i32 s30, s25, 7
    s_add_u32 s26, s26, s30
    s_add_u32 s27, s27, s26
    s_lshl_b32 s20, s26, 10
    s_lshl_b32 s80, s27, 10
    s_sub_u32 s80, s80, 1024
    s_lshl_b32 s30, s5, 3
    s_add_u32 s29, s29, s25
    s_add_u32 s29, s29, s30
    s_lshl_b32 s82, s28, s29
    s_add_u32 s22, s22, 49152
    s_add_u32 s23, s23, 1
    s_cmp_eq_u32 s23, 3
    s_cselect_b32 s7, 147456, 0
    s_cselect_b32 s23, 0, s23
    s_sub_u32 s22, s22, s7
LD4_x2:
    s_mov_b32 s44, 26
LD4_la:
    s_mov_b32 s34, s82
    s_andn2_b32 s3, s34, s94
    s_cbranch_scc0 WR28_ok
WR28_t:
    s_mov_b32 exec_hi, 0
    global_load_dwordx2 v[42:43], v40, s[68:69] sc1
    s_max_u32 s96, s96, 1
    s_sub_u32 s96, s96, 1
    s_waitcnt vmcnt(0)
    v_cmp_eq_u64 s[94:95], s[74:75], v[42:43]
    s_mov_b64 exec, -1
    s_cmp_eq_u32 s96, 0
    s_cselect_b32 s94, -1, s94
    s_cselect_b32 s96, 1, s96
    s_andn2_b32 s3, s34, s94
    s_cbranch_scc0 WR28_ok
    s_sleep 2
    s_branch WR28_t
WR28_ok:
    s_add_u32 m0, s38, 0
    s_nop 0
    buffer_load_dwordx4 v16, s[12:15], s36 offen lds
    s_add_u32 s21, s21, 1
    s_add_u32 s30, s21, s45
    s_and_b32 s30, s30, 3
    s_andn2_b32 s24, s21, 3
    s_add_u32 s24, s24, s30
    s_add_u32 m0, s22, 0
    s_nop 0
    buffer_load_dwordx4 v8, s[8:11], s20 offen offset:0 sc1 lds
    s_sub_u32 s25, s24, 8
    s_lshr_b32 s25, s25, 1
    s_and_b32 s26, s24, 1
    s_mul_i32 s26, s26, 3
    s_add_u32 s26, s26, 1
    s_add_u32 m0, s38, 4096
    s_nop 0
    buffer_load_dwordx4 v17, s[12:15], s81 offen lds
    s_cmp_lt_u32 s24, 8
    s_cselect_b32 s25, s24, s25
    s_cselect_b32 s26, 0, s26
    s_cselect_b32 s27, 3, 1
    s_cselect_b32 s29, 16, 0
    s_sub_u32 s30, s24, 24
    s_lshl_b32 s30, s30, 1
    s_cmp_ge_u32 s24, 24
    s_cselect_b32 s25, s30, s25
    s_cselect_b32 s26, 6, s26
    s_cselect_b32 s27, 7, s27
    s_cselect_b32 s28, 3, 1
    s_mul_i32 s30, s25, 7
    s_add_u32 m0, s22, 0
    s_nop 0
    buffer_load_dwordx4 v8, s[8:11], s80 offen offset:1024 sc1 lds
    s_add_u32 s26, s26, s30
    s_add_u32 s27, s27, s26
    s_lshl_b32 s90, s26, 10
    s_lshl_b32 s76, s27, 10
    s_sub_u32 s76, s76, 1024
    s_add_u32 m0, s38, 8192
    s_nop 0
    buffer_load_dwordx4 v18, s[12:15], s36 offen lds
    s_lshl_b32 s91, s26, 16
    s_lshl_b32 s77, s27, 16
    s_lshl_b32 s30, s5, 3
    s_add_u32 s29, s29, s25
    s_add_u32 s29, s29, s30
    s_add_u32 m0, s22, 8192
    s_nop 0
    buffer_load_dwordx4 v9, s[8:11], s20 offen offset:0 sc1 lds
    s_lshl_b32 s82, s28, s29
    s_add_u32 s23, s23, 1
    s_cmp_eq_u32 s23, 3
    s_cselect_b32 s93, 147456, 0
    s_cselect_b32 s23, 0, s23
    s_sub_u32 s93, 49152, s93
    s_add_u32 m0, s38, 12288
    s_nop 0
    buffer_load_dwordx4 v19, s[12:15], s81 offen lds
    s_add_u32 m0, s22, 8192
    s_nop 0
    buffer_load_dwordx4 v9, s[8:11], s80 offen offset:1024 sc1 lds
    s_mov_b32 s20, s90
    s_mov_b32 s36, s91
    s_mov_b32 s80, s76
    s_mov_b32 s81, s77
    s_add_u32 s22, s22, s93
    s_add_u32 s38, s38, s93
    s_waitcnt vmcnt(8)
    s_barrier
    s_sub_u32 s44, s44, 1
    s_cmp_lg_u32 s44, 0
    s_cbranch_scc1 LD4_la
    s_waitcnt vmcnt(0)
    s_barrier
    s_getpc_b64 s[34:35]
CT29:
    s_add_u32 s34, s34, CT_e4-CT29
    s_addc_u32 s35, s35, (CT_e4-CT29)>>32
    s_lshl_b32 s3, s6, 7
    v_lshlrev_b32 v49, 9, v1
    v_add_u32 v49, s3, v49
    v_cmp_gt_u32 vcc, KEND-CT_e4, v49
    s_nop 0
    s_mov_b64 exec, vcc
    s_cbranch_execz CT29_e
    global_load_dword v48, v49, s[34:35]
CT29_e:
    s_mov_b64 exec, -1
    s_barrier
LD4_e:
    s_endpgm
.section .rodata,"a"
.p2align 6
.amdhsa_kernel sequential_preLN__sliding_local_dilated__dense_activation_gelu__prompt_kernel
  .amdhsa_next_free_vgpr 256
  .amdhsa_next_free_sgpr 102
  .amdhsa_accum_offset 256
  .amdhsa_group_segment_fixed_size 0
  .amdhsa_kernarg_size 88
  .amdhsa_user_sgpr_count 2
  .amdhsa_user_sgpr_kernarg_segment_ptr 1
  .amdhsa_system_sgpr_workgroup_id_x 1
  .amdhsa_float_denorm_mode_32 3
.end_amdhsa_kernel
```
